```python
import torch

def _softmax(x, axis=-1):
    return torch.softmax(x, dim=axis)
def _gelu(x):
    return torch.nn.functional.gelu(x, approximate="tanh")
def _silu(x):
    return torch.nn.functional.silu(x)
def _sigmoid(x):
    return torch.sigmoid(x)
def _layernorm(x, axis=-1, eps=1e-5):
    m = x.mean(dim=axis, keepdim=True)
    v = x.var(dim=axis, keepdim=True, unbiased=False)
    return (x - m) / torch.sqrt(v + eps)
def _scatter_add(tgt, idx, src, axis=0):
    return tgt.clone().index_add_(axis, idx, src)
def _segment_sum(src, seg, n):
    out = torch.zeros((n,) + src.shape[1:], dtype=src.dtype)
    return out.index_add_(0, seg, src)
def _pad(x, pw):
    flat = tuple(v for pair in reversed(pw) for v in pair)
    return torch.nn.functional.pad(x, flat)

kernel_name = 'interleave_layers__linear_kernel_hedgehog__glu_gated_reglu__prompt'

def setup_inputs():

    _w = (lambda a: (lambda t: t.to(torch.bfloat16) if t.is_floating_point() else t)(torch.as_tensor(a)))
    def _A_setup():
        B, S, D, H = 1, 2048, 512, 32
        Dh = D // H
        return {
            "x": _w((lambda *s: torch.randn(*s, dtype=torch.bfloat16) * 0.05)(B, S, D)),
            "wqkv": _w((lambda *s: torch.randn(*s, dtype=torch.bfloat16) * 0.4)(D, 3 * D)),
            "w_phi": _w((lambda *s: torch.randn(*s, dtype=torch.bfloat16) * 0.4)(H, Dh, Dh) * (Dh ** -0.5)),
            "wo": _w((lambda *s: torch.randn(*s, dtype=torch.bfloat16) * 0.05)(D, D)),
        }
    _A_in = _A_setup()

    def _B_setup():
        B, S, D, F = 1, 2048, 512, 1792
        return {
            "x": _w((lambda *s: torch.randn(*s, dtype=torch.bfloat16) * 0.05)(B, S, D)),
            "W_gate": _w((lambda *s: torch.randn(*s, dtype=torch.bfloat16) * 0.8)(D, F) * (2.0 / D) ** 0.5),
            "W_up": _w((lambda *s: torch.randn(*s, dtype=torch.bfloat16) * 0.8)(D, F) * (2.0 / D) ** 0.5),
            "W_down": _w((lambda *s: torch.randn(*s, dtype=torch.bfloat16) * 0.8)(F, D) * (1.0 / F) ** 0.5),
        }
    _B_in = _B_setup()

    return {
        "A_x": _A_in["x"],
        "A_wqkv": _A_in["wqkv"],
        "A_w_phi": _A_in["w_phi"],
        "A_wo": _A_in["wo"],
        "B_x": _B_in["x"],
        "B_W_gate": _B_in["W_gate"],
        "B_W_up": _B_in["W_up"],
        "B_W_down": _B_in["W_down"],
    }

def reference(A_x, A_wqkv, A_w_phi, A_wo, B_x, B_W_gate, B_W_up, B_W_down):
    def _A_ref(x, wqkv, w_phi, wo):
        B, S, D = x.shape
        H = 32; Dh = D // H
        qkv = (lambda x, *d: x.permute(*d))((x @ wqkv).reshape(B, S, 3, H, Dh), 2, 0, 3, 1, 4)
        q, k, v = qkv[0], qkv[1], qkv[2]
        pq = torch.einsum("bhsd,hdf->bhsf", q, w_phi)
        pk = torch.einsum("bhsd,hdf->bhsf", k, w_phi)
        phi_q = torch.concatenate([_softmax(pq, axis=-1), _softmax(-pq, axis=-1)], axis=-1)
        phi_k = torch.concatenate([_softmax(pk, axis=-1), _softmax(-pk, axis=-1)], axis=-1)
        kv = torch.einsum("bhsf,bhsd->bhfd", phi_k, v)
        z  = torch.einsum("bhsf->bhf", phi_k)
        num = torch.einsum("bhqf,bhfd->bhqd", phi_q, kv)
        den = torch.einsum("bhqf,bhf->bhq", phi_q, z)[..., None] + 1e-6
        o = num / den
        return (lambda x, *d: x.permute(*d))(o, 0, 2, 1, 3).reshape(B, S, D) @ wo

    def _B_ref(x, W_gate, W_up, W_down):
        gate = torch.einsum("bsd,df->bsf", x, W_gate)
        up = torch.einsum("bsd,df->bsf", x, W_up)
        gate = gate * (lambda x, dt: x.to(dt))(gate > 0, gate.dtype)
        h = gate * up
        return torch.einsum("bsf,fd->bsd", h, W_down)

    x = A_x
    x = x + _A_ref(_layernorm(x, axis=-1), A_wqkv, A_w_phi, A_wo)
    x = x + _B_ref(_layernorm(x, axis=-1), B_W_gate, B_W_up, B_W_down)
    x = x + _A_ref(_layernorm(x, axis=-1), A_wqkv, A_w_phi, A_wo)
    x = x + _B_ref(_layernorm(x, axis=-1), B_W_gate, B_W_up, B_W_down)
    return x
```

```asm
; @launch grid=(256,1,1) block=(256,1,1) lds=163840
.amdgcn_target "amdgcn-amd-amdhsa--gfx950"
.text
.p2align 12
.globl interleave_layers__linear_kernel_hedgehog__glu_gated_reglu__prompt_kernel
.p2align 8
.type interleave_layers__linear_kernel_hedgehog__glu_gated_reglu__prompt_kernel,@function
interleave_layers__linear_kernel_hedgehog__glu_gated_reglu__prompt_kernel:
  s_cmp_ge_u32 s2, 256
  s_cbranch_scc1 M_END
  s_load_dwordx2 s[80:81], s[0:1], 8
  s_load_dwordx2 s[88:89], s[0:1], 16
  s_load_dwordx2 s[12:13], s[0:1], 0
  s_load_dwordx2 s[8:9], s[0:1], 80
  s_load_dwordx2 s[16:17], s[0:1], 64
  s_load_dwordx2 s[20:21], s[0:1], 72
  s_load_dwordx4 s[40:43], s[0:1], 40
  s_load_dwordx2 s[72:73], s[0:1], 56
  s_load_dwordx2 s[6:7], s[0:1], 24
  s_lshr_b32 s26, s2, 3
  s_getpc_b64 s[4:5]
PC0:
  v_lshrrev_b32 v2, 4, v0
  v_lshl_add_u32 v2, s26, 4, v2
  v_lshlrev_b32 v2, 7, v2
  v_min_u32 v2, CODE_END-PC0-4, v2
  v_mov_b32 v3, s5
  v_add_co_u32 v2, vcc, s4, v2
  v_addc_co_u32 v3, vcc, 0, v3, vcc
  global_load_dword v21, v[2:3], off
  v_lshrrev_b32 v1, 6, v0
  v_and_b32 v0, 63, v0
  v_readfirstlane_b32 s24, v1
  s_mov_b32 s82, 0x180000
  s_mov_b32 s83, 0x20000
  s_lshr_b32 s64, s26, 4
  s_and_b32 s28, s26, 15
  s_and_b32 s30, s28, 7
  s_lshl_b32 s52, s24, 13
  s_lshl_b32 s65, s64, 11
  s_add_u32 s96, s65, s52
  s_lshl_b32 s65, s30, 1
  s_lshl_b32 s66, s24, 2
  s_xor_b32 s65, s65, s66
  s_or_b32 s67, s64, s65
  s_lshl_b32 s65, s28, 6
  s_mul_i32 s66, s67, 98304
  s_add_u32 s92, s66, s65
  v_lshrrev_b32 v48, 2, v0
  v_and_b32 v49, 3, v0
  v_lshrrev_b32 v51, 4, v0
  v_xor_b32 v49, v49, v51
  v_lshlrev_b32 v49, 4, v49
  v_mul_u32_u24 v32, 3072, v48
  v_add_u32 v32, v32, v49
  v_add_u32 v33, 48128, v32
  s_waitcnt lgkmcnt(0)
  s_xor_b32 m0, s96, 0x0
  s_add_u32 s61, s92, 1024
  buffer_load_dwordx4 v32, s[80:83], s61 offen lds
  buffer_load_dwordx4 v33, s[80:83], s61 offen offset:1024 lds
  s_mov_b32 s90, 0x4000
  s_mov_b32 s91, 0x20000
  v_lshlrev_b32 v1, 4, v0
  s_lshl_b32 s66, s28, 10
  s_mov_b32 m0, 0x27800
  s_nop 0
  buffer_load_dwordx4 v1, s[88:91], s66 offen lds
  s_xor_b32 m0, s96, 0x8000
  s_add_u32 s61, s92, 2048
  buffer_load_dwordx4 v32, s[80:83], s61 offen lds
  buffer_load_dwordx4 v33, s[80:83], s61 offen offset:1024 lds
  s_and_b32 s25, s2, 7
  s_lshl_b32 s27, s25, 1
  s_add_u32 s27, s27, s64
  s_mov_b32 s14, 0x200000
  s_mov_b32 s15, 0x20000
  s_lshl_b32 s64, s27, 17
  s_lshl_b32 s66, s28, 13
  s_add_u32 s64, s64, s66
  s_lshl_b32 s66, s24, 11
  s_add_u32 s64, s64, s66
  buffer_load_dwordx4 v[240:243], v1, s[12:15], s64 offen
  buffer_load_dwordx4 v[244:247], v1, s[12:15], s64 offen offset:1024
  s_xor_b32 s66, s67, 1
  s_mul_i32 s66, s66, 98304
  s_add_u32 s93, s66, s65
  s_xor_b32 s66, s67, 2
  s_mul_i32 s66, s66, 98304
  s_add_u32 s94, s66, s65
  s_xor_b32 s66, s67, 3
  s_mul_i32 s66, s66, 98304
  s_add_u32 s95, s66, s65
  s_mov_b32 s10, 0x10000000
  s_mov_b32 s11, 0x20000
  s_mov_b32 s18, 0x200000
  s_mov_b32 s19, 0x20000
  s_mov_b32 s22, 0x100
  s_mov_b32 s23, 0x20000
  s_lshr_b32 s29, s28, 3
  s_lshl_b32 s64, s27, 2
  s_add_u32 s64, s64, s24
  s_lshl_b32 s64, s64, 15
  s_lshl_b32 s65, s30, 7
  s_or_b32 s64, s64, s65
  s_lshl_b32 s65, s29, 14
  s_or_b32 s97, s64, s65
  s_lshl_b32 s65, s29, 11
  s_or_b32 s98, s65, s52
  v_and_b32 v50, 7, v0
  v_lshlrev_b32 v53, 4, v50
  v_xor_b32 v50, v50, v51
  v_lshlrev_b32 v50, 4, v50
  v_lshrrev_b32 v52, 3, v0
  v_lshl_or_b32 v34, v52, 10, v50
  v_xor_b32 v35, 64, v34
  v_add_u32 v35, 7168, v35
  s_lshr_b32 s64, s2, 6
  s_and_b32 s65, s2, 63
  s_and_b32 s66, s2, 7
  s_lshr_b32 s67, s24, 1
  s_lshl_b32 s67, s67, 2
  s_and_b32 s68, s24, 1
  s_or_b32 s67, s67, s68
  s_lshl_b32 s67, s67, 8
  s_mov_b32 s87, 0x20000
  s_mov_b32 s75, 0x20000
  s_cmp_lt_u32 s65, 56
  s_cselect_b32 s74, 0x1c0000, 0
  s_cselect_b32 s68, 0, 0x70000000
  s_mov_b32 s86, s74
  s_mul_i32 s70, s64, 7
  s_lshr_b32 s71, s65, 3
  s_add_u32 s70, s70, s71
  s_lshl_b32 s88, s70, 16
  s_lshl_b32 s71, s24, 14
  s_add_u32 s88, s88, s71
  s_lshl_b32 s71, s66, 7
  s_add_u32 s88, s88, s71
  s_mul_i32 s89, s66, 229376
  s_lshl_b32 s70, s70, 13
  s_add_u32 s89, s89, s70
  s_add_u32 s67, s67, s68
  s_add_u32 s89, s89, s67
  s_add_u32 s89, s89, 0x1200000
  s_cmp_ge_u32 s65, 28
  s_cselect_b32 s84, s42, s40
  s_cselect_b32 s85, s43, s41
  s_cselect_b32 s70, 28, 0
  s_cselect_b32 s71, 1, 0
  s_sub_u32 s65, s65, s70
  s_lshl_b32 s99, s65, 7
  s_lshl_b32 s65, s65, 2
  s_add_u32 s65, s65, s24
  s_lshl_b32 s69, s64, 2
  s_add_u32 s69, s69, s24
  s_mul_i32 s69, s69, 114688
  s_add_u32 s99, s99, s69
  s_lshl_b32 s101, s65, 15
  s_lshl_b32 s70, s64, 13
  s_add_u32 s101, s101, s70
  s_lshl_b32 s70, s71, 8
  s_add_u32 s70, s70, s68
  s_add_u32 s101, s101, s70
  s_add_u32 s101, s101, 0x1400000
  s_mul_i32 s64, s64, 112
  s_add_u32 s64, s64, s65
  s_lshl_b32 s64, s64, 1
  s_add_u32 s64, s64, s71
  s_lshl_b32 s64, s64, 6
  s_add_u32 s64, s64, s68
  s_add_u32 s77, s64, 0x20000
  v_mul_u32_u24 v36, 3584, v52
  v_add_u32 v36, v36, v53
  v_lshl_or_b32 v37, v52, 10, v53
  s_load_dword s32, s[8:9], 0
  s_lshl_b32 s64, s28, 2
  s_add_u32 s64, s64, s24
  s_lshl_b32 s64, s64, 4
  s_add_u32 s49, s64, s27
  s_lshl_b32 s64, s49, 9
  s_add_u32 s64, s64, 0x600000
  s_and_b32 s50, s64, 0xfffff800
  s_lshl_b32 s65, s49, 6
  s_add_u32 s65, s65, 0x680000
  v_mov_b32 v96, -1
  v_mov_b32 v97, -1
  v_mov_b32 v98, -1
  v_mov_b32 v99, -1
  v_lshlrev_b32 v100, 11, v1
  v_or_b32 v100, v100, v1
  v_and_b32 v100, 0x1001f0, v100
  buffer_store_dwordx4 v[96:99], v100, s[8:11], s64 offen sc1
  v_lshlrev_b32 v101, 16, v0
  v_lshl_or_b32 v101, v0, 2, v101
  v_and_b32 v101, 0x10003c, v101
  buffer_store_dword v96, v101, s[8:11], s65 offen sc1
  s_getreg_b32 s59, hwreg(HW_REG_XCC_ID)
  s_and_b32 s59, s59, 15
  s_or_b32 s59, s59, 0x80
  v_add_u32 v2, 0x10000, v1
  v_cmp_eq_u32 vcc, 0, v0
  v_mov_b32 v26, 0x7ffffff0
  s_nop 0
  v_cndmask_b32 v5, v26, v0, vcc
  s_mov_b32 s33, 20000
  v_and_b32 v50, 15, v0
  v_lshrrev_b32 v51, 4, v0
  v_and_b32 v52, 31, v0
  v_lshrrev_b32 v53, 5, v0
  v_lshlrev_b32 v3, 2, v50
  v_bfe_u32 v54, v0, 2, 1
  v_and_b32 v55, 3, v0
  v_lshlrev_b32 v55, 2, v55
  v_lshl_or_b32 v4, v54, 7, v55
  v_lshlrev_b32 v54, 4, v50
  v_lshl_or_b32 v7, v51, 9, v54
  s_lshl_b32 s64, s24, 9
  s_add_u32 s64, s64, 0x20000
  s_movk_i32 s65, 12672
  v_mul_lo_u32 v54, v53, s65
  v_lshl_add_u32 v54, v52, 4, v54
  v_add_u32 v8, s64, v54
  s_movk_i32 s65, 2112
  v_bfe_u32 v54, v0, 1, 1
  v_mul_lo_u32 v54, v54, s65
  v_and_b32 v55, 1, v0
  v_lshl_add_u32 v54, v55, 3, v54
  v_lshrrev_b32 v55, 2, v50
  v_lshl_add_u32 v55, v51, 3, v55
  v_lshl_add_u32 v54, v55, 4, v54
  s_lshr_b32 s66, s24, 1
  s_mul_i32 s66, s66, 12672
  s_add_u32 s66, s66, 0x20000
  s_and_b32 s67, s24, 1
  s_mul_i32 s67, s67, 4224
  s_add_u32 s67, s67, s66
  s_add_u32 s66, s66, 8448
  v_add_u32 v9, s67, v54
  v_add_u32 v10, s66, v54
  v_lshlrev_b32 v54, 4, v50
  v_lshl_or_b32 v54, v53, 8, v54
  v_and_b32 v55, 1, v51
  v_lshl_or_b32 v54, v55, 3, v54
  s_lshl_b32 s64, s24, 9
  s_add_u32 s64, s64, 0x26400
  v_add_u32 v11, s64, v54
  s_lshl_b32 s64, s24, 5
  s_add_u32 s64, s64, 0x26c00
  v_and_b32 v54, 3, v0
  v_lshl_or_b32 v54, v54, 1, v55
  v_lshl_or_b32 v54, v54, 1, v53
  v_lshl_add_u32 v12, v54, 1, s64
  v_and_b32 v54, 3, v0
  v_bfe_u32 v55, v0, 2, 1
  v_lshl_or_b32 v54, v55, 3, v54
  v_bfe_u32 v55, v0, 3, 1
  v_lshl_or_b32 v54, v55, 2, v54
  v_lshlrev_b32 v54, 4, v54
  v_lshl_or_b32 v54, v53, 10, v54
  v_add_u32 v54, 0x26400, v54
  v_lshlrev_b32 v55, 6, v53
  v_add_u32 v55, 0x26c00, v55
  v_bfe_u32 v56, v0, 4, 1
  v_cmp_eq_u32 vcc, v56, v53
  v_mov_b32 v57, 0x26d00
  s_nop 0
  v_cndmask_b32 v13, v57, v54, vcc
  v_cndmask_b32 v14, v57, v55, vcc
  v_lshlrev_b32 v54, 4, v50
  v_lshl_or_b32 v54, v53, 8, v54
  v_lshl_or_b32 v54, v56, 13, v54
  s_lshl_b32 s64, s24, 11
  v_add_u32 v15, s64, v54
  v_lshlrev_b32 v54, 10, v50
  v_lshl_or_b32 v16, v51, 4, v54
  v_lshlrev_b32 v54, 4, v50
  v_lshl_or_b32 v54, v53, 2, v54
  v_cmp_eq_u32 vcc, 0, v56
  v_mov_b32 v55, 0x7ffffff0
  s_nop 0
  v_cndmask_b32 v17, v55, v54, vcc
  s_lshl_b32 s64, s24, 7
  s_add_u32 s64, s64, 0x27100
  v_lshlrev_b32 v54, 2, v52
  v_add_u32 v18, s64, v54
  v_mov_b32 v56, 0
  v_mov_b32 v57, 0
  v_mov_b32 v58, 0
  v_mov_b32 v59, 0
  v_add_u32 v54, 0x26d00, v1
  ds_write_b128 v54, v[56:59]
  s_mov_b32 s53, 0x3f80
  s_mov_b32 s54, 0x3f800000
  s_mov_b32 s55, 0x3f803f80
  s_mov_b32 s56, 0x3fb8aa3b
  s_lshl_b32 s66, s27, 2
  s_add_u32 s65, s66, s24
  s_lshl_b32 s64, s65, 15
  s_add_u32 s38, s64, 0x200000
  s_lshl_b32 s64, s65, 11
  s_add_u32 s41, s64, 0x40000
  s_mul_i32 s64, s28, 229376
  s_add_u32 s64, s64, s52
  s_add_u32 s35, s64, 0x1400000
  s_lshr_b32 s67, s26, 3
  s_lshl_b32 s64, s24, 2
  s_or_b32 s64, s64, s67
  s_lshl_b32 s64, s64, 8
  s_or_b32 s64, s64, s30
  s_lshl_b32 s36, s64, 7
  s_lshl_b32 s67, s29, 12
  s_or_b32 s57, s67, s52
  s_mul_i32 s64, s30, 229376
  s_mul_i32 s67, s24, 57344
  s_add_u32 s64, s64, s67
  s_add_u32 s37, s64, 0x1200000
  s_lshl_b32 s67, s29, 1
  s_add_u32 s66, s66, s67
  s_lshr_b32 s67, s24, 1
  s_add_u32 s67, s67, s66
  s_and_b32 s68, s24, 1
  s_lshl_b32 s64, s66, 15
  s_add_u32 s64, s64, s52
  s_add_u32 s39, s64, 0x200000
  s_lshl_b32 s64, s67, 15
  s_lshl_b32 s69, s30, 12
  s_add_u32 s64, s64, s69
  s_lshl_b32 s69, s68, 8
  s_add_u32 s64, s64, s69
  s_add_u32 s40, s64, 0x200000
  s_lshl_b32 s64, s67, 11
  s_lshl_b32 s69, s68, 8
  s_add_u32 s64, s64, s69
  s_mul_i32 s69, s30, 0x108
  s_and_b32 s69, s69, 0x608
  s_add_u32 s64, s64, s69
  s_add_u32 s42, s64, 0x40000
  s_mul_i32 s64, s65, 114688
  s_mul_i32 s69, s28, 7168
  s_add_u32 s64, s64, s69
  s_add_u32 s43, s64, 0x800000
  s_mul_i32 s64, s66, 114688
  s_mul_i32 s69, s24, 28672
  s_add_u32 s64, s64, s69
  s_add_u32 s44, s64, 0x800000
  s_lshl_b32 s64, s65, 7
  s_add_u32 s45, s64, 0x2000
  s_lshl_b32 s69, s28, 2
  s_add_u32 s64, s64, s69
  s_add_u32 s48, s64, 0x4000
  s_lshl_b32 s64, s67, 7
  s_lshl_b32 s69, s30, 3
  s_add_u32 s64, s64, s69
  s_lshl_b32 s69, s68, 2
  s_add_u32 s64, s64, s69
  s_add_u32 s46, s64, 0x2000
  s_lshl_b32 s64, s66, 7
  s_lshl_b32 s69, s24, 4
  s_add_u32 s64, s64, s69
  s_add_u32 s47, s64, 0x4000
  s_lshl_b32 s64, s27, 17
  s_lshl_b32 s69, s29, 16
  s_add_u32 s64, s64, s69
  s_lshl_b32 s69, s24, 14
  s_add_u32 s64, s64, s69
  s_lshl_b32 s69, s30, 7
  s_add_u32 s51, s64, s69
  s_lshl_b32 s64, s29, 8
  s_lshl_b32 s69, s24, 6
  s_add_u32 s64, s64, s69
  s_add_u32 s64, s64, 0x27100
  v_add_u32 v19, s64, v3
  v_and_b32 v50, 31, v0
  v_lshrrev_b32 v51, 5, v0
  v_bfe_u32 v53, v0, 2, 1
  v_bfe_u32 v54, v0, 3, 1
  v_and_b32 v52, 19, v50
  v_lshl_or_b32 v52, v53, 3, v52
  v_lshl_or_b32 v52, v54, 2, v52
  v_lshl_or_b32 v54, v53, 1, v54
  v_xor_b32 v54, v54, v51
  v_lshlrev_b32 v54, 4, v54
  v_lshl_or_b32 v54, v52, 6, v54
  v_add_u32 v38, s52, v54
  v_xor_b32 v39, 32, v38
  v_add_u32 v46, s52, v1
  v_bfe_u32 v54, v0, 1, 3
  v_xor_b32 v54, v54, v51
  v_lshlrev_b32 v54, 4, v54
  v_lshl_or_b32 v54, v50, 7, v54
  s_add_u32 s64, s52, 0x10000
  v_add_u32 v40, s64, v54
  v_xor_b32 v41, 32, v40
  v_xor_b32 v42, 64, v40
  v_xor_b32 v43, 96, v40
  v_lshlrev_b32 v54, 4, v50
  v_add_u32 v45, 0x20000, v54
  s_lshl_b32 s64, s24, 2
  v_add_u32 v44, s64, v45
  v_bfe_u32 v55, v0, 4, 1
  v_and_b32 v54, 1, v0
  v_lshlrev_b32 v54, 9, v54
  v_lshl_or_b32 v54, v51, 8, v54
  v_bfe_u32 v56, v0, 2, 2
  v_lshl_or_b32 v54, v56, 5, v54
  v_lshl_or_b32 v54, v55, 4, v54
  v_bfe_u32 v56, v0, 1, 1
  v_lshl_or_b32 v54, v56, 3, v54
  v_add_u32 v57, 0x27800, v54
  v_lshrrev_b32 v54, 3, v50
  v_and_b32 v55, 3, v50
  v_lshl_or_b32 v54, v54, 2, v55
  v_lshl_or_b32 v54, v53, 4, v54
  v_mov_b32 v58, 0x3f80
  v_lshlrev_b32 v55, 3, v51
  v_sub_u32 v55, v54, v55
  v_and_b32 v56, 1, v55
  v_lshlrev_b32 v56, 4, v56
  v_lshlrev_b32 v56, v56, v58
  v_ashrrev_i32 v55, 1, v55
  v_cmp_eq_u32 vcc, 0, v55
  s_nop 1
  v_cndmask_b32 v64, 0, v56, vcc
  v_cmp_eq_u32 vcc, 1, v55
  s_nop 1
  v_cndmask_b32 v65, 0, v56, vcc
  v_cmp_eq_u32 vcc, 2, v55
  s_nop 1
  v_cndmask_b32 v66, 0, v56, vcc
  v_cmp_eq_u32 vcc, 3, v55
  s_nop 1
  v_cndmask_b32 v67, 0, v56, vcc
  v_cmp_eq_u32 vcc, 8, v55
  s_nop 1
  v_cndmask_b32 v68, 0, v56, vcc
  v_cmp_eq_u32 vcc, 9, v55
  s_nop 1
  v_cndmask_b32 v69, 0, v56, vcc
  v_cmp_eq_u32 vcc, 10, v55
  s_nop 1
  v_cndmask_b32 v70, 0, v56, vcc
  v_cmp_eq_u32 vcc, 11, v55
  s_nop 1
  v_cndmask_b32 v71, 0, v56, vcc
  v_accvgpr_write_b32 a0, v64
  v_accvgpr_write_b32 a1, v65
  v_accvgpr_write_b32 a2, v66
  v_accvgpr_write_b32 a3, v67
  v_accvgpr_write_b32 a4, v68
  v_accvgpr_write_b32 a5, v69
  v_accvgpr_write_b32 a6, v70
  v_accvgpr_write_b32 a7, v71
  v_accvgpr_write_b32 a64, s55
  v_accvgpr_write_b32 a65, s55
  v_accvgpr_write_b32 a66, s55
  v_accvgpr_write_b32 a67, s55
  v_lshrrev_b32 v54, 4, v0
  v_bfe_u32 v55, v0, 1, 3
  v_xor_b32 v54, v54, v55
  v_lshlrev_b32 v54, 4, v54
  v_lshl_or_b32 v54, v3, 5, v54
  s_lshl_b32 s64, s24, 11
  s_lshl_b32 s65, s24, 12
  s_or_b32 s64, s64, s65
  s_and_b32 s64, s64, 0x2800
  s_lshl_b32 s65, s29, 14
  s_or_b32 s64, s64, s65
  s_or_b32 s64, s64, 0x10000
  v_or_b32 v47, s64, v54
  s_waitcnt lgkmcnt(0)
  s_mul_i32 s31, s32, 0x9E3779B1
  s_add_u32 s31, s31, 0x7F4A7C15
  s_cmp_eq_u32 s24, 0
  s_cbranch_scc1 PG1
  s_cmp_eq_u32 s24, 1
  s_cbranch_scc1 PG2
  s_cmp_eq_u32 s24, 2
  s_cbranch_scc1 PG3
  s_branch PG4
PGB:
  s_waitcnt vmcnt(6)
  s_xor_b32 m0, s96, 0x800
  s_add_u32 s61, s93, 1024
  buffer_load_dwordx4 v32, s[80:83], s61 offen lds
  buffer_load_dwordx4 v33, s[80:83], s61 offen offset:1024 lds
  ds_read_b64_tr_b16 v[60:61], v57
  ds_read_b64_tr_b16 v[62:63], v57 offset:128
  v_cmp_eq_u32 vcc, 0, v53
  s_waitcnt lgkmcnt(1)
  s_nop 0
  v_cndmask_b32 v80, 0, v60, vcc
  v_cndmask_b32 v84, v60, 0, vcc
  v_cndmask_b32 v81, 0, v61, vcc
  v_cndmask_b32 v85, v61, 0, vcc
  s_waitcnt lgkmcnt(0)
  v_cndmask_b32 v82, 0, v62, vcc
  s_xor_b32 m0, s96, 0x1000
  s_add_u32 s61, s94, 1024
  buffer_load_dwordx4 v32, s[80:83], s61 offen lds
  buffer_load_dwordx4 v33, s[80:83], s61 offen offset:1024 lds
  v_cndmask_b32 v86, v62, 0, vcc
  v_cndmask_b32 v83, 0, v63, vcc
  v_cndmask_b32 v87, v63, 0, vcc
  v_accvgpr_write_b32 a16, v80
  v_accvgpr_write_b32 a17, v81
  v_accvgpr_write_b32 a18, v82
  v_accvgpr_write_b32 a19, v83
  v_accvgpr_write_b32 a20, v84
  s_xor_b32 m0, s96, 0x1800
  s_add_u32 s61, s95, 1024
  buffer_load_dwordx4 v32, s[80:83], s61 offen lds
  buffer_load_dwordx4 v33, s[80:83], s61 offen offset:1024 lds
  v_accvgpr_write_b32 a21, v85
  v_accvgpr_write_b32 a22, v86
  v_accvgpr_write_b32 a23, v87
  s_waitcnt vmcnt(9)
  v_dot2_f32_bf16 v248, v240, s55, 0
  v_dot2_f32_bf16 v250, v240, v240, 0
  v_dot2_f32_bf16 v248, v241, s55, v248
  v_dot2_f32_bf16 v250, v241, v241, v250
  v_dot2_f32_bf16 v248, v242, s55, v248
  s_xor_b32 m0, s96, 0x8800
  s_add_u32 s61, s93, 2048
  buffer_load_dwordx4 v32, s[80:83], s61 offen lds
  buffer_load_dwordx4 v33, s[80:83], s61 offen offset:1024 lds
  v_dot2_f32_bf16 v250, v242, v242, v250
  v_dot2_f32_bf16 v248, v243, s55, v248
  v_dot2_f32_bf16 v250, v243, v243, v250
  s_waitcnt vmcnt(10)
  v_dot2_f32_bf16 v249, v244, s55, 0
  v_dot2_f32_bf16 v251, v244, v244, 0
  v_dot2_f32_bf16 v249, v245, s55, v249
  v_dot2_f32_bf16 v251, v245, v245, v251
  v_dot2_f32_bf16 v249, v246, s55, v249
  s_xor_b32 m0, s96, 0x9000
  s_add_u32 s61, s94, 2048
  buffer_load_dwordx4 v32, s[80:83], s61 offen lds
  buffer_load_dwordx4 v33, s[80:83], s61 offen offset:1024 lds
  v_dot2_f32_bf16 v251, v246, v246, v251
  v_dot2_f32_bf16 v249, v247, s55, v249
  v_dot2_f32_bf16 v251, v247, v247, v251
  s_nop 1
  v_permlane32_swap_b32 v248, v249
  v_permlane32_swap_b32 v250, v251
  v_add_f32 v248, v248, v249
  v_add_f32 v250, v250, v251
  v_and_b32 v252, 15, v0
  s_xor_b32 m0, s96, 0x9800
  s_add_u32 s61, s95, 2048
  buffer_load_dwordx4 v32, s[80:83], s61 offen lds
  buffer_load_dwordx4 v33, s[80:83], s61 offen offset:1024 lds
  v_cmp_eq_u32 vcc, 0, v252
  v_lshrrev_b32 v252, 1, v0
  v_mov_b32 v253, 0x7ffffff0
  v_permlane16_swap_b32 v248, v250
  v_cndmask_b32 v252, v253, v252, vcc
  v_add_f32 v248, v248, v250
  v_mov_b32 v249, s31
  s_lshl_b32 s64, s27, 11
  s_lshl_b32 s65, s28, 7
  s_add_u32 s64, s64, s65
  s_lshl_b32 s65, s24, 5
  s_add_u32 s64, s64, s65
  s_add_u32 s64, s64, 0x10000
  v_add_f32_dpp v248, v248, v248 quad_perm:[1,0,3,2] row_mask:0xf bank_mask:0xf
  s_nop 1
  v_add_f32_dpp v248, v248, v248 quad_perm:[2,3,0,1] row_mask:0xf bank_mask:0xf
  s_nop 1
  v_add_f32_dpp v248, v248, v248 row_half_mirror row_mask:0xf bank_mask:0xf
  s_nop 1
  v_add_f32_dpp v248, v248, v248 row_mirror row_mask:0xf bank_mask:0xf
  s_waitcnt vmcnt(12)
  buffer_store_dwordx2 v[248:249], v252, s[8:11], s64 offen sc1
  s_lshl_b32 s64, s25, 5
  s_add_u32 s64, s64, s26
  v_mov_b32 v26, s59
  buffer_store_byte v26, v5, s[20:23], s64 offen
  s_waitcnt vmcnt(8)
  ds_read_b128 a[32:35], v38 offset:0
  ds_read_b128 a[36:39], v39 offset:0
  ds_read_b128 a[40:43], v38 offset:2048
  ds_read_b128 a[44:47], v39 offset:2048
  ds_read_b128 a[48:51], v38 offset:4096
  ds_read_b128 a[52:55], v39 offset:4096
  ds_read_b128 a[56:59], v38 offset:6144
  ds_read_b128 a[60:63], v39 offset:6144
  s_waitcnt lgkmcnt(7)
  v_mfma_f32_32x32x16_bf16 v[64:79], a[32:35], a[16:19], 0
  s_xor_b32 m0, s98, 0x10000
  s_xor_b32 s61, s97, 0x0
  buffer_load_dwordx4 v34, s[12:15], s61 offen  lds
  buffer_load_dwordx4 v35, s[12:15], s61 offen offset:1024  lds
  s_branch PGS1
.p2align 12
PG1:
  s_branch PG5
PGS1:
  s_waitcnt lgkmcnt(6)
  v_mfma_f32_32x32x16_bf16 v[64:79], a[36:39], a[20:23], v[64:79]
  s_waitcnt lgkmcnt(5)
  v_mfma_f32_32x32x16_bf16 v[80:95], a[40:43], a[16:19], 0
  s_waitcnt lgkmcnt(4)
  v_mfma_f32_32x32x16_bf16 v[80:95], a[44:47], a[20:23], v[80:95]
  s_nop 7
  v_cvt_pk_bf16_f32 v64, v64, v65
  v_cvt_pk_bf16_f32 v65, v66, v67
  v_cvt_pk_bf16_f32 v66, v68, v69
  v_cvt_pk_bf16_f32 v67, v70, v71
  ds_write_b128 v46, v[64:67] offset:0
  s_waitcnt lgkmcnt(4)
  v_mfma_f32_32x32x16_bf16 v[96:111], a[48:51], a[16:19], 0
  s_xor_b32 m0, s98, 0x10800
  s_xor_b32 s61, s97, 0x4000
  buffer_load_dwordx4 v34, s[12:15], s61 offen  lds
  buffer_load_dwordx4 v35, s[12:15], s61 offen offset:1024  lds
  v_cvt_pk_bf16_f32 v72, v72, v73
  v_cvt_pk_bf16_f32 v73, v74, v75
  v_cvt_pk_bf16_f32 v74, v76, v77
  v_cvt_pk_bf16_f32 v75, v78, v79
  ds_write_b128 v46, v[72:75] offset:1024
  s_waitcnt lgkmcnt(4)
  v_mfma_f32_32x32x16_bf16 v[96:111], a[52:55], a[20:23], v[96:111]
  v_cvt_pk_bf16_f32 v80, v80, v81
  v_cvt_pk_bf16_f32 v81, v82, v83
  v_cvt_pk_bf16_f32 v82, v84, v85
  v_cvt_pk_bf16_f32 v83, v86, v87
  ds_write_b128 v46, v[80:83] offset:2048
  s_waitcnt lgkmcnt(4)
  v_mfma_f32_32x32x16_bf16 v[112:127], a[56:59], a[16:19], 0
  v_cvt_pk_bf16_f32 v88, v88, v89
  v_cvt_pk_bf16_f32 v89, v90, v91
  v_cvt_pk_bf16_f32 v90, v92, v93
  v_cvt_pk_bf16_f32 v91, v94, v95
  ds_write_b128 v46, v[88:91] offset:3072
  s_waitcnt lgkmcnt(4)
  v_mfma_f32_32x32x16_bf16 v[112:127], a[60:63], a[20:23], v[112:127]
  v_cvt_pk_bf16_f32 v96, v96, v97
  v_cvt_pk_bf16_f32 v97, v98, v99
  v_cvt_pk_bf16_f32 v98, v100, v101
  v_cvt_pk_bf16_f32 v99, v102, v103
  ds_write_b128 v46, v[96:99] offset:4096
  v_mfma_f32_32x32x16_bf16 v[48:63], a[64:67], v[64:67], 0
  s_xor_b32 m0, s98, 0x11000
  s_xor_b32 s61, s97, 0x80
  buffer_load_dwordx4 v34, s[12:15], s61 offen  lds
  buffer_load_dwordx4 v35, s[12:15], s61 offen offset:1024  lds
  v_cvt_pk_bf16_f32 v104, v104, v105
  v_cvt_pk_bf16_f32 v105, v106, v107
  v_cvt_pk_bf16_f32 v106, v108, v109
  v_cvt_pk_bf16_f32 v107, v110, v111
  ds_write_b128 v46, v[104:107] offset:5120
  v_mfma_f32_32x32x16_bf16 v[48:63], a[64:67], v[72:75], v[48:63]
  v_cvt_pk_bf16_f32 v112, v112, v113
  v_cvt_pk_bf16_f32 v113, v114, v115
  v_cvt_pk_bf16_f32 v114, v116, v117
  v_cvt_pk_bf16_f32 v115, v118, v119
  ds_write_b128 v46, v[112:115] offset:6144
  v_mfma_f32_32x32x16_bf16 v[48:63], a[64:67], v[80:83], v[48:63]
  v_cvt_pk_bf16_f32 v120, v120, v121
  v_cvt_pk_bf16_f32 v121, v122, v123
  v_cvt_pk_bf16_f32 v122, v124, v125
  v_cvt_pk_bf16_f32 v123, v126, v127
  ds_write_b128 v46, v[120:123] offset:7168
  v_mfma_f32_32x32x16_bf16 v[48:63], a[64:67], v[88:91], v[48:63]
  v_mfma_f32_32x32x16_bf16 v[48:63], a[64:67], v[96:99], v[48:63]
  s_xor_b32 m0, s98, 0x11800
  s_xor_b32 s61, s97, 0x4080
  buffer_load_dwordx4 v34, s[12:15], s61 offen  lds
  buffer_load_dwordx4 v35, s[12:15], s61 offen offset:1024  lds
  v_min_u32 v22, 11, v0
  v_lshlrev_b32 v22, 21, v22
  buffer_load_dword v21, v22, s[8:11], 0 offen offset:1024 sc1
  v_mfma_f32_32x32x16_bf16 v[48:63], a[64:67], v[104:107], v[48:63]
  v_mfma_f32_32x32x16_bf16 v[48:63], a[64:67], v[112:115], v[48:63]
  v_mfma_f32_32x32x16_bf16 v[48:63], a[64:67], v[120:123], v[48:63]
  s_nop 11
  v_cvt_pk_bf16_f32 v49, v48, v48
  v_and_b32 v50, 0xffff0000, v49
  v_sub_f32 v50, v48, v50
  v_cvt_pk_bf16_f32 v49, v48, v50
  ds_write_b32 v44, v49 offset:29696
  s_waitcnt vmcnt(11)
  ds_read_b128 a[32:35], v38 offset:32768
  ds_read_b128 a[36:39], v39 offset:32768
  ds_read_b128 a[40:43], v38 offset:34816
  ds_read_b128 a[44:47], v39 offset:34816
  ds_read_b128 a[48:51], v38 offset:36864
  ds_read_b128 a[52:55], v39 offset:36864
  ds_read_b128 a[56:59], v38 offset:38912
  ds_read_b128 a[60:63], v39 offset:38912
  s_waitcnt lgkmcnt(7)
  v_mfma_f32_32x32x16_bf16 v[64:79], a[32:35], a[0:3], 0
  s_xor_b32 m0, s98, 0x18000
  s_xor_b32 s61, s97, 0x100
  buffer_load_dwordx4 v34, s[12:15], s61 offen  lds
  buffer_load_dwordx4 v35, s[12:15], s61 offen offset:1024  lds
  s_lshl_b32 s71, s2, 2
  s_add_u32 s71, s71, s24
  s_lshl_b32 s71, s71, 2
  v_and_or_b32 v22, v0, 3, s71
  v_lshlrev_b32 v22, 7, v22
  global_load_dword v21, v22, s[6:7]
  s_waitcnt lgkmcnt(6)
  v_mfma_f32_32x32x16_bf16 v[64:79], a[36:39], a[4:7], v[64:79]
  s_waitcnt lgkmcnt(5)
  v_mfma_f32_32x32x16_bf16 v[80:95], a[40:43], a[0:3], 0
  s_waitcnt lgkmcnt(4)
  v_mfma_f32_32x32x16_bf16 v[80:95], a[44:47], a[4:7], v[80:95]
  s_nop 7
  v_cvt_pk_bf16_f32 v64, v64, v65
  v_cvt_pk_bf16_f32 v65, v66, v67
  v_cvt_pk_bf16_f32 v66, v68, v69
  v_cvt_pk_bf16_f32 v67, v70, v71
  ds_write_b128 v46, v[64:67] offset:32768
  s_waitcnt lgkmcnt(4)
  v_mfma_f32_32x32x16_bf16 v[96:111], a[48:51], a[0:3], 0
  s_xor_b32 m0, s98, 0x18800
  s_xor_b32 s61, s97, 0x4100
  buffer_load_dwordx4 v34, s[12:15], s61 offen  lds
  buffer_load_dwordx4 v35, s[12:15], s61 offen offset:1024  lds
  v_cvt_pk_bf16_f32 v72, v72, v73
  v_cvt_pk_bf16_f32 v73, v74, v75
  v_cvt_pk_bf16_f32 v74, v76, v77
  v_cvt_pk_bf16_f32 v75, v78, v79
  ds_write_b128 v46, v[72:75] offset:33792
  s_waitcnt lgkmcnt(4)
  v_mfma_f32_32x32x16_bf16 v[96:111], a[52:55], a[4:7], v[96:111]
  v_cvt_pk_bf16_f32 v80, v80, v81
  v_cvt_pk_bf16_f32 v81, v82, v83
  v_cvt_pk_bf16_f32 v82, v84, v85
  v_cvt_pk_bf16_f32 v83, v86, v87
  ds_write_b128 v46, v[80:83] offset:34816
  s_waitcnt lgkmcnt(4)
  v_mfma_f32_32x32x16_bf16 v[112:127], a[56:59], a[0:3], 0
  v_cvt_pk_bf16_f32 v88, v88, v89
  v_cvt_pk_bf16_f32 v89, v90, v91
  v_cvt_pk_bf16_f32 v90, v92, v93
  v_cvt_pk_bf16_f32 v91, v94, v95
  ds_write_b128 v46, v[88:91] offset:35840
  s_waitcnt lgkmcnt(4)
  v_mfma_f32_32x32x16_bf16 v[112:127], a[60:63], a[4:7], v[112:127]
  v_cvt_pk_bf16_f32 v96, v96, v97
  v_cvt_pk_bf16_f32 v97, v98, v99
  v_cvt_pk_bf16_f32 v98, v100, v101
  v_cvt_pk_bf16_f32 v99, v102, v103
  ds_write_b128 v46, v[96:99] offset:36864
  v_mfma_f32_32x32x16_bf16 v[48:63], a[64:67], v[64:67], 0
  s_waitcnt vmcnt(10)
  ds_read_b128 v[128:131], v40 offset:0
  ds_read_b128 v[132:135], v41 offset:0
  ds_read_b128 v[136:139], v42 offset:0
  ds_read_b128 v[140:143], v43 offset:0
  v_cvt_pk_bf16_f32 v104, v104, v105
  v_cvt_pk_bf16_f32 v105, v106, v107
  v_cvt_pk_bf16_f32 v106, v108, v109
  v_cvt_pk_bf16_f32 v107, v110, v111
  ds_write_b128 v46, v[104:107] offset:37888
  v_mfma_f32_32x32x16_bf16 v[48:63], a[64:67], v[72:75], v[48:63]
  v_cvt_pk_bf16_f32 v112, v112, v113
  v_cvt_pk_bf16_f32 v113, v114, v115
  v_cvt_pk_bf16_f32 v114, v116, v117
  v_cvt_pk_bf16_f32 v115, v118, v119
  ds_write_b128 v46, v[112:115] offset:38912
  v_mfma_f32_32x32x16_bf16 v[48:63], a[64:67], v[80:83], v[48:63]
  v_cvt_pk_bf16_f32 v120, v120, v121
  v_cvt_pk_bf16_f32 v121, v122, v123
  v_cvt_pk_bf16_f32 v122, v124, v125
  v_cvt_pk_bf16_f32 v123, v126, v127
  ds_write_b128 v46, v[120:123] offset:39936
  v_mfma_f32_32x32x16_bf16 v[48:63], a[64:67], v[88:91], v[48:63]
  v_mfma_f32_32x32x16_bf16 v[48:63], a[64:67], v[96:99], v[48:63]
  s_xor_b32 m0, s98, 0x19000
  s_xor_b32 s61, s97, 0x180
  buffer_load_dwordx4 v34, s[12:15], s61 offen  lds
  buffer_load_dwordx4 v35, s[12:15], s61 offen offset:1024  lds
  v_mfma_f32_32x32x16_bf16 v[48:63], a[64:67], v[104:107], v[48:63]
  v_mfma_f32_32x32x16_bf16 v[48:63], a[64:67], v[112:115], v[48:63]
  v_mfma_f32_32x32x16_bf16 v[48:63], a[64:67], v[120:123], v[48:63]
  s_nop 11
  v_cvt_pk_bf16_f32 v49, v48, v48
  v_and_b32 v50, 0xffff0000, v49
  v_sub_f32 v50, v48, v50
  v_cvt_pk_bf16_f32 v49, v48, v50
  ds_write_b32 v44, v49 offset:30208
  v_xor_b32 v64, 64, v47
  s_waitcnt lgkmcnt(0)
  s_barrier
  ds_read_b128 a[68:71], v47
  ds_read_b128 a[72:75], v64
  s_xor_b32 m0, s98, 0x19800
  s_xor_b32 s61, s97, 0x4180
  buffer_load_dwordx4 v34, s[12:15], s61 offen  lds
  buffer_load_dwordx4 v35, s[12:15], s61 offen offset:1024  lds
  ds_read_b128 a[192:195], v1 offset:32768
  ds_read_b128 a[196:199], v1 offset:0
  ds_read_b128 a[200:203], v1 offset:33792
  ds_read_b128 a[204:207], v1 offset:1024
  ds_read_b128 a[208:211], v1 offset:34816
  ds_read_b128 a[212:215], v1 offset:2048
  s_waitcnt lgkmcnt(5)
  v_mfma_f32_32x32x16_bf16 v[80:95], a[192:195], v[128:131], 0
  s_barrier
  s_waitcnt vmcnt(10)
  ds_read_b128 v[144:147], v40 offset:4096
  ds_read_b128 v[148:151], v41 offset:4096
  ds_read_b128 v[152:155], v42 offset:4096
  ds_read_b128 v[156:159], v43 offset:4096
  ds_read_b128 a[216:219], v1 offset:35840
  s_waitcnt lgkmcnt(9)
  v_mfma_f32_32x32x16_bf16 v[64:79], a[196:199], v[128:131], 0
  ds_read_b128 a[220:223], v1 offset:3072
  s_waitcnt lgkmcnt(9)
  v_mfma_f32_32x32x16_bf16 v[80:95], a[200:203], v[132:135], v[80:95]
  s_xor_b32 m0, s98, 0x10000
  s_xor_b32 s61, s97, 0x200
  buffer_load_dwordx4 v34, s[12:15], s61 offen  lds
  buffer_load_dwordx4 v35, s[12:15], s61 offen offset:1024  lds
  ds_read_b128 a[224:227], v46 offset:0
  ds_read_b128 a[192:195], v1 offset:36864
  s_waitcnt lgkmcnt(10)
  v_mfma_f32_32x32x16_bf16 v[64:79], a[204:207], v[132:135], v[64:79]
  ds_read_b128 a[228:231], v46 offset:1024
  ds_read_b128 a[196:199], v1 offset:4096
  s_waitcnt lgkmcnt(11)
  v_mfma_f32_32x32x16_bf16 v[80:95], a[208:211], v[136:139], v[80:95]
  ds_read_b128 a[200:203], v1 offset:37888
  s_waitcnt lgkmcnt(11)
  v_mfma_f32_32x32x16_bf16 v[64:79], a[212:215], v[136:139], v[64:79]
  s_xor_b32 m0, s98, 0x10800
  s_xor_b32 s61, s97, 0x4200
  buffer_load_dwordx4 v34, s[12:15], s61 offen  lds
  buffer_load_dwordx4 v35, s[12:15], s61 offen offset:1024  lds
  ds_read_b128 a[232:235], v46 offset:2048
  ds_read_b128 a[204:207], v1 offset:5120
  s_waitcnt lgkmcnt(8)
  v_mfma_f32_32x32x16_bf16 v[80:95], a[216:219], v[140:143], v[80:95]
  ds_read_b128 a[208:211], v1 offset:38912
  s_waitcnt lgkmcnt(8)
  v_mfma_f32_32x32x16_bf16 v[64:79], a[220:223], v[140:143], v[64:79]
  s_waitcnt vmcnt(8)
  ds_read_b128 v[160:163], v40 offset:32768
  ds_read_b128 v[164:167], v41 offset:32768
  ds_read_b128 v[168:171], v42 offset:32768
  ds_read_b128 v[172:175], v43 offset:32768
  ds_read_b128 a[236:239], v46 offset:3072
  ds_read_b128 a[212:215], v1 offset:6144
  s_waitcnt lgkmcnt(12)
  v_mfma_f32_32x32x16_bf16 v[80:95], a[192:195], v[144:147], v[80:95]
  ds_read_b128 a[216:219], v1 offset:39936
  s_waitcnt lgkmcnt(11)
  v_mfma_f32_32x32x16_bf16 v[64:79], a[196:199], v[144:147], v[64:79]
  ds_read_b128 a[240:243], v46 offset:4096
  ds_read_b128 a[220:223], v1 offset:7168
  s_waitcnt lgkmcnt(12)
  v_mfma_f32_32x32x16_bf16 v[80:95], a[200:203], v[148:151], v[80:95]
  s_xor_b32 m0, s98, 0x11000
  s_xor_b32 s61, s97, 0x280
  buffer_load_dwordx4 v34, s[12:15], s61 offen  lds
  buffer_load_dwordx4 v35, s[12:15], s61 offen offset:1024  lds
  ds_read_b128 a[192:195], v1 offset:40960
  s_waitcnt lgkmcnt(11)
  v_mfma_f32_32x32x16_bf16 v[64:79], a[204:207], v[148:151], v[64:79]
  ds_read_b128 a[244:247], v46 offset:5120
  ds_read_b128 a[196:199], v1 offset:8192
  s_waitcnt lgkmcnt(12)
  v_mfma_f32_32x32x16_bf16 v[80:95], a[208:211], v[152:155], v[80:95]
  s_xor_b32 m0, s98, 0x11800
  s_xor_b32 s61, s97, 0x4280
  buffer_load_dwordx4 v34, s[12:15], s61 offen  lds
  buffer_load_dwordx4 v35, s[12:15], s61 offen offset:1024  lds
  ds_read_b128 a[200:203], v1 offset:41984
  s_waitcnt lgkmcnt(7)
  v_mfma_f32_32x32x16_bf16 v[64:79], a[212:215], v[152:155], v[64:79]
  ds_read_b128 a[248:251], v46 offset:6144
  ds_read_b128 a[204:207], v1 offset:9216
  s_waitcnt lgkmcnt(8)
  v_mfma_f32_32x32x16_bf16 v[80:95], a[216:219], v[156:159], v[80:95]
  ds_read_b128 a[208:211], v1 offset:43008
  s_waitcnt lgkmcnt(7)
  v_mfma_f32_32x32x16_bf16 v[64:79], a[220:223], v[156:159], v[64:79]
  s_waitcnt vmcnt(8)
  ds_read_b128 v[176:179], v40 offset:36864
  ds_read_b128 v[180:183], v41 offset:36864
  ds_read_b128 v[184:187], v42 offset:36864
  ds_read_b128 v[188:191], v43 offset:36864
  ds_read_b128 a[252:255], v46 offset:7168
  ds_read_b128 a[212:215], v1 offset:10240
  s_waitcnt lgkmcnt(12)
  v_mfma_f32_32x32x16_bf16 v[80:95], a[192:195], v[160:163], v[80:95]
  ds_read_b128 a[216:219], v1 offset:44032
  s_waitcnt lgkmcnt(11)
  v_mfma_f32_32x32x16_bf16 v[64:79], a[196:199], v[160:163], v[64:79]
  s_xor_b32 m0, s98, 0x18000
  s_xor_b32 s61, s97, 0x300
  buffer_load_dwordx4 v34, s[12:15], s61 offen  lds
  buffer_load_dwordx4 v35, s[12:15], s61 offen offset:1024  lds
  ds_read_b128 a[220:223], v1 offset:11264
  s_waitcnt lgkmcnt(11)
  v_mfma_f32_32x32x16_bf16 v[80:95], a[200:203], v[164:167], v[80:95]
  ds_read_b128 a[192:195], v1 offset:45056
  s_waitcnt lgkmcnt(10)
  v_mfma_f32_32x32x16_bf16 v[64:79], a[204:207], v[164:167], v[64:79]
  ds_read_b128 a[196:199], v1 offset:12288
  s_waitcnt lgkmcnt(10)
  v_mfma_f32_32x32x16_bf16 v[80:95], a[208:211], v[168:171], v[80:95]
  s_xor_b32 m0, s98, 0x18800
  s_xor_b32 s61, s97, 0x4300
  buffer_load_dwordx4 v34, s[12:15], s61 offen  lds
  buffer_load_dwordx4 v35, s[12:15], s61 offen offset:1024  lds
  ds_read_b128 a[200:203], v1 offset:46080
  s_waitcnt lgkmcnt(5)
  v_mfma_f32_32x32x16_bf16 v[64:79], a[212:215], v[168:171], v[64:79]
  ds_read_b128 a[204:207], v1 offset:13312
  s_waitcnt lgkmcnt(5)
  v_mfma_f32_32x32x16_bf16 v[80:95], a[216:219], v[172:175], v[80:95]
  s_waitcnt vmcnt(8)
  ds_read_b128 v[192:195], v40 offset:0
  ds_read_b128 v[196:199], v41 offset:0
  ds_read_b128 v[200:203], v42 offset:0
  ds_read_b128 v[204:207], v43 offset:0
  ds_read_b128 a[208:211], v1 offset:47104
  s_waitcnt lgkmcnt(9)
  v_mfma_f32_32x32x16_bf16 v[64:79], a[220:223], v[172:175], v[64:79]
  ds_read_b128 a[212:215], v1 offset:14336
  s_waitcnt lgkmcnt(9)
  v_mfma_f32_32x32x16_bf16 v[80:95], a[192:195], v[176:179], v[80:95]
  ds_read_b128 a[216:219], v1 offset:48128
  s_waitcnt lgkmcnt(9)
  v_mfma_f32_32x32x16_bf16 v[64:79], a[196:199], v[176:179], v[64:79]
  s_xor_b32 m0, s98, 0x19000
  s_xor_b32 s61, s97, 0x380
  buffer_load_dwordx4 v34, s[12:15], s61 offen  lds
  buffer_load_dwordx4 v35, s[12:15], s61 offen offset:1024  lds
  ds_read_b128 a[220:223], v1 offset:15360
  s_waitcnt lgkmcnt(9)
  v_mfma_f32_32x32x16_bf16 v[80:95], a[200:203], v[180:183], v[80:95]
  ds_read_b128 a[192:195], v1 offset:49152
  s_waitcnt lgkmcnt(9)
  v_mfma_f32_32x32x16_bf16 v[64:79], a[204:207], v[180:183], v[64:79]
  s_xor_b32 m0, s98, 0x19800
  s_xor_b32 s61, s97, 0x4380
  buffer_load_dwordx4 v34, s[12:15], s61 offen  lds
  buffer_load_dwordx4 v35, s[12:15], s61 offen offset:1024  lds
  ds_read_b128 a[196:199], v1 offset:16384
  s_waitcnt lgkmcnt(5)
  v_mfma_f32_32x32x16_bf16 v[80:95], a[208:211], v[184:187], v[80:95]
  ds_read_b128 a[200:203], v1 offset:50176
  s_waitcnt lgkmcnt(5)
  v_mfma_f32_32x32x16_bf16 v[64:79], a[212:215], v[184:187], v[64:79]
  ds_read_b128 a[204:207], v1 offset:17408
  s_waitcnt lgkmcnt(5)
  v_mfma_f32_32x32x16_bf16 v[80:95], a[216:219], v[188:191], v[80:95]
  s_waitcnt vmcnt(8)
  ds_read_b128 v[208:211], v40 offset:4096
  ds_read_b128 v[212:215], v41 offset:4096
  ds_read_b128 v[216:219], v42 offset:4096
  ds_read_b128 v[220:223], v43 offset:4096
  ds_read_b128 a[208:211], v1 offset:51200
  s_waitcnt lgkmcnt(9)
  v_mfma_f32_32x32x16_bf16 v[64:79], a[220:223], v[188:191], v[64:79]
  ds_read_b128 a[212:215], v1 offset:18432
  s_waitcnt lgkmcnt(9)
  v_mfma_f32_32x32x16_bf16 v[80:95], a[192:195], v[192:195], v[80:95]
  s_lshl_b32 s63, s27, 11
  s_lshl_b32 s64, s24, 9
  s_add_u32 s63, s63, s64
  s_add_u32 s63, s63, 0x10000
  v_and_b32 v30, 0x1f0, v1
  buffer_load_dwordx4 v[52:55], v30, s[8:11], s63 offen sc1
  s_lshl_b32 s65, s28, 7
  s_add_u32 s65, s65, s52
  s_add_u32 s65, s65, 0x10000
  v_lshlrev_b32 v57, 9, v0
  v_lshl_or_b32 v57, v0, 5, v57
  v_and_b32 v57, 0x1860, v57
  buffer_load_dword v56, v57, s[8:11], s65 offen offset:4 sc1
  ds_read_b128 a[216:219], v1 offset:52224
  s_waitcnt lgkmcnt(9)
  v_mfma_f32_32x32x16_bf16 v[64:79], a[196:199], v[192:195], v[64:79]
  ds_read_b128 a[220:223], v1 offset:19456
  s_waitcnt lgkmcnt(9)
  v_mfma_f32_32x32x16_bf16 v[80:95], a[200:203], v[196:199], v[80:95]
  ds_read_b128 a[192:195], v1 offset:53248
  s_waitcnt lgkmcnt(9)
  v_mfma_f32_32x32x16_bf16 v[64:79], a[204:207], v[196:199], v[64:79]
  s_waitcnt lgkmcnt(5)
  s_xor_b32 m0, s96, 0x10000
  s_add_u32 s61, s92, 0
  buffer_load_dwordx4 v32, s[80:83], s61 offen lds
  buffer_load_dwordx4 v33, s[80:83], s61 offen offset:1024 lds
  ds_read_b128 a[196:199], v1 offset:20480
  s_waitcnt lgkmcnt(5)
  v_mfma_f32_32x32x16_bf16 v[80:95], a[208:211], v[200:203], v[80:95]
  ds_read_b128 a[200:203], v1 offset:54272
  s_waitcnt lgkmcnt(5)
  v_mfma_f32_32x32x16_bf16 v[64:79], a[212:215], v[200:203], v[64:79]
  s_waitcnt vmcnt(8)
  ds_read_b128 v[224:227], v40 offset:32768
  ds_read_b128 v[228:231], v41 offset:32768
  ds_read_b128 v[232:235], v42 offset:32768
  ds_read_b128 v[236:239], v43 offset:32768
  ds_read_b128 a[204:207], v1 offset:21504
  s_waitcnt lgkmcnt(9)
  v_mfma_f32_32x32x16_bf16 v[80:95], a[216:219], v[204:207], v[80:95]
  ds_read_b128 a[208:211], v1 offset:55296
  s_waitcnt lgkmcnt(9)
  v_mfma_f32_32x32x16_bf16 v[64:79], a[220:223], v[204:207], v[64:79]
  ds_read_b128 a[212:215], v1 offset:22528
  s_waitcnt lgkmcnt(9)
  v_mfma_f32_32x32x16_bf16 v[80:95], a[192:195], v[208:211], v[80:95]
  s_xor_b32 m0, s96, 0x10800
  s_add_u32 s61, s93, 0
  buffer_load_dwordx4 v32, s[80:83], s61 offen lds
  buffer_load_dwordx4 v33, s[80:83], s61 offen offset:1024 lds
  ds_read_b128 a[216:219], v1 offset:56320
  s_waitcnt lgkmcnt(9)
  v_mfma_f32_32x32x16_bf16 v[64:79], a[196:199], v[208:211], v[64:79]
  ds_read_b128 a[220:223], v1 offset:23552
  s_waitcnt lgkmcnt(9)
  v_mfma_f32_32x32x16_bf16 v[80:95], a[200:203], v[212:215], v[80:95]
  s_waitcnt vmcnt(6)
  ds_read_b128 v[240:243], v40 offset:36864
  ds_read_b128 v[244:247], v41 offset:36864
  ds_read_b128 v[248:251], v42 offset:36864
  ds_read_b128 v[252:255], v43 offset:36864
  ds_read_b128 a[192:195], v1 offset:57344
  s_waitcnt lgkmcnt(9)
  v_mfma_f32_32x32x16_bf16 v[64:79], a[204:207], v[212:215], v[64:79]
  ds_read_b128 a[196:199], v1 offset:24576
  s_waitcnt lgkmcnt(9)
  v_mfma_f32_32x32x16_bf16 v[80:95], a[208:211], v[216:219], v[80:95]
  ds_read_b128 a[200:203], v1 offset:58368
  s_waitcnt lgkmcnt(9)
  v_mfma_f32_32x32x16_bf16 v[64:79], a[212:215], v[216:219], v[64:79]
  s_xor_b32 m0, s96, 0x11000
  s_add_u32 s61, s94, 0
  buffer_load_dwordx4 v32, s[80:83], s61 offen lds
  buffer_load_dwordx4 v33, s[80:83], s61 offen offset:1024 lds
  ds_read_b128 a[204:207], v1 offset:25600
  s_waitcnt lgkmcnt(9)
  v_mfma_f32_32x32x16_bf16 v[80:95], a[216:219], v[220:223], v[80:95]
  ds_read_b128 a[208:211], v1 offset:59392
  s_waitcnt lgkmcnt(9)
  v_mfma_f32_32x32x16_bf16 v[64:79], a[220:223], v[220:223], v[64:79]
  ds_read_b128 a[212:215], v1 offset:26624
  s_waitcnt lgkmcnt(5)
  v_mfma_f32_32x32x16_bf16 v[80:95], a[192:195], v[224:227], v[80:95]
  ds_read_b128 a[216:219], v1 offset:60416
  s_waitcnt lgkmcnt(5)
  v_mfma_f32_32x32x16_bf16 v[64:79], a[196:199], v[224:227], v[64:79]
  ds_read_b128 a[220:223], v1 offset:27648
  s_waitcnt lgkmcnt(5)
  v_mfma_f32_32x32x16_bf16 v[80:95], a[200:203], v[228:231], v[80:95]
  ds_read_b128 a[192:195], v1 offset:61440
  s_waitcnt lgkmcnt(5)
  v_mfma_f32_32x32x16_bf16 v[64:79], a[204:207], v[228:231], v[64:79]
  ds_read_b128 a[196:199], v1 offset:28672
  s_waitcnt lgkmcnt(5)
  v_mfma_f32_32x32x16_bf16 v[80:95], a[208:211], v[232:235], v[80:95]
  ds_read_b128 a[200:203], v1 offset:62464
  s_waitcnt lgkmcnt(5)
  v_mfma_f32_32x32x16_bf16 v[64:79], a[212:215], v[232:235], v[64:79]
  ds_read_b128 a[204:207], v1 offset:29696
  s_waitcnt lgkmcnt(5)
  v_mfma_f32_32x32x16_bf16 v[80:95], a[216:219], v[236:239], v[80:95]
  ds_read_b128 a[28:31], v45 offset:29696
  ds_read_b128 a[32:35], v45 offset:30208
  s_mov_b32 s69, 0
S0_1:
  s_waitcnt vmcnt(7)
  v_xor_b32 v53, s31, v53
  v_xor_b32 v55, s31, v55
  s_waitcnt vmcnt(6)
  v_xor_b32 v56, s31, v56
  v_or3_b32 v53, v53, v55, v56
  v_cmp_ne_u32 vcc, 0, v53
  s_cbranch_vccz S0D_2
  buffer_load_dwordx4 v[52:55], v30, s[8:11], s63 offen sc1
  buffer_load_dword v56, v57, s[8:11], s65 offen offset:4 sc1
  s_waitcnt vmcnt(0)
  s_add_u32 s69, s69, 1
  s_cmp_lt_u32 s69, s33
  s_cbranch_scc1 S0_1
  s_mov_b32 s33, 1
S0D_2:
  ds_read_b128 a[208:211], v1 offset:63488
  s_waitcnt lgkmcnt(7)
  v_mfma_f32_32x32x16_bf16 v[64:79], a[220:223], v[236:239], v[64:79]
  v_mul_f32 v52, 0xbb000000, v52
  v_mul_f32 v54, 0x3b000000, v54
  ds_read_b128 a[212:215], v1 offset:30720
  s_waitcnt lgkmcnt(7)
  v_mfma_f32_32x32x16_bf16 v[80:95], a[192:195], v[240:243], v[80:95]
  v_cvt_pk_bf16_f32 v53, v52, v52
  v_fma_f32 v54, -v52, v52, v54
  ds_read_b128 a[216:219], v1 offset:64512
  s_waitcnt lgkmcnt(7)
  v_mfma_f32_32x32x16_bf16 v[64:79], a[196:199], v[240:243], v[64:79]
  v_and_b32 v55, 0xffff0000, v53
  v_max_f32 v54, 0, v54
  ds_read_b128 a[220:223], v1 offset:31744
  s_waitcnt lgkmcnt(7)
  v_mfma_f32_32x32x16_bf16 v[80:95], a[200:203], v[244:247], v[80:95]
  v_sub_f32 v55, v52, v55
  v_add_f32 v54, 0x3727c5ac, v54
  s_waitcnt lgkmcnt(6)
  v_mfma_f32_32x32x16_bf16 v[64:79], a[204:207], v[244:247], v[64:79]
  v_cvt_pk_bf16_f32 v55, v55, v55
  v_rsq_f32 v24, v54
  s_waitcnt lgkmcnt(3)
  v_mfma_f32_32x32x16_bf16 v[80:95], a[208:211], v[248:251], v[80:95]
  v_cmp_gt_u32 vcc, 32, v0
  s_nop 1
  v_cndmask_b32 v53, v55, v53, vcc
  v_mul_f32 v25, s56, v24
  s_waitcnt lgkmcnt(2)
  v_mfma_f32_32x32x16_bf16 v[64:79], a[212:215], v[248:251], v[64:79]
  v_accvgpr_write_b32 a24, v53
  v_accvgpr_write_b32 a25, v53
  s_waitcnt lgkmcnt(1)
  v_mfma_f32_32x32x16_bf16 v[80:95], a[216:219], v[252:255], v[80:95]
  v_accvgpr_write_b32 a26, v53
  v_accvgpr_write_b32 a27, v53
  s_waitcnt lgkmcnt(0)
  v_mfma_f32_32x32x16_bf16 v[64:79], a[220:223], v[252:255], v[64:79]
  v_mfma_f32_32x32x16_bf16 v[80:95], a[32:35], a[24:27], v[80:95]
  v_mfma_f32_32x32x16_bf16 v[64:79], a[28:31], a[24:27], v[64:79]
  s_nop 10
  v_pk_mul_f32 v[80:81], v[80:81], v[24:25] op_sel_hi:[1,0]
  v_pk_mul_f32 v[82:83], v[82:83], v[24:25] op_sel_hi:[1,0]
  v_pk_mul_f32 v[84:85], v[84:85], v[24:25] op_sel_hi:[1,0]
  v_pk_mul_f32 v[86:87], v[86:87], v[24:25] op_sel_hi:[1,0]
  v_pk_mul_f32 v[88:89], v[88:89], v[24:25] op_sel_hi:[1,0]
  v_pk_mul_f32 v[90:91], v[90:91], v[24:25] op_sel_hi:[1,0]
  v_pk_mul_f32 v[92:93], v[92:93], v[24:25] op_sel_hi:[1,0]
  v_pk_mul_f32 v[94:95], v[94:95], v[24:25] op_sel_hi:[1,0]
  v_cvt_pk_bf16_f32 v80, v80, v81
  v_cvt_pk_bf16_f32 v81, v82, v83
  v_cvt_pk_bf16_f32 v82, v84, v85
  s_xor_b32 m0, s96, 0x11800
  s_add_u32 s61, s95, 0
  buffer_load_dwordx4 v32, s[80:83], s61 offen lds
  buffer_load_dwordx4 v33, s[80:83], s61 offen offset:1024 lds
  v_cvt_pk_bf16_f32 v83, v86, v87
  v_cvt_pk_bf16_f32 v84, v88, v89
  v_cvt_pk_bf16_f32 v85, v90, v91
  v_cvt_pk_bf16_f32 v86, v92, v93
  v_cvt_pk_bf16_f32 v87, v94, v95
  ds_write_b128 v8, v[80:83] offset:8448
  ds_write_b128 v8, v[84:87] offset:10560
  v_max3_f32 v26, v64, v65, v66
  v_min3_f32 v28, v64, v65, v66
  v_max3_f32 v26, v26, v67, v68
  v_min3_f32 v28, v28, v67, v68
  v_max3_f32 v26, v26, v69, v70
  v_min3_f32 v28, v28, v69, v70
  v_max3_f32 v26, v26, v71, v72
  v_min3_f32 v28, v28, v71, v72
  v_max3_f32 v26, v26, v73, v74
  v_min3_f32 v28, v28, v73, v74
  v_max3_f32 v26, v26, v75, v76
  s_add_u32 m0, s52, 0x18000
  s_nop 0
  buffer_load_dwordx4 v36, s[84:87], s99 offen nt lds
  s_add_u32 s99, s99, 28672
  v_min3_f32 v28, v28, v75, v76
  v_max3_f32 v26, v26, v77, v78
  v_min3_f32 v28, v28, v77, v78
  v_max_f32 v26, v26, v79
  v_min_f32 v28, v28, v79
  v_mul_f32 v26, v26, v25
  v_mul_f32 v28, v28, v25
  v_pk_fma_f32 v[112:113], v[64:65], v[24:25], v[26:27] op_sel:[0,1,0] op_sel_hi:[1,1,0] neg_lo:[0,0,1] neg_hi:[0,0,1]
  v_pk_fma_f32 v[114:115], v[66:67], v[24:25], v[26:27] op_sel:[0,1,0] op_sel_hi:[1,1,0] neg_lo:[0,0,1] neg_hi:[0,0,1]
  v_pk_fma_f32 v[116:117], v[68:69], v[24:25], v[26:27] op_sel:[0,1,0] op_sel_hi:[1,1,0] neg_lo:[0,0,1] neg_hi:[0,0,1]
  v_pk_fma_f32 v[118:119], v[70:71], v[24:25], v[26:27] op_sel:[0,1,0] op_sel_hi:[1,1,0] neg_lo:[0,0,1] neg_hi:[0,0,1]
  v_pk_fma_f32 v[120:121], v[72:73], v[24:25], v[26:27] op_sel:[0,1,0] op_sel_hi:[1,1,0] neg_lo:[0,0,1] neg_hi:[0,0,1]
  v_pk_fma_f32 v[122:123], v[74:75], v[24:25], v[26:27] op_sel:[0,1,0] op_sel_hi:[1,1,0] neg_lo:[0,0,1] neg_hi:[0,0,1]
  v_pk_fma_f32 v[124:125], v[76:77], v[24:25], v[26:27] op_sel:[0,1,0] op_sel_hi:[1,1,0] neg_lo:[0,0,1] neg_hi:[0,0,1]
  v_pk_fma_f32 v[126:127], v[78:79], v[24:25], v[26:27] op_sel:[0,1,0] op_sel_hi:[1,1,0] neg_lo:[0,0,1] neg_hi:[0,0,1]
  v_exp_f32 v112, v112
  s_branch PGS2
.p2align 12
PG2:
  s_branch PG6
PGS2:
  v_exp_f32 v113, v113
  v_exp_f32 v114, v114
  s_add_u32 m0, s52, 0x18400
  s_nop 0
  buffer_load_dwordx4 v36, s[84:87], s99 offen nt lds
  s_add_u32 s99, s99, 28672
  v_exp_f32 v115, v115
  v_exp_f32 v116, v116
  v_exp_f32 v117, v117
  v_exp_f32 v118, v118
  v_exp_f32 v119, v119
  v_exp_f32 v120, v120
  v_exp_f32 v121, v121
  v_exp_f32 v122, v122
  v_exp_f32 v123, v123
  v_exp_f32 v124, v124
  v_exp_f32 v125, v125
  v_exp_f32 v126, v126
  v_exp_f32 v127, v127
  v_pk_add_f32 v[30:31], v[112:113], v[114:115]
  v_pk_add_f32 v[30:31], v[30:31], v[116:117]
  v_pk_add_f32 v[30:31], v[30:31], v[118:119]
  v_pk_add_f32 v[30:31], v[30:31], v[120:121]
  v_pk_add_f32 v[30:31], v[30:31], v[122:123]
  s_add_u32 m0, s52, 0x18800
  s_nop 0
  buffer_load_dwordx4 v36, s[84:87], s99 offen nt lds
  s_add_u32 s99, s99, 28672
  v_pk_add_f32 v[30:31], v[30:31], v[124:125]
  v_pk_add_f32 v[30:31], v[30:31], v[126:127]
  v_add_f32 v30, v30, v31
  v_rcp_f32 v30, v30
  s_nop 0
  v_pk_mul_f32 v[112:113], v[112:113], v[30:31] op_sel_hi:[1,0]
  v_pk_mul_f32 v[114:115], v[114:115], v[30:31] op_sel_hi:[1,0]
  v_pk_mul_f32 v[116:117], v[116:117], v[30:31] op_sel_hi:[1,0]
  v_pk_mul_f32 v[118:119], v[118:119], v[30:31] op_sel_hi:[1,0]
  v_pk_mul_f32 v[120:121], v[120:121], v[30:31] op_sel_hi:[1,0]
  v_pk_mul_f32 v[122:123], v[122:123], v[30:31] op_sel_hi:[1,0]
  v_pk_mul_f32 v[124:125], v[124:125], v[30:31] op_sel_hi:[1,0]
  v_pk_mul_f32 v[126:127], v[126:127], v[30:31] op_sel_hi:[1,0]
  v_cvt_pk_bf16_f32 v48, v112, v113
  v_cvt_pk_bf16_f32 v49, v114, v115
  v_cvt_pk_bf16_f32 v50, v116, v117
  v_cvt_pk_bf16_f32 v51, v118, v119
  ds_write_b128 v8, v[48:51] offset:0
  v_cvt_pk_bf16_f32 v52, v120, v121
  s_add_u32 m0, s52, 0x18c00
  s_nop 0
  buffer_load_dwordx4 v36, s[84:87], s99 offen nt lds
  v_cvt_pk_bf16_f32 v53, v122, v123
  v_cvt_pk_bf16_f32 v54, v124, v125
  v_cvt_pk_bf16_f32 v55, v126, v127
  ds_write_b128 v8, v[52:55] offset:2112
  v_pk_fma_f32 v[64:65], v[64:65], v[24:25], v[28:29] op_sel:[0,1,0] op_sel_hi:[1,1,0] neg_lo:[1,0,0] neg_hi:[1,0,0]
  v_pk_fma_f32 v[66:67], v[66:67], v[24:25], v[28:29] op_sel:[0,1,0] op_sel_hi:[1,1,0] neg_lo:[1,0,0] neg_hi:[1,0,0]
  v_pk_fma_f32 v[68:69], v[68:69], v[24:25], v[28:29] op_sel:[0,1,0] op_sel_hi:[1,1,0] neg_lo:[1,0,0] neg_hi:[1,0,0]
  v_pk_fma_f32 v[70:71], v[70:71], v[24:25], v[28:29] op_sel:[0,1,0] op_sel_hi:[1,1,0] neg_lo:[1,0,0] neg_hi:[1,0,0]
  v_pk_fma_f32 v[72:73], v[72:73], v[24:25], v[28:29] op_sel:[0,1,0] op_sel_hi:[1,1,0] neg_lo:[1,0,0] neg_hi:[1,0,0]
  v_pk_fma_f32 v[74:75], v[74:75], v[24:25], v[28:29] op_sel:[0,1,0] op_sel_hi:[1,1,0] neg_lo:[1,0,0] neg_hi:[1,0,0]
  v_pk_fma_f32 v[76:77], v[76:77], v[24:25], v[28:29] op_sel:[0,1,0] op_sel_hi:[1,1,0] neg_lo:[1,0,0] neg_hi:[1,0,0]
  v_pk_fma_f32 v[78:79], v[78:79], v[24:25], v[28:29] op_sel:[0,1,0] op_sel_hi:[1,1,0] neg_lo:[1,0,0] neg_hi:[1,0,0]
  v_exp_f32 v64, v64
  v_exp_f32 v65, v65
  v_exp_f32 v66, v66
  v_exp_f32 v67, v67
  v_exp_f32 v68, v68
  v_exp_f32 v69, v69
  s_add_u32 m0, s52, 0x19000
  s_nop 0
  buffer_load_dwordx4 v37, s[72:75], s88 offen nt lds
  s_add_u32 s88, s88, 8192
  v_exp_f32 v70, v70
  v_exp_f32 v71, v71
  v_exp_f32 v72, v72
  v_exp_f32 v73, v73
  v_exp_f32 v74, v74
  v_exp_f32 v75, v75
  v_exp_f32 v76, v76
  v_exp_f32 v77, v77
  v_exp_f32 v78, v78
  v_exp_f32 v79, v79
  v_pk_add_f32 v[30:31], v[64:65], v[66:67]
  v_pk_add_f32 v[30:31], v[30:31], v[68:69]
  v_pk_add_f32 v[30:31], v[30:31], v[70:71]
  v_pk_add_f32 v[30:31], v[30:31], v[72:73]
  v_pk_add_f32 v[30:31], v[30:31], v[74:75]
  v_pk_add_f32 v[30:31], v[30:31], v[76:77]
  v_pk_add_f32 v[30:31], v[30:31], v[78:79]
  v_add_f32 v30, v30, v31
  s_add_u32 m0, s52, 0x19400
  s_nop 0
  buffer_load_dwordx4 v37, s[72:75], s88 offen nt lds
  v_rcp_f32 v30, v30
  s_nop 0
  v_pk_mul_f32 v[64:65], v[64:65], v[30:31] op_sel_hi:[1,0]
  v_pk_mul_f32 v[66:67], v[66:67], v[30:31] op_sel_hi:[1,0]
  v_pk_mul_f32 v[68:69], v[68:69], v[30:31] op_sel_hi:[1,0]
  v_pk_mul_f32 v[70:71], v[70:71], v[30:31] op_sel_hi:[1,0]
  v_pk_mul_f32 v[72:73], v[72:73], v[30:31] op_sel_hi:[1,0]
  v_pk_mul_f32 v[74:75], v[74:75], v[30:31] op_sel_hi:[1,0]
  v_pk_mul_f32 v[76:77], v[76:77], v[30:31] op_sel_hi:[1,0]
  v_pk_mul_f32 v[78:79], v[78:79], v[30:31] op_sel_hi:[1,0]
  v_cvt_pk_bf16_f32 v56, v64, v65
  v_cvt_pk_bf16_f32 v57, v66, v67
  v_cvt_pk_bf16_f32 v58, v68, v69
  v_cvt_pk_bf16_f32 v59, v70, v71
  ds_write_b128 v8, v[56:59] offset:4224
  v_cvt_pk_bf16_f32 v60, v72, v73
  v_cvt_pk_bf16_f32 v61, v74, v75
  v_cvt_pk_bf16_f32 v62, v76, v77
  v_cvt_pk_bf16_f32 v63, v78, v79
  ds_write_b128 v8, v[60:63] offset:6336
  v_mov_b32 v72, s55
  v_mov_b32 v73, s55
  v_mov_b32 v74, s55
  v_mov_b32 v75, s55
  s_waitcnt lgkmcnt(0)
  s_barrier
  ds_read_b64_tr_b16 v[96:97], v9 offset:0
  ds_read_b64_tr_b16 v[98:99], v9 offset:64
  ds_read_b64_tr_b16 v[112:113], v10 offset:0
  ds_read_b64_tr_b16 v[114:115], v10 offset:64
  ds_read_b64_tr_b16 v[100:101], v9 offset:512
  ds_read_b64_tr_b16 v[102:103], v9 offset:576
  ds_read_b64_tr_b16 v[116:117], v10 offset:512
  ds_read_b64_tr_b16 v[118:119], v10 offset:576
  ds_read_b64_tr_b16 v[104:105], v9 offset:1024
  ds_read_b64_tr_b16 v[106:107], v9 offset:1088
  ds_read_b64_tr_b16 v[120:121], v10 offset:1024
  ds_read_b64_tr_b16 v[122:123], v10 offset:1088
  ds_read_b64_tr_b16 v[108:109], v9 offset:1536
  ds_read_b64_tr_b16 v[110:111], v9 offset:1600
  ds_read_b64_tr_b16 v[124:125], v10 offset:1536
  ds_read_b64_tr_b16 v[126:127], v10 offset:1600
  s_waitcnt lgkmcnt(12)
  v_mfma_f32_16x16x32_bf16 v[64:67], v[96:99], v[112:115], 0
  v_mfma_f32_16x16x32_bf16 v[68:71], v[72:75], v[96:99], 0
  s_waitcnt lgkmcnt(8)
  v_mfma_f32_16x16x32_bf16 v[64:67], v[100:103], v[116:119], v[64:67]
  v_mfma_f32_16x16x32_bf16 v[68:71], v[72:75], v[100:103], v[68:71]
  s_waitcnt lgkmcnt(4)
  v_mfma_f32_16x16x32_bf16 v[64:67], v[104:107], v[120:123], v[64:67]
  v_mfma_f32_16x16x32_bf16 v[68:71], v[72:75], v[104:107], v[68:71]
  s_waitcnt lgkmcnt(0)
  v_mfma_f32_16x16x32_bf16 v[64:67], v[108:111], v[124:127], v[64:67]
  v_mfma_f32_16x16x32_bf16 v[68:71], v[72:75], v[108:111], v[68:71]
  s_sub_u32 s60, s49, s24
  s_lshl_b32 s60, s60, 9
  s_add_u32 s60, s60, 0x5d9c00
  s_lshl_b32 s63, s49, 6
  s_add_u32 s63, s63, 0x680000
  s_nop 1
  v_cvt_pk_bf16_f32 v112, v64, v65
  v_cvt_pk_bf16_f32 v113, v66, v67
  v_mov_b32 v114, v68
  buffer_store_dwordx2 v[112:113], v11, s[8:11], s60 offen sc1
  buffer_store_dword v114, v3, s[8:11], s63 offen sc1
  s_mov_b32 s84, s6
  s_mov_b32 s85, s7
  s_mov_b32 s86, 0x80000
  s_mov_b32 s87, 0x20000
  v_add_u32 v38, 0x10000, v38
  v_add_u32 v39, 0x10000, v39
  v_add_u32 v46, 0x10000, v46
  s_waitcnt vmcnt(8)
  ds_read_b128 a[32:35], v38 offset:0
  ds_read_b128 a[36:39], v39 offset:0
  ds_read_b128 a[40:43], v38 offset:2048
  ds_read_b128 a[44:47], v39 offset:2048
  ds_read_b128 a[48:51], v38 offset:4096
  ds_read_b128 a[52:55], v39 offset:4096
  ds_read_b128 a[56:59], v38 offset:6144
  ds_read_b128 a[60:63], v39 offset:6144
  s_waitcnt lgkmcnt(7)
  v_mfma_f32_32x32x16_bf16 v[64:79], a[32:35], a[16:19], 0
  v_bfe_u32 v28, v0, 2, 2
  v_lshrrev_b32 v30, 5, v0
  v_lshl_or_b32 v28, v30, 3, v28
  v_lshrrev_b32 v27, 3, v0
  v_and_b32 v29, 0x70, v1
  v_lshl_or_b32 v27, v27, 10, v29
  v_add_u32 v29, 7168, v27
  s_xor_b32 m0, s57, 0x0
  s_xor_b32 s61, s36, 0x0
  buffer_load_dwordx4 v27, s[84:87], s61 offen  lds
  buffer_load_dwordx4 v29, s[84:87], s61 offen offset:1024  lds
  s_waitcnt lgkmcnt(6)
  v_mfma_f32_32x32x16_bf16 v[64:79], a[36:39], a[20:23], v[64:79]
  v_lshlrev_b32 v40, 7, v28
  v_lshlrev_b32 v42, 2, v3
  v_lshl_or_b32 v42, v30, 9, v42
  s_waitcnt lgkmcnt(5)
  v_mfma_f32_32x32x16_bf16 v[80:95], a[40:43], a[16:19], 0
  v_and_b32 v28, 1, v0
  v_lshl_or_b32 v40, v28, 4, v40
  s_waitcnt lgkmcnt(4)
  v_mfma_f32_32x32x16_bf16 v[80:95], a[44:47], a[20:23], v[80:95]
  s_nop 2
  v_cvt_pk_bf16_f32 v64, v64, v65
  v_cvt_pk_bf16_f32 v65, v66, v67
  v_cvt_pk_bf16_f32 v66, v68, v69
  v_cvt_pk_bf16_f32 v67, v70, v71
  ds_write_b128 v46, v[64:67] offset:0
  s_waitcnt lgkmcnt(4)
  v_mfma_f32_32x32x16_bf16 v[96:111], a[48:51], a[16:19], 0
  s_xor_b32 m0, s57, 0x800
  s_xor_b32 s61, s36, 0x4000
  buffer_load_dwordx4 v27, s[84:87], s61 offen  lds
  buffer_load_dwordx4 v29, s[84:87], s61 offen offset:1024  lds
  v_cvt_pk_bf16_f32 v72, v72, v73
  v_cvt_pk_bf16_f32 v73, v74, v75
  v_cvt_pk_bf16_f32 v74, v76, v77
  v_cvt_pk_bf16_f32 v75, v78, v79
  ds_write_b128 v46, v[72:75] offset:1024
  s_waitcnt lgkmcnt(4)
  v_mfma_f32_32x32x16_bf16 v[96:111], a[52:55], a[20:23], v[96:111]
  v_cvt_pk_bf16_f32 v80, v80, v81
  v_cvt_pk_bf16_f32 v81, v82, v83
  v_cvt_pk_bf16_f32 v82, v84, v85
  v_cvt_pk_bf16_f32 v83, v86, v87
  ds_write_b128 v46, v[80:83] offset:2048
  s_waitcnt lgkmcnt(4)
  v_mfma_f32_32x32x16_bf16 v[112:127], a[56:59], a[16:19], 0
  v_cvt_pk_bf16_f32 v88, v88, v89
  v_cvt_pk_bf16_f32 v89, v90, v91
  v_cvt_pk_bf16_f32 v90, v92, v93
  v_cvt_pk_bf16_f32 v91, v94, v95
  ds_write_b128 v46, v[88:91] offset:3072
  s_waitcnt lgkmcnt(4)
  v_mfma_f32_32x32x16_bf16 v[112:127], a[60:63], a[20:23], v[112:127]
  v_cvt_pk_bf16_f32 v96, v96, v97
  v_cvt_pk_bf16_f32 v97, v98, v99
  v_cvt_pk_bf16_f32 v98, v100, v101
  v_cvt_pk_bf16_f32 v99, v102, v103
  ds_write_b128 v46, v[96:99] offset:4096
  v_mfma_f32_32x32x16_bf16 v[48:63], a[64:67], v[64:67], 0
  s_xor_b32 m0, s57, 0x1000
  s_xor_b32 s61, s36, 0x8000
  buffer_load_dwordx4 v27, s[84:87], s61 offen  lds
  buffer_load_dwordx4 v29, s[84:87], s61 offen offset:1024  lds
  v_cvt_pk_bf16_f32 v104, v104, v105
  v_cvt_pk_bf16_f32 v105, v106, v107
  v_cvt_pk_bf16_f32 v106, v108, v109
  v_cvt_pk_bf16_f32 v107, v110, v111
  ds_write_b128 v46, v[104:107] offset:5120
  v_mfma_f32_32x32x16_bf16 v[48:63], a[64:67], v[72:75], v[48:63]
  v_cvt_pk_bf16_f32 v112, v112, v113
  v_cvt_pk_bf16_f32 v113, v114, v115
  v_cvt_pk_bf16_f32 v114, v116, v117
  v_cvt_pk_bf16_f32 v115, v118, v119
  ds_write_b128 v46, v[112:115] offset:6144
  v_mfma_f32_32x32x16_bf16 v[48:63], a[64:67], v[80:83], v[48:63]
  v_cvt_pk_bf16_f32 v120, v120, v121
  v_cvt_pk_bf16_f32 v121, v122, v123
  v_cvt_pk_bf16_f32 v122, v124, v125
  v_cvt_pk_bf16_f32 v123, v126, v127
  ds_write_b128 v46, v[120:123] offset:7168
  v_mfma_f32_32x32x16_bf16 v[48:63], a[64:67], v[88:91], v[48:63]
  v_bfe_u32 v28, v0, 1, 1
  v_lshl_or_b32 v40, v28, 3, v40
  v_mfma_f32_32x32x16_bf16 v[48:63], a[64:67], v[96:99], v[48:63]
  s_lshl_b32 s63, s24, 5
  s_add_u32 s63, s63, 0x18000
  v_add_u32 v40, s63, v40
  v_bfe_u32 v28, v0, 4, 1
  s_xor_b32 m0, s57, 0x1800
  s_xor_b32 s61, s36, 0xc000
  buffer_load_dwordx4 v27, s[84:87], s61 offen  lds
  buffer_load_dwordx4 v29, s[84:87], s61 offen offset:1024  lds
  v_mfma_f32_32x32x16_bf16 v[48:63], a[64:67], v[104:107], v[48:63]
  v_lshl_or_b32 v41, v28, 13, v40
  v_mfma_f32_32x32x16_bf16 v[48:63], a[64:67], v[112:115], v[48:63]
  v_lshl_or_b32 v40, v28, 11, v40
  v_lshl_or_b32 v43, v28, 11, v42
  v_mfma_f32_32x32x16_bf16 v[48:63], a[64:67], v[120:123], v[48:63]
  v_lshl_or_b32 v42, v28, 10, v42
  s_nop 10
  v_cvt_pk_bf16_f32 v49, v48, v48
  v_and_b32 v50, 0xffff0000, v49
  v_sub_f32 v50, v48, v50
  v_cvt_pk_bf16_f32 v49, v48, v50
  ds_write_b32 v44, v49 offset:32256
  s_waitcnt lgkmcnt(0)
  s_barrier
  ds_read_b128 a[192:195], v2 offset:0
  ds_read_b128 a[196:199], v2 offset:1024
  ds_read_b128 a[200:203], v2 offset:2048
  ds_read_b128 a[204:207], v2 offset:3072
  ds_read_b128 a[208:211], v2 offset:4096
  ds_read_b128 a[212:215], v2 offset:5120
  s_waitcnt lgkmcnt(5)
  v_mfma_f32_32x32x16_bf16 v[96:111], a[192:195], v[128:131], 0
  s_waitcnt vmcnt(10)
  s_barrier
  ds_read_b64_tr_b16 v[64:65], v40 offset:0
  ds_read_b64_tr_b16 v[66:67], v40 offset:512
  ds_read_b128 a[216:219], v2 offset:6144
  s_waitcnt lgkmcnt(7)
  v_mfma_f32_32x32x16_bf16 v[96:111], a[196:199], v[132:135], v[96:111]
  ds_read_b64_tr_b16 v[68:69], v40 offset:8192
  ds_read_b64_tr_b16 v[70:71], v40 offset:8704
  ds_read_b64_tr_b16 v[72:73], v40 offset:16384
  ds_read_b64_tr_b16 v[74:75], v40 offset:16896
  ds_read_b128 a[220:223], v2 offset:7168
  s_waitcnt lgkmcnt(11)
  v_mfma_f32_32x32x16_bf16 v[96:111], a[200:203], v[136:139], v[96:111]
  ds_read_b64_tr_b16 v[76:77], v40 offset:24576
  ds_read_b64_tr_b16 v[78:79], v40 offset:25088
  ds_read_b128 a[192:195], v2 offset:8192
  s_waitcnt lgkmcnt(13)
  v_mfma_f32_32x32x16_bf16 v[96:111], a[204:207], v[140:143], v[96:111]
  ds_read_b64_tr_b16 v[80:81], v41 offset:4096
  ds_read_b64_tr_b16 v[82:83], v41 offset:4608
  ds_read_b64_tr_b16 v[84:85], v41 offset:20480
  ds_read_b64_tr_b16 v[86:87], v41 offset:20992
  ds_read_b128 a[196:199], v2 offset:9216
  s_waitcnt lgkmcnt(15)
  v_mfma_f32_32x32x16_bf16 v[96:111], a[208:211], v[144:147], v[96:111]
  s_waitcnt lgkmcnt(1)
  s_barrier
  ds_read_b128 a[200:203], v2 offset:10240
  v_mfma_f32_32x32x16_bf16 v[96:111], a[212:215], v[148:151], v[96:111]
  v_mfma_f32_16x16x32_bf16 v[88:91], a[64:67], v[64:67], 0
  buffer_store_dwordx4 v[64:67], v42, s[8:11], s101 offen sc1
  ds_read_b128 a[204:207], v2 offset:11264
  v_mfma_f32_32x32x16_bf16 v[96:111], a[216:219], v[152:155], v[96:111]
  v_mfma_f32_16x16x32_bf16 v[88:91], a[64:67], v[68:71], v[88:91]
  buffer_store_dwordx4 v[68:71], v42, s[8:11], s101 offen offset:2048 sc1
  s_add_u32 s101, s101, 4096
  v_bfe_u32 v126, v0, 2, 2
  ds_read_b128 a[208:211], v2 offset:12288
  v_mfma_f32_32x32x16_bf16 v[96:111], a[220:223], v[156:159], v[96:111]
  v_mfma_f32_16x16x32_bf16 v[88:91], a[64:67], v[72:75], v[88:91]
  buffer_store_dwordx4 v[72:75], v42, s[8:11], s101 offen sc1
  v_lshrrev_b32 v125, 5, v0
  ds_read_b128 a[212:215], v2 offset:13312
  v_mfma_f32_32x32x16_bf16 v[96:111], a[192:195], v[160:163], v[96:111]
  v_mfma_f32_16x16x32_bf16 v[88:91], a[64:67], v[76:79], v[88:91]
  buffer_store_dwordx4 v[76:79], v42, s[8:11], s101 offen offset:2048 sc1
  v_lshl_or_b32 v126, v125, 3, v126
  ds_read_b128 a[216:219], v2 offset:14336
  s_waitcnt lgkmcnt(5)
  v_mfma_f32_32x32x16_bf16 v[96:111], a[196:199], v[164:167], v[96:111]
  buffer_store_dwordx4 v[80:83], v43, s[8:11], s89 offen sc1
  s_add_u32 s89, s89, 4096
  v_bfe_u32 v125, v0, 4, 1
  ds_read_b128 a[220:223], v2 offset:15360
  s_waitcnt lgkmcnt(5)
  v_mfma_f32_32x32x16_bf16 v[96:111], a[200:203], v[168:171], v[96:111]
  buffer_store_dwordx4 v[84:87], v43, s[8:11], s89 offen sc1
  ds_read_b128 a[192:195], v2 offset:16384
  s_waitcnt lgkmcnt(5)
  v_mfma_f32_32x32x16_bf16 v[96:111], a[204:207], v[172:175], v[96:111]
  buffer_store_dword v88, v3, s[8:11], s77 offen sc1
  v_lshl_or_b32 v126, v126, 2, v125
  ds_read_b128 a[196:199], v2 offset:17408
  s_waitcnt lgkmcnt(5)
  v_mfma_f32_32x32x16_bf16 v[96:111], a[208:211], v[176:179], v[96:111]
  v_and_b32 v125, 1, v0
  ds_read_b128 a[200:203], v2 offset:18432
  s_waitcnt lgkmcnt(5)
  v_mfma_f32_32x32x16_bf16 v[96:111], a[212:215], v[180:183], v[96:111]
  v_lshl_or_b32 v126, v126, 1, v125
  s_xor_b32 m0, s57, 0x18000
  s_xor_b32 s61, s36, 0x10000
  buffer_load_dwordx4 v27, s[84:87], s61 offen  lds
  buffer_load_dwordx4 v29, s[84:87], s61 offen offset:1024  lds
  ds_read_b128 a[204:207], v2 offset:19456
  s_waitcnt lgkmcnt(5)
  v_mfma_f32_32x32x16_bf16 v[96:111], a[216:219], v[184:187], v[96:111]
  v_and_b32 v176, 1, v0
  ds_read_b128 a[208:211], v2 offset:20480
  s_waitcnt lgkmcnt(5)
  v_mfma_f32_32x32x16_bf16 v[96:111], a[220:223], v[188:191], v[96:111]
  v_bfe_u32 v125, v0, 1, 1
  v_lshlrev_b32 v176, 4, v176
  ds_read_b128 a[212:215], v2 offset:21504
  s_waitcnt lgkmcnt(5)
  v_mfma_f32_32x32x16_bf16 v[96:111], a[192:195], v[192:195], v[96:111]
  v_lshl_or_b32 v126, v126, 1, v125
  v_lshlrev_b32 v176, v176, s53
  ds_read_b128 a[216:219], v2 offset:22528
  s_waitcnt lgkmcnt(5)
  v_mfma_f32_32x32x16_bf16 v[96:111], a[196:199], v[196:199], v[96:111]
  s_and_b32 s63, s27, 1
  s_mul_i32 s63, s63, 0x18000
  s_or_b32 s63, s63, s52
  v_lshl_add_u32 v125, v126, 3, s63
  s_xor_b32 m0, s57, 0x18800
  s_xor_b32 s61, s36, 0x14000
  buffer_load_dwordx4 v27, s[84:87], s61 offen  lds
  buffer_load_dwordx4 v29, s[84:87], s61 offen offset:1024  lds
  ds_read_b128 a[220:223], v2 offset:23552
  s_waitcnt lgkmcnt(5)
  v_mfma_f32_32x32x16_bf16 v[96:111], a[200:203], v[200:203], v[96:111]
  v_bfe_u32 v177, v0, 1, 3
  ds_read_b128 a[192:195], v2 offset:24576
  s_waitcnt lgkmcnt(5)
  v_mfma_f32_32x32x16_bf16 v[96:111], a[204:207], v[204:207], v[96:111]
  v_xor_b32 v126, 0x18000, v125
  v_cmp_eq_u32 vcc, 0, v177
  s_nop 1
  v_cndmask_b32 v168, 0, v176, vcc
  ds_read_b128 a[196:199], v2 offset:25600
  s_waitcnt lgkmcnt(5)
  v_mfma_f32_32x32x16_bf16 v[96:111], a[208:211], v[208:211], v[96:111]
  v_and_b32 v122, 7, v0
  ds_read_b128 a[200:203], v2 offset:26624
  s_waitcnt lgkmcnt(5)
  v_mfma_f32_32x32x16_bf16 v[96:111], a[212:215], v[212:215], v[96:111]
  v_min_u32 v127, 2, v122
  v_cmp_eq_u32 vcc, 1, v177
  s_nop 1
  v_cndmask_b32 v169, 0, v176, vcc
  s_xor_b32 m0, s57, 0x19000
  s_xor_b32 s61, s36, 0x18000
  buffer_load_dwordx4 v27, s[84:87], s61 offen  lds
  buffer_load_dwordx4 v29, s[84:87], s61 offen offset:1024  lds
  ds_read_b128 a[204:207], v2 offset:27648
  s_waitcnt lgkmcnt(5)
  v_mfma_f32_32x32x16_bf16 v[96:111], a[216:219], v[216:219], v[96:111]
  v_cmp_eq_u32 vcc, 2, v177
  s_nop 1
  v_cndmask_b32 v170, 0, v176, vcc
  ds_read_b128 a[208:211], v2 offset:28672
  s_waitcnt lgkmcnt(5)
  v_mfma_f32_32x32x16_bf16 v[96:111], a[220:223], v[220:223], v[96:111]
  v_bfe_u32 v121, v0, 3, 1
  v_cmp_eq_u32 vcc, 3, v177
  s_nop 1
  v_cndmask_b32 v171, 0, v176, vcc
  ds_read_b128 a[212:215], v2 offset:29696
  s_waitcnt lgkmcnt(5)
  v_mfma_f32_32x32x16_bf16 v[96:111], a[192:195], v[224:227], v[96:111]
  v_mad_u32_u24 v127, v121, 28, v127
  ds_read_b128 a[216:219], v2 offset:30720
  s_waitcnt lgkmcnt(5)
  v_mfma_f32_32x32x16_bf16 v[96:111], a[196:199], v[228:231], v[96:111]
  s_mul_i32 s63, s28, 7
  s_lshr_b32 s63, s63, 2
  v_add_u32 v127, s63, v127
  v_cmp_eq_u32 vcc, 4, v177
  s_nop 1
  v_cndmask_b32 v172, 0, v176, vcc
  s_xor_b32 m0, s57, 0x19800
  s_xor_b32 s61, s36, 0x1c000
  buffer_load_dwordx4 v27, s[84:87], s61 offen  lds
  buffer_load_dwordx4 v29, s[84:87], s61 offen offset:1024  lds
  s_lshl_b32 s71, s28, 11
  s_add_u32 s71, s71, s38
  s_add_u32 s71, s71, 0x200000
  v_lshlrev_b32 v47, 5, v3
  buffer_load_dword v21, v47, s[8:11], s71 offen sc1
  s_and_b32 s71, s28, 3
  s_lshl_b32 s71, s71, 13
  s_add_u32 s71, s71, s45
  buffer_load_dword v21, v5, s[8:11], s71 offen sc1
  ds_read_b128 a[220:223], v2 offset:31744
  s_waitcnt lgkmcnt(5)
  v_mfma_f32_32x32x16_bf16 v[96:111], a[200:203], v[232:235], v[96:111]
  v_cmp_eq_u32 vcc, 5, v177
  s_nop 1
  v_cndmask_b32 v173, 0, v176, vcc
  s_waitcnt lgkmcnt(4)
  v_mfma_f32_32x32x16_bf16 v[96:111], a[204:207], v[236:239], v[96:111]
  v_accvgpr_read_b32 v32, a68
  v_accvgpr_read_b32 v33, a69
  v_accvgpr_read_b32 v34, a70
  v_lshl_add_u32 v121, v122, 3, s30
  v_cmp_lt_u32 vcc, 15, v0
  s_nop 1
  v_cndmask_b32 v127, v127, v121, vcc
  s_waitcnt lgkmcnt(3)
  v_mfma_f32_32x32x16_bf16 v[96:111], a[208:211], v[240:243], v[96:111]
  v_accvgpr_read_b32 v35, a71
  v_accvgpr_read_b32 v36, a72
  s_lshl_b32 s63, s24, 6
  v_add_u32 v127, s63, v127
  v_cmp_eq_u32 vcc, 6, v177
  s_nop 1
  v_cndmask_b32 v174, 0, v176, vcc
  s_waitcnt lgkmcnt(2)
  v_mfma_f32_32x32x16_bf16 v[96:111], a[212:215], v[244:247], v[96:111]
  v_accvgpr_read_b32 v37, a73
  v_accvgpr_read_b32 v38, a74
  v_accvgpr_read_b32 v39, a75
  v_lshlrev_b32 v127, 8, v127
  v_cmp_eq_u32 vcc, 7, v177
  s_nop 1
  v_cndmask_b32 v175, 0, v176, vcc
  s_waitcnt lgkmcnt(1)
  v_mfma_f32_32x32x16_bf16 v[96:111], a[216:219], v[248:251], v[96:111]
  v_and_b32 v22, 28, v3
  s_lshl_b32 s63, s25, 5
  buffer_load_dword v22, v22, s[20:23], s63 offen sc1
  ds_read_b128 a[28:31], v45 offset:32256
  s_waitcnt vmcnt(11)
  s_barrier
  s_lshl_b32 s63, s2, 8
  s_lshl_b32 s64, s24, 28
  s_add_u32 s63, s63, s64
  s_add_u32 s63, s63, 0x30000
  v_mov_b32 v116, s31
  v_lshlrev_b32 v117, 2, v0
  buffer_store_dword v116, v117, s[8:11], s63 offen sc1
  s_waitcnt lgkmcnt(1)
  v_mfma_f32_32x32x16_bf16 v[96:111], a[220:223], v[252:255], v[96:111]
  s_waitcnt lgkmcnt(0)
  v_mfma_f32_32x32x16_bf16 v[96:111], a[28:31], a[24:27], v[96:111]
  s_nop 11
  v_max3_f32 v26, v96, v97, v98
  v_min3_f32 v28, v96, v97, v98
  v_max3_f32 v26, v26, v99, v100
  v_min3_f32 v28, v28, v99, v100
  v_max3_f32 v26, v26, v101, v102
  v_min3_f32 v28, v28, v101, v102
  v_max3_f32 v26, v26, v103, v104
  v_min3_f32 v28, v28, v103, v104
  v_max3_f32 v26, v26, v105, v106
  v_min3_f32 v28, v28, v105, v106
  v_max3_f32 v26, v26, v107, v108
  v_min3_f32 v28, v28, v107, v108
  v_max3_f32 v26, v26, v109, v110
  v_min3_f32 v28, v28, v109, v110
  v_max_f32 v26, v26, v111
  v_min_f32 v28, v28, v111
  v_mul_f32 v26, v26, v25
  v_mul_f32 v28, v28, v25
  v_pk_fma_f32 v[64:65], v[96:97], v[24:25], v[26:27] op_sel:[0,1,0] op_sel_hi:[1,1,0] neg_lo:[0,0,1] neg_hi:[0,0,1]
  v_pk_fma_f32 v[66:67], v[98:99], v[24:25], v[26:27] op_sel:[0,1,0] op_sel_hi:[1,1,0] neg_lo:[0,0,1] neg_hi:[0,0,1]
  v_pk_fma_f32 v[68:69], v[100:101], v[24:25], v[26:27] op_sel:[0,1,0] op_sel_hi:[1,1,0] neg_lo:[0,0,1] neg_hi:[0,0,1]
  v_pk_fma_f32 v[70:71], v[102:103], v[24:25], v[26:27] op_sel:[0,1,0] op_sel_hi:[1,1,0] neg_lo:[0,0,1] neg_hi:[0,0,1]
  v_pk_fma_f32 v[72:73], v[104:105], v[24:25], v[26:27] op_sel:[0,1,0] op_sel_hi:[1,1,0] neg_lo:[0,0,1] neg_hi:[0,0,1]
  v_pk_fma_f32 v[74:75], v[106:107], v[24:25], v[26:27] op_sel:[0,1,0] op_sel_hi:[1,1,0] neg_lo:[0,0,1] neg_hi:[0,0,1]
  v_pk_fma_f32 v[76:77], v[108:109], v[24:25], v[26:27] op_sel:[0,1,0] op_sel_hi:[1,1,0] neg_lo:[0,0,1] neg_hi:[0,0,1]
  v_pk_fma_f32 v[78:79], v[110:111], v[24:25], v[26:27] op_sel:[0,1,0] op_sel_hi:[1,1,0] neg_lo:[0,0,1] neg_hi:[0,0,1]
  v_exp_f32 v64, v64
  v_exp_f32 v65, v65
  v_exp_f32 v66, v66
  v_exp_f32 v67, v67
  v_exp_f32 v68, v68
  v_exp_f32 v69, v69
  v_exp_f32 v70, v70
  v_exp_f32 v71, v71
  v_exp_f32 v72, v72
  v_exp_f32 v73, v73
  v_exp_f32 v74, v74
  v_exp_f32 v75, v75
  v_exp_f32 v76, v76
  v_exp_f32 v77, v77
  v_exp_f32 v78, v78
  v_exp_f32 v79, v79
  v_pk_add_f32 v[30:31], v[64:65], v[66:67]
  v_pk_add_f32 v[30:31], v[30:31], v[68:69]
  v_pk_add_f32 v[30:31], v[30:31], v[70:71]
  v_pk_add_f32 v[30:31], v[30:31], v[72:73]
  v_pk_add_f32 v[30:31], v[30:31], v[74:75]
  v_pk_add_f32 v[30:31], v[30:31], v[76:77]
  v_pk_add_f32 v[30:31], v[30:31], v[78:79]
  v_add_f32 v30, v30, v31
  v_rcp_f32 v30, v30
  s_xor_b32 s60, s50, 0x1800
  buffer_load_dwordx4 v[128:131], v7, s[8:11], s60 offen offset:0 sc1
  v_pk_mul_f32 v[64:65], v[64:65], v[30:31] op_sel_hi:[1,0]
  v_pk_mul_f32 v[66:67], v[66:67], v[30:31] op_sel_hi:[1,0]
  v_pk_mul_f32 v[68:69], v[68:69], v[30:31] op_sel_hi:[1,0]
  v_pk_mul_f32 v[70:71], v[70:71], v[30:31] op_sel_hi:[1,0]
  v_pk_mul_f32 v[72:73], v[72:73], v[30:31] op_sel_hi:[1,0]
  v_pk_mul_f32 v[74:75], v[74:75], v[30:31] op_sel_hi:[1,0]
  v_pk_mul_f32 v[76:77], v[76:77], v[30:31] op_sel_hi:[1,0]
  v_pk_mul_f32 v[78:79], v[78:79], v[30:31] op_sel_hi:[1,0]
  s_xor_b32 s60, s50, 0x1800
  buffer_load_dwordx4 v[132:135], v7, s[8:11], s60 offen offset:256 sc1
  v_cvt_pk_bf16_f32 v48, v64, v65
  v_cvt_pk_bf16_f32 v49, v66, v67
  v_cvt_pk_bf16_f32 v50, v68, v69
  v_cvt_pk_bf16_f32 v51, v70, v71
  v_cvt_pk_bf16_f32 v52, v72, v73
  v_cvt_pk_bf16_f32 v53, v74, v75
  v_cvt_pk_bf16_f32 v54, v76, v77
  v_cvt_pk_bf16_f32 v55, v78, v79
  s_xor_b32 s60, s50, 0x1000
  buffer_load_dwordx4 v[136:139], v7, s[8:11], s60 offen offset:0 sc1
  v_pk_fma_f32 v[80:81], v[96:97], v[24:25], v[28:29] op_sel:[0,1,0] op_sel_hi:[1,1,0] neg_lo:[1,0,0] neg_hi:[1,0,0]
  v_pk_fma_f32 v[82:83], v[98:99], v[24:25], v[28:29] op_sel:[0,1,0] op_sel_hi:[1,1,0] neg_lo:[1,0,0] neg_hi:[1,0,0]
  v_pk_fma_f32 v[84:85], v[100:101], v[24:25], v[28:29] op_sel:[0,1,0] op_sel_hi:[1,1,0] neg_lo:[1,0,0] neg_hi:[1,0,0]
  v_pk_fma_f32 v[86:87], v[102:103], v[24:25], v[28:29] op_sel:[0,1,0] op_sel_hi:[1,1,0] neg_lo:[1,0,0] neg_hi:[1,0,0]
  v_pk_fma_f32 v[88:89], v[104:105], v[24:25], v[28:29] op_sel:[0,1,0] op_sel_hi:[1,1,0] neg_lo:[1,0,0] neg_hi:[1,0,0]
  v_pk_fma_f32 v[90:91], v[106:107], v[24:25], v[28:29] op_sel:[0,1,0] op_sel_hi:[1,1,0] neg_lo:[1,0,0] neg_hi:[1,0,0]
  v_pk_fma_f32 v[92:93], v[108:109], v[24:25], v[28:29] op_sel:[0,1,0] op_sel_hi:[1,1,0] neg_lo:[1,0,0] neg_hi:[1,0,0]
  v_pk_fma_f32 v[94:95], v[110:111], v[24:25], v[28:29] op_sel:[0,1,0] op_sel_hi:[1,1,0] neg_lo:[1,0,0] neg_hi:[1,0,0]
  s_xor_b32 s60, s50, 0x1000
  buffer_load_dwordx4 v[140:143], v7, s[8:11], s60 offen offset:256 sc1
  v_exp_f32 v80, v80
  v_exp_f32 v81, v81
  v_exp_f32 v82, v82
  v_exp_f32 v83, v83
  v_exp_f32 v84, v84
  v_exp_f32 v85, v85
  v_exp_f32 v86, v86
  v_exp_f32 v87, v87
  s_xor_b32 s60, s50, 0x800
  buffer_load_dwordx4 v[144:147], v7, s[8:11], s60 offen offset:0 sc1
  v_exp_f32 v88, v88
  v_exp_f32 v89, v89
  v_exp_f32 v90, v90
  v_exp_f32 v91, v91
  v_exp_f32 v92, v92
  v_exp_f32 v93, v93
  v_exp_f32 v94, v94
  v_exp_f32 v95, v95
  s_xor_b32 s60, s50, 0x800
  buffer_load_dwordx4 v[148:151], v7, s[8:11], s60 offen offset:256 sc1
  v_pk_add_f32 v[30:31], v[80:81], v[82:83]
  v_pk_add_f32 v[30:31], v[30:31], v[84:85]
  s_branch PGS3
.p2align 12
PG3:
  s_branch PG7
PGS3:
  v_pk_add_f32 v[30:31], v[30:31], v[86:87]
  v_pk_add_f32 v[30:31], v[30:31], v[88:89]
  v_pk_add_f32 v[30:31], v[30:31], v[90:91]
  v_pk_add_f32 v[30:31], v[30:31], v[92:93]
  v_pk_add_f32 v[30:31], v[30:31], v[94:95]
  v_add_f32 v30, v30, v31
  s_xor_b32 s60, s50, 0x0
  buffer_load_dwordx4 v[152:155], v7, s[8:11], s60 offen offset:0 sc1
  v_rcp_f32 v30, v30
  s_nop 0
  v_pk_mul_f32 v[80:81], v[80:81], v[30:31] op_sel_hi:[1,0]
  v_pk_mul_f32 v[82:83], v[82:83], v[30:31] op_sel_hi:[1,0]
  v_pk_mul_f32 v[84:85], v[84:85], v[30:31] op_sel_hi:[1,0]
  v_pk_mul_f32 v[86:87], v[86:87], v[30:31] op_sel_hi:[1,0]
  v_pk_mul_f32 v[88:89], v[88:89], v[30:31] op_sel_hi:[1,0]
  v_pk_mul_f32 v[90:91], v[90:91], v[30:31] op_sel_hi:[1,0]
  v_pk_mul_f32 v[92:93], v[92:93], v[30:31] op_sel_hi:[1,0]
  s_xor_b32 s60, s50, 0x0
  buffer_load_dwordx4 v[156:159], v7, s[8:11], s60 offen offset:256 sc1
  v_pk_mul_f32 v[94:95], v[94:95], v[30:31] op_sel_hi:[1,0]
  v_cvt_pk_bf16_f32 v56, v80, v81
  v_cvt_pk_bf16_f32 v57, v82, v83
  v_cvt_pk_bf16_f32 v58, v84, v85
  v_cvt_pk_bf16_f32 v59, v86, v87
  v_cvt_pk_bf16_f32 v60, v88, v89
  v_cvt_pk_bf16_f32 v61, v90, v91
  v_cvt_pk_bf16_f32 v62, v92, v93
  s_lshr_b32 s60, s49, 4
  s_lshl_b32 s60, s60, 10
  s_add_u32 s60, s60, 0x680000
  buffer_load_dwordx4 v[160:163], v1, s[8:11], s60 offen sc1
  v_cvt_pk_bf16_f32 v63, v94, v95
  s_waitcnt vmcnt(13)
  ds_read_b64_tr_b16 v[192:193], v125 offset:0
  ds_read_b64_tr_b16 v[194:195], v125 offset:512
  ds_read_b64_tr_b16 v[196:197], v125 offset:64
  ds_read_b64_tr_b16 v[198:199], v125 offset:576
  ds_read_b64_tr_b16 v[200:201], v125 offset:2048
  ds_read_b64_tr_b16 v[202:203], v125 offset:2560
  ds_read_b64_tr_b16 v[204:205], v125 offset:2112
  ds_read_b64_tr_b16 v[206:207], v125 offset:2624
  ds_read_b64_tr_b16 v[208:209], v125 offset:4096
  ds_read_b64_tr_b16 v[210:211], v125 offset:4608
  ds_read_b64_tr_b16 v[212:213], v125 offset:4160
  ds_read_b64_tr_b16 v[214:215], v125 offset:4672
  ds_read_b64_tr_b16 v[216:217], v125 offset:6144
  ds_read_b64_tr_b16 v[218:219], v125 offset:6656
  ds_read_b64_tr_b16 v[220:221], v125 offset:6208
  ds_read_b64_tr_b16 v[222:223], v125 offset:6720
  ds_read_b64_tr_b16 v[224:225], v126 offset:0
  ds_read_b64_tr_b16 v[226:227], v126 offset:512
  ds_read_b64_tr_b16 v[228:229], v126 offset:64
  ds_read_b64_tr_b16 v[230:231], v126 offset:576
  ds_read_b64_tr_b16 v[232:233], v126 offset:2048
  ds_read_b64_tr_b16 v[234:235], v126 offset:2560
  ds_read_b64_tr_b16 v[236:237], v126 offset:2112
  ds_read_b64_tr_b16 v[238:239], v126 offset:2624
  ds_read_b64_tr_b16 v[240:241], v126 offset:4096
  ds_read_b64_tr_b16 v[242:243], v126 offset:4608
  ds_read_b64_tr_b16 v[244:245], v126 offset:4160
  ds_read_b64_tr_b16 v[246:247], v126 offset:4672
  ds_read_b64_tr_b16 v[248:249], v126 offset:6144
  ds_read_b64_tr_b16 v[250:251], v126 offset:6656
  ds_read_b64_tr_b16 v[252:253], v126 offset:6208
  ds_read_b64_tr_b16 v[254:255], v126 offset:6720
  s_mov_b32 s69, 0
KV_3:
  s_waitcnt vmcnt(8)
  v_mfma_f32_16x16x32_bf16 v[64:67], v[168:171], v[128:131], 0
  s_waitcnt vmcnt(7)
  v_mfma_f32_16x16x32_bf16 v[64:67], v[172:175], v[132:135], v[64:67]
  s_waitcnt vmcnt(6)
  v_mfma_f32_16x16x32_bf16 v[64:67], v[168:171], v[136:139], v[64:67]
  s_waitcnt vmcnt(5)
  v_mfma_f32_16x16x32_bf16 v[64:67], v[172:175], v[140:143], v[64:67]
  s_waitcnt vmcnt(4)
  v_mfma_f32_16x16x32_bf16 v[64:67], v[168:171], v[144:147], v[64:67]
  s_waitcnt vmcnt(3)
  v_mfma_f32_16x16x32_bf16 v[64:67], v[172:175], v[148:151], v[64:67]
  s_waitcnt vmcnt(2)
  v_mfma_f32_16x16x32_bf16 v[64:67], v[168:171], v[152:155], v[64:67]
  s_waitcnt vmcnt(1)
  v_mfma_f32_16x16x32_bf16 v[64:67], v[172:175], v[156:159], v[64:67]
  s_waitcnt vmcnt(0)
  v_permlane32_swap_b32 v160, v161
  v_permlane32_swap_b32 v162, v163
  v_add_f32 v68, v160, v161
  v_add_f32 v69, v162, v163
  s_nop 1
  v_permlane16_swap_b32 v68, v69
  v_add_f32 v68, v68, v69
  s_nop 1
  v_add_f32_dpp v68, v68, v68 row_ror:4 row_mask:0xf bank_mask:0xf
  s_nop 1
  v_add_f32_dpp v68, v68, v68 row_ror:8 row_mask:0xf bank_mask:0xf
  v_add_f32 v69, v68, v64
  v_cmp_u_f32 vcc, v69, v66
  s_cbranch_vccz KVD_4
  s_lshr_b32 s60, s49, 4
  s_lshl_b32 s60, s60, 10
  s_add_u32 s60, s60, 0x680000
  buffer_load_dwordx4 v[160:163], v1, s[8:11], s60 offen sc1
  v_max3_u32 v69, v128, v129, v130
  v_max_u32 v69, v69, v131
  v_cmp_eq_u32 s[76:77], -1, v69
  v_max3_u32 v69, v132, v133, v134
  v_max_u32 v69, v69, v135
  v_cmp_eq_u32 s[88:89], -1, v69
  v_max3_u32 v69, v136, v137, v138
  v_max_u32 v69, v69, v139
  v_cmp_eq_u32 s[90:91], -1, v69
  v_max3_u32 v69, v140, v141, v142
  v_max_u32 v69, v69, v143
  v_cmp_eq_u32 s[92:93], -1, v69
  v_max3_u32 v69, v144, v145, v146
  v_max_u32 v69, v69, v147
  v_cmp_eq_u32 s[94:95], -1, v69
  v_max3_u32 v69, v148, v149, v150
  v_max_u32 v69, v69, v151
  v_cmp_eq_u32 s[96:97], -1, v69
  v_max3_u32 v69, v152, v153, v154
  v_max_u32 v69, v69, v155
  v_cmp_eq_u32 s[98:99], -1, v69
  v_max3_u32 v69, v156, v157, v158
  v_max_u32 v69, v69, v159
  v_cmp_eq_u32 s[100:101], -1, v69
  s_mov_b64 exec, s[76:77]
  s_xor_b32 s60, s50, 0x1800
  buffer_load_dwordx4 v[128:131], v7, s[8:11], s60 offen offset:0 sc1
  s_mov_b64 exec, s[88:89]
  s_xor_b32 s60, s50, 0x1800
  buffer_load_dwordx4 v[132:135], v7, s[8:11], s60 offen offset:256 sc1
  s_mov_b64 exec, s[90:91]
  s_xor_b32 s60, s50, 0x1000
  buffer_load_dwordx4 v[136:139], v7, s[8:11], s60 offen offset:0 sc1
  s_mov_b64 exec, s[92:93]
  s_xor_b32 s60, s50, 0x1000
  buffer_load_dwordx4 v[140:143], v7, s[8:11], s60 offen offset:256 sc1
  s_mov_b64 exec, s[94:95]
  s_xor_b32 s60, s50, 0x800
  buffer_load_dwordx4 v[144:147], v7, s[8:11], s60 offen offset:0 sc1
  s_mov_b64 exec, s[96:97]
  s_xor_b32 s60, s50, 0x800
  buffer_load_dwordx4 v[148:151], v7, s[8:11], s60 offen offset:256 sc1
  s_mov_b64 exec, s[98:99]
  s_xor_b32 s60, s50, 0x0
  buffer_load_dwordx4 v[152:155], v7, s[8:11], s60 offen offset:0 sc1
  s_mov_b64 exec, s[100:101]
  s_xor_b32 s60, s50, 0x0
  buffer_load_dwordx4 v[156:159], v7, s[8:11], s60 offen offset:256 sc1
  s_mov_b64 exec, -1
  s_waitcnt vmcnt(0)
  s_add_u32 s69, s69, 1
  s_cmp_lt_u32 s69, s33
  s_cbranch_scc1 KV_3
  s_mov_b32 s33, 1
KVD_4:
  s_mul_i32 s63, s59, 0x01010101
  v_cmp_ne_u32 vcc, s63, v22
  s_nop 0
  s_or_b32 s58, vcc_lo, vcc_hi
  s_mov_b32 s64, 0x30000
  buffer_load_dword v112, v127, s[8:11], s64 offen sc1
  v_cvt_pk_bf16_f32 v70, v64, v65
  v_cvt_pk_bf16_f32 v71, v66, v67
  v_cvt_pk_bf16_f32 v68, v68, v68
  ds_write_b64 v11, v[70:71]
  ds_write_b16 v12, v68
  s_waitcnt lgkmcnt(0)
  s_barrier
  ds_read_b128 a[192:195], v14 offset:0
  ds_read_b128 a[196:199], v13 offset:0
  ds_read_b128 a[200:203], v14 offset:16
  ds_read_b128 a[204:207], v13 offset:256
  ds_read_b128 a[208:211], v14 offset:32
  ds_read_b128 a[212:215], v13 offset:512
  ds_read_b128 a[216:219], v14 offset:48
  ds_read_b128 a[220:223], v13 offset:768
  s_waitcnt lgkmcnt(7)
  v_mfma_f32_32x32x16_bf16 v[80:95], a[192:195], v[48:51], 0
  s_waitcnt lgkmcnt(5)
  v_mfma_f32_32x32x16_bf16 v[80:95], a[200:203], v[52:55], v[80:95]
  s_waitcnt lgkmcnt(3)
  v_mfma_f32_32x32x16_bf16 v[80:95], a[208:211], v[56:59], v[80:95]
  s_waitcnt lgkmcnt(1)
  v_mfma_f32_32x32x16_bf16 v[80:95], a[216:219], v[60:63], v[80:95]
  v_mfma_f32_32x32x16_bf16 v[64:79], a[196:199], v[48:51], 0
  v_mfma_f32_32x32x16_bf16 v[64:79], a[204:207], v[52:55], v[64:79]
  v_mfma_f32_32x32x16_bf16 v[64:79], a[212:215], v[56:59], v[64:79]
  s_waitcnt lgkmcnt(0)
  v_mfma_f32_32x32x16_bf16 v[64:79], a[220:223], v[60:63], v[64:79]
  s_nop 6
  v_add_f32 v80, 0x358637bd, v80
  v_add_f32 v88, 0x358637bd, v88
  v_rcp_f32 v80, v80
  v_rcp_f32 v88, v88
  s_lshl_b32 s63, s28, 11
  s_add_u32 s63, s63, s38
  v_pk_mul_f32 v[64:65], v[64:65], v[80:81] op_sel_hi:[1,0]
  v_pk_mul_f32 v[66:67], v[66:67], v[80:81] op_sel_hi:[1,0]
  v_pk_mul_f32 v[68:69], v[68:69], v[80:81] op_sel_hi:[1,0]
  v_pk_mul_f32 v[70:71], v[70:71], v[80:81] op_sel_hi:[1,0]
  v_cvt_pk_bf16_f32 v96, v64, v65
  v_cvt_pk_bf16_f32 v97, v66, v67
  v_cvt_pk_bf16_f32 v98, v68, v69
  v_cvt_pk_bf16_f32 v99, v70, v71
  s_add_u32 s60, s63, 0x200000
  s_cmp_lg_u32 s58, 0
  s_cbranch_scc1 ALT_0
  buffer_store_dwordx4 v[96:99], v1, s[8:11], s60 offen
ALTB_0:
  v_pk_mul_f32 v[72:73], v[72:73], v[88:89] op_sel_hi:[1,0]
  v_pk_mul_f32 v[74:75], v[74:75], v[88:89] op_sel_hi:[1,0]
  v_pk_mul_f32 v[76:77], v[76:77], v[88:89] op_sel_hi:[1,0]
  v_pk_mul_f32 v[78:79], v[78:79], v[88:89] op_sel_hi:[1,0]
  v_cvt_pk_bf16_f32 v100, v72, v73
  v_cvt_pk_bf16_f32 v101, v74, v75
  v_cvt_pk_bf16_f32 v102, v76, v77
  v_cvt_pk_bf16_f32 v103, v78, v79
  s_cmp_lg_u32 s58, 0
  s_cbranch_scc1 ALT_1
  buffer_store_dwordx4 v[100:103], v1, s[8:11], s60 offen offset:1024
ALTB_1:
  s_waitcnt vmcnt(0)
  s_add_u32 s70, s31, 1
  v_mov_b32 v31, s70
  s_cmp_lg_u32 s58, 0
  s_cbranch_scc1 ALT_2
  buffer_store_dword v31, v5, s[8:11], s48 offen
ALTB_2:
  s_mov_b32 s69, 0
FU_5:
  v_cmp_ne_u32 vcc, s31, v112
  s_cbranch_vccz FUD_6
  s_mov_b32 s64, 0x30000
  buffer_load_dword v112, v127, s[8:11], s64 offen sc1
  s_waitcnt vmcnt(0)
  s_add_u32 s69, s69, 1
  s_cmp_lt_u32 s69, s33
  s_cbranch_scc1 FU_5
  s_mov_b32 s33, 1
FUD_6:
  s_lshr_b32 s60, s26, 3
  s_xor_b32 s60, s60, s30
  s_and_b32 s60, s60, 0
  s_xor_b32 s62, s60, 0
  s_mul_i32 s62, s62, 7168
  s_add_u32 s72, s44, s62
  s_lshl1_add_u32 s80, s62, s37
  s_xor_b32 s62, s60, 1
  s_mul_i32 s62, s62, 7168
  s_add_u32 s73, s44, s62
  s_lshl1_add_u32 s81, s62, s37
  s_xor_b32 s62, s60, 2
  s_mul_i32 s62, s62, 7168
  s_add_u32 s74, s44, s62
  s_lshl1_add_u32 s82, s62, s37
  s_xor_b32 s62, s60, 3
  s_mul_i32 s62, s62, 7168
  s_add_u32 s75, s44, s62
  s_lshl1_add_u32 s83, s62, s37
  s_add_u32 m0, s52, 0x0
  s_add_u32 s61, s35, 0x0
  buffer_load_dwordx4 v1, s[8:11], s61 offen sc1 lds
  buffer_load_dwordx4 v1, s[8:11], s61 offen offset:1024 sc1 lds
  buffer_load_dwordx4 v1, s[8:11], s61 offen offset:2048 sc1 lds
  buffer_load_dwordx4 v1, s[8:11], s61 offen offset:3072 sc1 lds
  s_lshl_b32 s71, s28, 11
  s_add_u32 s71, s71, s38
  v_lshlrev_b32 v29, 5, v3
  buffer_load_dword v21, v29, s[8:11], s71 offen sc1
  s_lshl_b32 s71, s28, 7
  s_add_u32 s71, s71, s41
  buffer_load_dword v21, v5, s[8:11], s71 offen sc1
  v_add_u32 v27, 0x18000, v15
  v_and_b32 v47, 0xffff0000, v39
  v_lshlrev_b32 v46, 16, v39
  v_and_b32 v45, 0xffff0000, v38
  v_lshlrev_b32 v44, 16, v38
  v_and_b32 v43, 0xffff0000, v37
  v_lshlrev_b32 v42, 16, v37
  v_and_b32 v41, 0xffff0000, v36
  v_lshlrev_b32 v40, 16, v36
  v_and_b32 v39, 0xffff0000, v35
  v_lshlrev_b32 v38, 16, v35
  v_and_b32 v37, 0xffff0000, v34
  v_lshlrev_b32 v36, 16, v34
  v_and_b32 v35, 0xffff0000, v33
  v_lshlrev_b32 v34, 16, v33
  v_and_b32 v33, 0xffff0000, v32
  v_lshlrev_b32 v32, 16, v32
  s_mov_b32 s69, 0
POLL_7:
  buffer_load_dword v26, v4, s[8:11], s47 offen sc1
  s_waitcnt vmcnt(0)
  s_add_u32 s68, s31, 1
  v_subrev_u32 v26, s68, v26
  v_cmp_lt_u32 vcc, 15, v26
  s_cbranch_vccz PD_8
  s_add_u32 s69, s69, 1
  s_cmp_lt_u32 s69, s33
  s_cbranch_scc1 POLL_7
  s_mov_b32 s33, 1
PD_8:
  s_add_u32 s60, s39, 0x200000
  buffer_load_dwordx4 v[128:131], v1, s[8:11], s60 offen sc1
  buffer_load_dwordx4 v[132:135], v1, s[8:11], s60 offen offset:1024 sc1
  buffer_load_dwordx4 v[136:139], v1, s[8:11], s60 offen offset:2048 sc1
  buffer_load_dwordx4 v[140:143], v1, s[8:11], s60 offen offset:3072 sc1
  s_add_u32 s60, s39, 0x201000
  buffer_load_dwordx4 v[144:147], v1, s[8:11], s60 offen sc1
  buffer_load_dwordx4 v[148:151], v1, s[8:11], s60 offen offset:1024 sc1
  buffer_load_dwordx4 v[152:155], v1, s[8:11], s60 offen offset:2048 sc1
  buffer_load_dwordx4 v[156:159], v1, s[8:11], s60 offen offset:3072 sc1
  s_waitcnt vmcnt(7)
  v_mfma_f32_32x32x16_bf16 v[64:79], v[192:195], v[128:131], 0
  s_add_u32 s60, s39, 0x208000
  buffer_load_dwordx4 v[160:163], v1, s[8:11], s60 offen sc1
  v_mfma_f32_32x32x16_bf16 v[80:95], v[196:199], v[128:131], 0
  s_waitcnt vmcnt(7)
  v_mfma_f32_32x32x16_bf16 v[64:79], v[200:203], v[132:135], v[64:79]
  buffer_load_dwordx4 v[164:167], v1, s[8:11], s60 offen offset:1024 sc1
  v_mfma_f32_32x32x16_bf16 v[80:95], v[204:207], v[132:135], v[80:95]
  s_waitcnt vmcnt(7)
  v_mfma_f32_32x32x16_bf16 v[64:79], v[208:211], v[136:139], v[64:79]
  buffer_load_dwordx4 v[168:171], v1, s[8:11], s60 offen offset:2048 sc1
  v_mfma_f32_32x32x16_bf16 v[80:95], v[212:215], v[136:139], v[80:95]
  s_waitcnt vmcnt(7)
  v_mfma_f32_32x32x16_bf16 v[64:79], v[216:219], v[140:143], v[64:79]
  buffer_load_dwordx4 v[172:175], v1, s[8:11], s60 offen offset:3072 sc1
  v_mfma_f32_32x32x16_bf16 v[80:95], v[220:223], v[140:143], v[80:95]
  s_waitcnt vmcnt(7)
  v_mfma_f32_32x32x16_bf16 v[64:79], v[224:227], v[144:147], v[64:79]
  s_add_u32 s60, s39, 0x209000
  buffer_load_dwordx4 v[176:179], v1, s[8:11], s60 offen sc1
  v_mfma_f32_32x32x16_bf16 v[80:95], v[228:231], v[144:147], v[80:95]
  s_waitcnt vmcnt(7)
  v_mfma_f32_32x32x16_bf16 v[64:79], v[232:235], v[148:151], v[64:79]
  buffer_load_dwordx4 v[180:183], v1, s[8:11], s60 offen offset:1024 sc1
  v_mfma_f32_32x32x16_bf16 v[80:95], v[236:239], v[148:151], v[80:95]
  s_waitcnt vmcnt(7)
  v_mfma_f32_32x32x16_bf16 v[64:79], v[240:243], v[152:155], v[64:79]
  buffer_load_dwordx4 v[184:187], v1, s[8:11], s60 offen offset:2048 sc1
  v_mfma_f32_32x32x16_bf16 v[80:95], v[244:247], v[152:155], v[80:95]
  s_waitcnt vmcnt(7)
  v_mfma_f32_32x32x16_bf16 v[64:79], v[248:251], v[156:159], v[64:79]
  buffer_load_dwordx4 v[188:191], v1, s[8:11], s60 offen offset:3072 sc1
  v_mfma_f32_32x32x16_bf16 v[80:95], v[252:255], v[156:159], v[80:95]
  s_waitcnt vmcnt(7)
  v_mfma_f32_32x32x16_bf16 v[96:111], v[192:195], v[160:163], 0
  v_mfma_f32_32x32x16_bf16 v[112:127], v[196:199], v[160:163], 0
  s_waitcnt vmcnt(6)
  v_mfma_f32_32x32x16_bf16 v[96:111], v[200:203], v[164:167], v[96:111]
  s_add_u32 m0, s52, 0x1000
  s_add_u32 s61, s35, 0x1000
  buffer_load_dwordx4 v1, s[8:11], s61 offen sc1 lds
  v_mfma_f32_32x32x16_bf16 v[112:127], v[204:207], v[164:167], v[112:127]
  buffer_load_dwordx4 v1, s[8:11], s61 offen offset:1024 sc1 lds
  v_cvt_pk_bf16_f32 v64, v64, v65
  v_cvt_pk_bf16_f32 v65, v66, v67
  s_waitcnt vmcnt(7)
  v_mfma_f32_32x32x16_bf16 v[96:111], v[208:211], v[168:171], v[96:111]
  buffer_load_dwordx4 v1, s[8:11], s61 offen offset:2048 sc1 lds
  v_cvt_pk_bf16_f32 v66, v68, v69
  v_cvt_pk_bf16_f32 v67, v70, v71
  v_mfma_f32_32x32x16_bf16 v[112:127], v[212:215], v[168:171], v[112:127]
  buffer_load_dwordx4 v1, s[8:11], s61 offen offset:3072 sc1 lds
  ds_write_b128 v27, v[64:67] offset:0
  s_waitcnt vmcnt(8)
  v_mfma_f32_32x32x16_bf16 v[96:111], v[216:219], v[172:175], v[96:111]
  buffer_load_dwordx4 a[0:3], v1, s[8:11], s80 offen sc1
  v_cvt_pk_bf16_f32 v72, v72, v73
  v_cvt_pk_bf16_f32 v73, v74, v75
  v_mfma_f32_32x32x16_bf16 v[112:127], v[220:223], v[172:175], v[112:127]
  buffer_load_dwordx4 a[4:7], v1, s[8:11], s80 offen offset:1024 sc1
  v_cvt_pk_bf16_f32 v74, v76, v77
  v_cvt_pk_bf16_f32 v75, v78, v79
  s_waitcnt vmcnt(9)
  v_mfma_f32_32x32x16_bf16 v[96:111], v[224:227], v[176:179], v[96:111]
  ds_write_b128 v27, v[72:75] offset:512
  v_mfma_f32_32x32x16_bf16 v[112:127], v[228:231], v[176:179], v[112:127]
  buffer_load_dwordx4 a[8:11], v1, s[8:11], s80 offen offset:2048 sc1
  v_cvt_pk_bf16_f32 v80, v80, v81
  v_cvt_pk_bf16_f32 v81, v82, v83
  s_waitcnt vmcnt(9)
  v_mfma_f32_32x32x16_bf16 v[96:111], v[232:235], v[180:183], v[96:111]
  buffer_load_dwordx4 a[12:15], v1, s[8:11], s80 offen offset:3072 sc1
  v_cvt_pk_bf16_f32 v82, v84, v85
  v_cvt_pk_bf16_f32 v83, v86, v87
  v_mfma_f32_32x32x16_bf16 v[112:127], v[236:239], v[180:183], v[112:127]
  s_add_u32 s67, s80, 0x1000
  buffer_load_dwordx4 a[16:19], v1, s[8:11], s67 offen sc1
  ds_write_b128 v27, v[80:83] offset:1024
  s_waitcnt vmcnt(10)
  v_mfma_f32_32x32x16_bf16 v[96:111], v[240:243], v[184:187], v[96:111]
  buffer_load_dwordx4 a[20:23], v1, s[8:11], s67 offen offset:1024 sc1
  v_cvt_pk_bf16_f32 v88, v88, v89
  v_cvt_pk_bf16_f32 v89, v90, v91
  v_mfma_f32_32x32x16_bf16 v[112:127], v[244:247], v[184:187], v[112:127]
  buffer_load_dwordx4 a[24:27], v1, s[8:11], s67 offen offset:2048 sc1
  v_cvt_pk_bf16_f32 v90, v92, v93
  v_cvt_pk_bf16_f32 v91, v94, v95
  s_waitcnt vmcnt(11)
  v_mfma_f32_32x32x16_bf16 v[96:111], v[248:251], v[188:191], v[96:111]
  buffer_load_dwordx4 a[28:31], v1, s[8:11], s67 offen offset:3072 sc1
  ds_write_b128 v27, v[88:91] offset:1536
  v_mfma_f32_32x32x16_bf16 v[112:127], v[252:255], v[188:191], v[112:127]
  s_nop 8
  v_cvt_pk_bf16_f32 v96, v96, v97
  v_cvt_pk_bf16_f32 v97, v98, v99
  v_cvt_pk_bf16_f32 v98, v100, v101
  v_cvt_pk_bf16_f32 v99, v102, v103
  ds_write_b128 v27, v[96:99] offset:16384
  v_cvt_pk_bf16_f32 v104, v104, v105
  v_cvt_pk_bf16_f32 v105, v106, v107
  v_cvt_pk_bf16_f32 v106, v108, v109
  v_cvt_pk_bf16_f32 v107, v110, v111
  ds_write_b128 v27, v[104:107] offset:16896
  v_cvt_pk_bf16_f32 v112, v112, v113
  v_cvt_pk_bf16_f32 v113, v114, v115
  v_cvt_pk_bf16_f32 v114, v116, v117
  v_cvt_pk_bf16_f32 v115, v118, v119
  ds_write_b128 v27, v[112:115] offset:17408
  v_cvt_pk_bf16_f32 v120, v120, v121
  v_cvt_pk_bf16_f32 v121, v122, v123
  v_cvt_pk_bf16_f32 v122, v124, v125
  v_cvt_pk_bf16_f32 v123, v126, v127
  ds_write_b128 v27, v[120:123] offset:17920
  s_add_u32 s63, s52, 0x18000
  v_add_u32 v26, s63, v1
  s_waitcnt lgkmcnt(0)
  s_barrier
  ds_read_b128 v[192:195], v26 offset:0
  ds_read_b128 v[196:199], v26 offset:2048
  ds_read_b128 v[200:203], v26 offset:4096
  ds_read_b128 v[204:207], v26 offset:6144
  ds_read_b128 v[208:211], v26 offset:1024
  ds_read_b128 v[212:215], v26 offset:3072
  ds_read_b128 v[216:219], v26 offset:5120
  ds_read_b128 v[220:223], v26 offset:7168
  s_waitcnt lgkmcnt(7)
  v_dot2_f32_bf16 v32, v192, s53, v32
  v_dot2_f32_bf16 v33, v192, s54, v33
  v_dot2_f32_bf16 v34, v193, s53, v34
  v_dot2_f32_bf16 v35, v193, s54, v35
  v_dot2_f32_bf16 v36, v194, s53, v36
  v_dot2_f32_bf16 v37, v194, s54, v37
  v_dot2_f32_bf16 v38, v195, s53, v38
  v_dot2_f32_bf16 v39, v195, s54, v39
  s_waitcnt lgkmcnt(6)
  v_dot2_f32_bf16 v32, v196, s53, v32
  v_dot2_f32_bf16 v33, v196, s54, v33
  v_dot2_f32_bf16 v34, v197, s53, v34
  v_dot2_f32_bf16 v35, v197, s54, v35
  v_dot2_f32_bf16 v36, v198, s53, v36
  v_dot2_f32_bf16 v37, v198, s54, v37
  v_dot2_f32_bf16 v38, v199, s53, v38
  v_dot2_f32_bf16 v39, v199, s54, v39
  s_waitcnt lgkmcnt(5)
  v_dot2_f32_bf16 v32, v200, s53, v32
  v_dot2_f32_bf16 v33, v200, s54, v33
  v_dot2_f32_bf16 v34, v201, s53, v34
  v_dot2_f32_bf16 v35, v201, s54, v35
  v_dot2_f32_bf16 v36, v202, s53, v36
  v_dot2_f32_bf16 v37, v202, s54, v37
  v_dot2_f32_bf16 v38, v203, s53, v38
  v_dot2_f32_bf16 v39, v203, s54, v39
  s_waitcnt lgkmcnt(4)
  v_dot2_f32_bf16 v32, v204, s53, v32
  v_dot2_f32_bf16 v33, v204, s54, v33
  v_dot2_f32_bf16 v34, v205, s53, v34
  v_dot2_f32_bf16 v35, v205, s54, v35
  v_dot2_f32_bf16 v36, v206, s53, v36
  v_dot2_f32_bf16 v37, v206, s54, v37
  v_dot2_f32_bf16 v38, v207, s53, v38
  v_dot2_f32_bf16 v39, v207, s54, v39
  v_cvt_pk_bf16_f32 v48, v32, v33
  v_cvt_pk_bf16_f32 v49, v34, v35
  v_cvt_pk_bf16_f32 v50, v36, v37
  v_cvt_pk_bf16_f32 v51, v38, v39
  s_cmp_lg_u32 s58, 0
  s_cbranch_scc1 ALT_3
  buffer_store_dwordx4 v[48:51], v7, s[8:11], s40 offen
ALTB_3:
  s_waitcnt lgkmcnt(3)
  v_dot2_f32_bf16 v40, v208, s53, v40
  v_dot2_f32_bf16 v41, v208, s54, v41
  v_dot2_f32_bf16 v42, v209, s53, v42
  v_dot2_f32_bf16 v43, v209, s54, v43
  v_dot2_f32_bf16 v44, v210, s53, v44
  v_dot2_f32_bf16 v45, v210, s54, v45
  v_dot2_f32_bf16 v46, v211, s53, v46
  v_dot2_f32_bf16 v47, v211, s54, v47
  s_waitcnt lgkmcnt(2)
  v_dot2_f32_bf16 v40, v212, s53, v40
  v_dot2_f32_bf16 v41, v212, s54, v41
  v_dot2_f32_bf16 v42, v213, s53, v42
  v_dot2_f32_bf16 v43, v213, s54, v43
  v_dot2_f32_bf16 v44, v214, s53, v44
  v_dot2_f32_bf16 v45, v214, s54, v45
  v_dot2_f32_bf16 v46, v215, s53, v46
  v_dot2_f32_bf16 v47, v215, s54, v47
  s_waitcnt lgkmcnt(1)
  v_dot2_f32_bf16 v40, v216, s53, v40
  v_dot2_f32_bf16 v41, v216, s54, v41
  v_dot2_f32_bf16 v42, v217, s53, v42
  v_dot2_f32_bf16 v43, v217, s54, v43
  v_dot2_f32_bf16 v44, v218, s53, v44
  v_dot2_f32_bf16 v45, v218, s54, v45
  v_dot2_f32_bf16 v46, v219, s53, v46
  v_dot2_f32_bf16 v47, v219, s54, v47
  s_waitcnt lgkmcnt(0)
  v_dot2_f32_bf16 v40, v220, s53, v40
  v_dot2_f32_bf16 v41, v220, s54, v41
  v_dot2_f32_bf16 v42, v221, s53, v42
  v_dot2_f32_bf16 v43, v221, s54, v43
  v_dot2_f32_bf16 v44, v222, s53, v44
  v_dot2_f32_bf16 v45, v222, s54, v45
  v_dot2_f32_bf16 v46, v223, s53, v46
  v_dot2_f32_bf16 v47, v223, s54, v47
  v_cvt_pk_bf16_f32 v52, v40, v41
  v_cvt_pk_bf16_f32 v53, v42, v43
  v_cvt_pk_bf16_f32 v54, v44, v45
  v_cvt_pk_bf16_f32 v55, v46, v47
  s_cmp_lg_u32 s58, 0
  s_cbranch_scc1 ALT_4
  buffer_store_dwordx4 v[52:55], v7, s[8:11], s40 offen offset:2048
ALTB_4:
  v_dot2_f32_bf16 v28, v48, s55, 0
  v_dot2_f32_bf16 v29, v48, v48, 0
  v_dot2_f32_bf16 v28, v49, s55, v28
  v_dot2_f32_bf16 v29, v49, v49, v29
  v_dot2_f32_bf16 v28, v50, s55, v28
  v_dot2_f32_bf16 v29, v50, v50, v29
  v_dot2_f32_bf16 v28, v51, s55, v28
  v_dot2_f32_bf16 v29, v51, v51, v29
  v_dot2_f32_bf16 v28, v52, s55, v28
  v_dot2_f32_bf16 v29, v52, v52, v29
  v_dot2_f32_bf16 v28, v53, s55, v28
  v_dot2_f32_bf16 v29, v53, v53, v29
  v_dot2_f32_bf16 v28, v54, s55, v28
  v_dot2_f32_bf16 v29, v54, v54, v29
  v_dot2_f32_bf16 v28, v55, s55, v28
  v_dot2_f32_bf16 v29, v55, v55, v29
  s_nop 2
  v_permlane32_swap_b32 v28, v29
  v_add_f32 v28, v28, v29
  v_mov_b32 v29, v28
  s_nop 1
  v_permlane16_swap_b32 v28, v29
  v_add_f32 v28, v28, v29
  s_cmp_lg_u32 s58, 0
  s_cbranch_scc1 ALT_5
  buffer_store_dword v28, v17, s[8:11], s42 offen
ALTB_5:
  s_waitcnt vmcnt(0)
  s_add_u32 s70, s31, 1
  v_mov_b32 v31, s70
  s_cmp_lg_u32 s58, 0
  s_cbranch_scc1 ALT_6
  buffer_store_dword v31, v5, s[8:11], s46 offen
ALTB_6:
  s_mul_i32 s63, s28, 896
  s_lshl_b32 s64, s24, 8
  s_add_u32 s63, s63, s64
  v_lshlrev_b32 v28, 2, v0
  s_add_u32 s63, s63, 0x20000
  buffer_load_dword v56, v28, s[8:11], s63 offen sc1
  s_add_u32 s63, s63, 0x3800
  buffer_load_dword v57, v28, s[8:11], s63 offen sc1
  s_add_u32 s63, s63, 0x3800
  buffer_load_dword v58, v28, s[8:11], s63 offen sc1
  s_add_u32 s63, s63, 0x3800
  buffer_load_dword v59, v28, s[8:11], s63 offen sc1
  s_add_u32 m0, s52, 0x18000
  s_add_u32 s61, s35, 0x8000
  buffer_load_dwordx4 v1, s[8:11], s61 offen sc1 lds
  buffer_load_dwordx4 v1, s[8:11], s61 offen offset:1024 sc1 lds
  buffer_load_dwordx4 v1, s[8:11], s61 offen offset:2048 sc1 lds
  buffer_load_dwordx4 v1, s[8:11], s61 offen offset:3072 sc1 lds
  s_add_u32 m0, s52, 0x19000
  s_add_u32 s61, s35, 0x9000
  buffer_load_dwordx4 v1, s[8:11], s61 offen sc1 lds
  buffer_load_dwordx4 v1, s[8:11], s61 offen offset:1024 sc1 lds
  buffer_load_dwordx4 v1, s[8:11], s61 offen offset:2048 sc1 lds
  buffer_load_dwordx4 v1, s[8:11], s61 offen offset:3072 sc1 lds
  s_add_u32 s67, s80, 0x2000
  buffer_load_dwordx4 a[32:35], v1, s[8:11], s67 offen sc1
  buffer_load_dwordx4 a[36:39], v1, s[8:11], s67 offen offset:1024 sc1
  s_mov_b32 s69, 0
POLL_9:
  buffer_load_dword v26, v3, s[8:11], s45 offen sc1
  s_waitcnt vmcnt(0)
  s_add_u32 s68, s31, 1
  v_subrev_u32 v26, s68, v26
  v_cmp_lt_u32 vcc, 15, v26
  s_cbranch_vccz PD_10
  s_add_u32 s69, s69, 1
  s_cmp_lt_u32 s69, s33
  s_cbranch_scc1 POLL_9
  s_mov_b32 s33, 1
PD_10:
  buffer_load_dwordx4 v[128:131], v1, s[8:11], s38 offen sc1
  buffer_load_dwordx4 v[132:135], v1, s[8:11], s38 offen offset:1024 sc1
  buffer_load_dwordx4 v[136:139], v1, s[8:11], s38 offen offset:2048 sc1
  buffer_load_dwordx4 v[140:143], v1, s[8:11], s38 offen offset:3072 sc1
  s_add_u32 s60, s38, 0x1000
  buffer_load_dwordx4 v[144:147], v1, s[8:11], s60 offen sc1
  buffer_load_dwordx4 v[148:151], v1, s[8:11], s60 offen offset:1024 sc1
  buffer_load_dwordx4 v[152:155], v1, s[8:11], s60 offen offset:2048 sc1
  buffer_load_dwordx4 v[156:159], v1, s[8:11], s60 offen offset:3072 sc1
  s_barrier
  ds_read_b128 a[192:195], v1 offset:0
  ds_read_b128 a[196:199], v2 offset:32768
  ds_read_b128 a[200:203], v1 offset:1024
  ds_read_b128 a[204:207], v2 offset:33792
  ds_read_b128 a[208:211], v1 offset:2048
  ds_read_b128 a[212:215], v2 offset:34816
  s_waitcnt vmcnt(7) lgkmcnt(5)
  v_mfma_f32_32x32x16_bf16 v[64:79], a[192:195], v[128:131], 0
  s_branch PGS4
.p2align 12
PG4:
  s_branch PG8
PGS4:
  s_add_u32 s60, s38, 0x2000
  buffer_load_dwordx4 v[160:163], v1, s[8:11], s60 offen sc1
  ds_read_b128 a[216:219], v1 offset:3072
  s_waitcnt lgkmcnt(5)
  v_mfma_f32_32x32x16_bf16 v[80:95], a[196:199], v[128:131], 0
  buffer_load_dwordx4 v[164:167], v1, s[8:11], s60 offen offset:1024 sc1
  ds_read_b128 a[220:223], v2 offset:35840
  s_waitcnt vmcnt(8) lgkmcnt(5)
  v_mfma_f32_32x32x16_bf16 v[64:79], a[200:203], v[132:135], v[64:79]
  ds_read_b128 a[192:195], v1 offset:4096
  s_waitcnt lgkmcnt(5)
  v_mfma_f32_32x32x16_bf16 v[80:95], a[204:207], v[132:135], v[80:95]
  buffer_load_dwordx4 v[168:171], v1, s[8:11], s60 offen offset:2048 sc1
  ds_read_b128 a[196:199], v2 offset:36864
  s_waitcnt vmcnt(8) lgkmcnt(5)
  v_mfma_f32_32x32x16_bf16 v[64:79], a[208:211], v[136:139], v[64:79]
  ds_read_b128 a[200:203], v1 offset:5120
  s_waitcnt lgkmcnt(5)
  v_mfma_f32_32x32x16_bf16 v[80:95], a[212:215], v[136:139], v[80:95]
  buffer_load_dwordx4 v[172:175], v1, s[8:11], s60 offen offset:3072 sc1
  ds_read_b128 a[204:207], v2 offset:37888
  s_waitcnt vmcnt(8) lgkmcnt(5)
  v_mfma_f32_32x32x16_bf16 v[64:79], a[216:219], v[140:143], v[64:79]
  ds_read_b128 a[208:211], v1 offset:6144
  s_waitcnt lgkmcnt(5)
  v_mfma_f32_32x32x16_bf16 v[80:95], a[220:223], v[140:143], v[80:95]
  buffer_load_dwordx4 v[48:51], v1, s[8:11], s41 offen sc1
  ds_read_b128 a[212:215], v2 offset:38912
  s_waitcnt vmcnt(8) lgkmcnt(5)
  v_mfma_f32_32x32x16_bf16 v[64:79], a[192:195], v[144:147], v[64:79]
  ds_read_b128 a[216:219], v1 offset:7168
  s_waitcnt lgkmcnt(5)
  v_mfma_f32_32x32x16_bf16 v[80:95], a[196:199], v[144:147], v[80:95]
  buffer_load_dwordx4 v[52:55], v1, s[8:11], s41 offen offset:1024 sc1
  ds_read_b128 a[220:223], v2 offset:39936
  s_waitcnt vmcnt(8) lgkmcnt(5)
  v_mfma_f32_32x32x16_bf16 v[64:79], a[200:203], v[148:151], v[64:79]
  ds_read_b128 a[192:195], v1 offset:8192
  s_waitcnt lgkmcnt(5)
  v_mfma_f32_32x32x16_bf16 v[80:95], a[204:207], v[148:151], v[80:95]
  s_add_u32 s60, s38, 0x3000
  buffer_load_dwordx4 v[176:179], v1, s[8:11], s60 offen sc1
  ds_read_b128 a[196:199], v2 offset:40960
  s_waitcnt vmcnt(8) lgkmcnt(5)
  v_mfma_f32_32x32x16_bf16 v[64:79], a[208:211], v[152:155], v[64:79]
  buffer_load_dwordx4 v[180:183], v1, s[8:11], s60 offen offset:1024 sc1
  ds_read_b128 a[200:203], v1 offset:9216
  s_waitcnt lgkmcnt(5)
  v_mfma_f32_32x32x16_bf16 v[80:95], a[212:215], v[152:155], v[80:95]
  ds_read_b128 a[204:207], v2 offset:41984
  s_waitcnt vmcnt(8) lgkmcnt(5)
  v_mfma_f32_32x32x16_bf16 v[64:79], a[216:219], v[156:159], v[64:79]
  buffer_load_dwordx4 v[184:187], v1, s[8:11], s60 offen offset:2048 sc1
  ds_read_b128 a[208:211], v1 offset:10240
  s_waitcnt lgkmcnt(5)
  v_mfma_f32_32x32x16_bf16 v[80:95], a[220:223], v[156:159], v[80:95]
  ds_read_b128 a[212:215], v2 offset:43008
  s_waitcnt vmcnt(8) lgkmcnt(5)
  v_mfma_f32_32x32x16_bf16 v[64:79], a[192:195], v[160:163], v[64:79]
  buffer_load_dwordx4 v[188:191], v1, s[8:11], s60 offen offset:3072 sc1
  ds_read_b128 a[216:219], v1 offset:11264
  s_waitcnt lgkmcnt(5)
  v_mfma_f32_32x32x16_bf16 v[80:95], a[196:199], v[160:163], v[80:95]
  ds_read_b128 a[220:223], v2 offset:44032
  s_waitcnt vmcnt(8) lgkmcnt(5)
  v_mfma_f32_32x32x16_bf16 v[64:79], a[200:203], v[164:167], v[64:79]
  s_add_u32 s60, s38, 0x4000
  buffer_load_dwordx4 v[192:195], v1, s[8:11], s60 offen sc1
  ds_read_b128 a[192:195], v1 offset:12288
  s_waitcnt lgkmcnt(5)
  v_mfma_f32_32x32x16_bf16 v[80:95], a[204:207], v[164:167], v[80:95]
  ds_read_b128 a[196:199], v2 offset:45056
  s_waitcnt vmcnt(8) lgkmcnt(5)
  v_mfma_f32_32x32x16_bf16 v[64:79], a[208:211], v[168:171], v[64:79]
  buffer_load_dwordx4 v[196:199], v1, s[8:11], s60 offen offset:1024 sc1
  ds_read_b128 a[200:203], v1 offset:13312
  s_waitcnt lgkmcnt(5)
  v_mfma_f32_32x32x16_bf16 v[80:95], a[212:215], v[168:171], v[80:95]
  ds_read_b128 a[204:207], v2 offset:46080
  s_waitcnt vmcnt(8) lgkmcnt(5)
  v_mfma_f32_32x32x16_bf16 v[64:79], a[216:219], v[172:175], v[64:79]
  buffer_load_dwordx4 v[200:203], v1, s[8:11], s60 offen offset:2048 sc1
  ds_read_b128 a[208:211], v1 offset:14336
  s_waitcnt lgkmcnt(5)
  v_mfma_f32_32x32x16_bf16 v[80:95], a[220:223], v[172:175], v[80:95]
  ds_read_b128 a[212:215], v2 offset:47104
  s_waitcnt vmcnt(6) lgkmcnt(5)
  v_mfma_f32_32x32x16_bf16 v[64:79], a[192:195], v[176:179], v[64:79]
  buffer_load_dwordx4 v[204:207], v1, s[8:11], s60 offen offset:3072 sc1
  v_add_f32 v56, v56, v57
  ds_read_b128 a[216:219], v1 offset:15360
  s_waitcnt lgkmcnt(5)
  v_mfma_f32_32x32x16_bf16 v[80:95], a[196:199], v[176:179], v[80:95]
  s_add_u32 s60, s38, 0x5000
  buffer_load_dwordx4 v[208:211], v1, s[8:11], s60 offen sc1
  v_add_f32 v58, v58, v59
  ds_read_b128 a[220:223], v2 offset:48128
  s_waitcnt vmcnt(7) lgkmcnt(5)
  v_mfma_f32_32x32x16_bf16 v[64:79], a[200:203], v[180:183], v[64:79]
  v_add_f32 v56, v56, v58
  ds_read_b128 a[192:195], v1 offset:16384
  s_waitcnt lgkmcnt(5)
  v_mfma_f32_32x32x16_bf16 v[80:95], a[204:207], v[180:183], v[80:95]
  buffer_load_dwordx4 v[212:215], v1, s[8:11], s60 offen offset:1024 sc1
  ds_read_b128 a[196:199], v2 offset:49152
  s_waitcnt vmcnt(7) lgkmcnt(5)
  v_mfma_f32_32x32x16_bf16 v[64:79], a[208:211], v[184:187], v[64:79]
  v_cvt_pk_bf16_f32 v57, v56, v56
  ds_read_b128 a[200:203], v1 offset:17408
  s_waitcnt lgkmcnt(5)
  v_mfma_f32_32x32x16_bf16 v[80:95], a[212:215], v[184:187], v[80:95]
  buffer_load_dwordx4 v[216:219], v1, s[8:11], s60 offen offset:2048 sc1
  v_and_b32 v57, 0xffff0000, v57
  ds_read_b128 a[204:207], v2 offset:50176
  s_waitcnt vmcnt(7) lgkmcnt(5)
  v_mfma_f32_32x32x16_bf16 v[64:79], a[216:219], v[188:191], v[64:79]
  ds_read_b128 a[208:211], v1 offset:18432
  s_waitcnt lgkmcnt(5)
  v_mfma_f32_32x32x16_bf16 v[80:95], a[220:223], v[188:191], v[80:95]
  buffer_load_dwordx4 v[220:223], v1, s[8:11], s60 offen offset:3072 sc1
  v_sub_f32 v57, v56, v57
  ds_read_b128 a[212:215], v2 offset:51200
  s_waitcnt vmcnt(7) lgkmcnt(5)
  v_mfma_f32_32x32x16_bf16 v[64:79], a[192:195], v[192:195], v[64:79]
  v_cvt_pk_bf16_f32 v57, v56, v57
  ds_read_b128 a[216:219], v1 offset:19456
  s_waitcnt lgkmcnt(5)
  v_mfma_f32_32x32x16_bf16 v[80:95], a[196:199], v[192:195], v[80:95]
  s_add_u32 s60, s38, 0x6000
  buffer_load_dwordx4 v[224:227], v1, s[8:11], s60 offen sc1
  ds_read_b128 a[220:223], v2 offset:52224
  s_waitcnt vmcnt(7) lgkmcnt(5)
  v_mfma_f32_32x32x16_bf16 v[64:79], a[200:203], v[196:199], v[64:79]
  s_lshl_b32 s63, s24, 8
  s_add_u32 s63, s63, 0x27800
  v_add_u32 v28, s63, v28
  ds_read_b128 a[192:195], v1 offset:20480
  s_waitcnt lgkmcnt(5)
  v_mfma_f32_32x32x16_bf16 v[80:95], a[204:207], v[196:199], v[80:95]
  buffer_load_dwordx4 v[228:231], v1, s[8:11], s60 offen offset:1024 sc1
  ds_write_b32 v28, v57
  ds_read_b128 a[196:199], v2 offset:53248
  s_waitcnt vmcnt(7) lgkmcnt(6)
  v_mfma_f32_32x32x16_bf16 v[64:79], a[208:211], v[200:203], v[64:79]
  buffer_load_dwordx4 v[232:235], v1, s[8:11], s60 offen offset:2048 sc1
  ds_read_b128 a[200:203], v1 offset:21504
  s_waitcnt lgkmcnt(6)
  v_mfma_f32_32x32x16_bf16 v[80:95], a[212:215], v[200:203], v[80:95]
  v_add_f32 v48, v48, v50
  v_add_f32 v49, v49, v51
  ds_read_b128 a[204:207], v2 offset:54272
  s_waitcnt vmcnt(7) lgkmcnt(6)
  v_mfma_f32_32x32x16_bf16 v[64:79], a[216:219], v[204:207], v[64:79]
  buffer_load_dwordx4 v[236:239], v1, s[8:11], s60 offen offset:3072 sc1
  v_add_f32 v52, v52, v54
  ds_read_b128 a[208:211], v1 offset:22528
  s_waitcnt lgkmcnt(6)
  v_mfma_f32_32x32x16_bf16 v[80:95], a[220:223], v[204:207], v[80:95]
  v_add_f32 v53, v53, v55
  ds_read_b128 a[212:215], v2 offset:55296
  s_waitcnt vmcnt(7) lgkmcnt(6)
  v_mfma_f32_32x32x16_bf16 v[64:79], a[192:195], v[208:211], v[64:79]
  s_add_u32 s60, s38, 0x7000
  buffer_load_dwordx4 v[240:243], v1, s[8:11], s60 offen sc1
  v_add_f32 v48, v48, v52
  ds_read_b128 a[216:219], v1 offset:23552
  s_waitcnt lgkmcnt(5)
  v_mfma_f32_32x32x16_bf16 v[80:95], a[196:199], v[208:211], v[80:95]
  v_add_f32 v49, v49, v53
  ds_read_b128 a[220:223], v2 offset:56320
  s_waitcnt vmcnt(7) lgkmcnt(5)
  v_mfma_f32_32x32x16_bf16 v[64:79], a[200:203], v[212:215], v[64:79]
  buffer_load_dwordx4 v[244:247], v1, s[8:11], s60 offen offset:1024 sc1
  v_permlane32_swap_b32 v48, v49
  v_add_f32 v48, v48, v49
  ds_read_b128 a[192:195], v1 offset:24576
  s_waitcnt lgkmcnt(5)
  v_mfma_f32_32x32x16_bf16 v[80:95], a[204:207], v[212:215], v[80:95]
  v_mul_f32 v48, 0x3b000000, v48
  ds_read_b128 a[196:199], v2 offset:57344
  s_waitcnt vmcnt(7) lgkmcnt(5)
  v_mfma_f32_32x32x16_bf16 v[64:79], a[208:211], v[216:219], v[64:79]
  buffer_load_dwordx4 v[248:251], v1, s[8:11], s60 offen offset:2048 sc1
  v_mov_b32 v49, v48
  buffer_load_dwordx4 a[40:43], v1, s[8:11], s67 offen offset:2048 sc1
  ds_read_b128 a[200:203], v1 offset:25600
  s_waitcnt lgkmcnt(5)
  v_mfma_f32_32x32x16_bf16 v[80:95], a[212:215], v[216:219], v[80:95]
  v_permlane32_swap_b32 v48, v49
  ds_read_b128 a[204:207], v2 offset:58368
  s_waitcnt vmcnt(8) lgkmcnt(5)
  v_mfma_f32_32x32x16_bf16 v[64:79], a[216:219], v[220:223], v[64:79]
  buffer_load_dwordx4 v[252:255], v1, s[8:11], s60 offen offset:3072 sc1
  v_fma_f32 v49, -v48, v48, v49
  buffer_load_dwordx4 a[44:47], v1, s[8:11], s67 offen offset:3072 sc1
  ds_read_b128 a[208:211], v1 offset:26624
  s_waitcnt lgkmcnt(5)
  v_mfma_f32_32x32x16_bf16 v[80:95], a[220:223], v[220:223], v[80:95]
  v_max_f32 v49, 0, v49
  ds_read_b128 a[212:215], v2 offset:59392
  s_waitcnt vmcnt(9) lgkmcnt(5)
  v_mfma_f32_32x32x16_bf16 v[64:79], a[192:195], v[224:227], v[64:79]
  v_add_f32 v49, 0x3727c5ac, v49
  v_cvt_pk_bf16_f32 v60, -v48, -v48
  buffer_load_dwordx4 a[48:51], v1, s[8:11], s81 offen sc1
  ds_read_b128 a[216:219], v1 offset:27648
  s_waitcnt lgkmcnt(5)
  v_mfma_f32_32x32x16_bf16 v[80:95], a[196:199], v[224:227], v[80:95]
  v_and_b32 v50, 0xffff0000, v60
  ds_read_b128 a[220:223], v2 offset:60416
  s_waitcnt vmcnt(9) lgkmcnt(5)
  v_mfma_f32_32x32x16_bf16 v[64:79], a[200:203], v[228:231], v[64:79]
  v_sub_f32 v50, -v48, v50
  buffer_load_dwordx4 a[52:55], v1, s[8:11], s81 offen offset:1024 sc1
  ds_read_b128 a[192:195], v1 offset:28672
  s_waitcnt lgkmcnt(5)
  v_mfma_f32_32x32x16_bf16 v[80:95], a[204:207], v[228:231], v[80:95]
  v_cvt_pk_bf16_f32 v50, v50, v50
  ds_read_b128 a[196:199], v2 offset:61440
  s_waitcnt vmcnt(9) lgkmcnt(5)
  v_mfma_f32_32x32x16_bf16 v[64:79], a[208:211], v[232:235], v[64:79]
  v_cmp_gt_u32 vcc, 32, v0
  s_nop 1
  v_cndmask_b32 v60, v50, v60, vcc
  buffer_load_dwordx4 a[56:59], v1, s[8:11], s81 offen offset:2048 sc1
  ds_read_b128 a[200:203], v1 offset:29696
  s_waitcnt lgkmcnt(5)
  v_mfma_f32_32x32x16_bf16 v[80:95], a[212:215], v[232:235], v[80:95]
  v_rcp_f32 v24, v49
  ds_read_b128 a[204:207], v2 offset:62464
  s_waitcnt vmcnt(9) lgkmcnt(5)
  v_mfma_f32_32x32x16_bf16 v[64:79], a[216:219], v[236:239], v[64:79]
  v_mov_b32 v61, 0
  v_mov_b32 v62, 0
  buffer_load_dwordx4 a[60:63], v1, s[8:11], s81 offen offset:3072 sc1
  ds_read_b128 a[208:211], v1 offset:30720
  s_waitcnt lgkmcnt(5)
  v_mfma_f32_32x32x16_bf16 v[80:95], a[220:223], v[236:239], v[80:95]
  v_mov_b32 v63, 0
  ds_read_b128 a[212:215], v2 offset:63488
  s_waitcnt vmcnt(9) lgkmcnt(5)
  v_mfma_f32_32x32x16_bf16 v[64:79], a[192:195], v[240:243], v[64:79]
  v_and_b32 v28, 31, v0
  s_add_u32 s67, s81, 0x1000
  buffer_load_dwordx4 a[64:67], v1, s[8:11], s67 offen sc1
  ds_read_b128 a[216:219], v1 offset:31744
  s_waitcnt lgkmcnt(5)
  v_mfma_f32_32x32x16_bf16 v[80:95], a[196:199], v[240:243], v[80:95]
  v_lshlrev_b32 v28, 2, v28
  ds_read_b128 a[220:223], v2 offset:64512
  s_waitcnt vmcnt(9) lgkmcnt(5)
  v_mfma_f32_32x32x16_bf16 v[64:79], a[200:203], v[244:247], v[64:79]
  v_add_u32 v28, 0x27800, v28
  buffer_load_dwordx4 a[68:71], v1, s[8:11], s67 offen offset:1024 sc1
  s_waitcnt lgkmcnt(4)
  v_mfma_f32_32x32x16_bf16 v[80:95], a[204:207], v[244:247], v[80:95]
  ds_write_b32 v18, v24
  s_waitcnt vmcnt(9) lgkmcnt(4)
  v_mfma_f32_32x32x16_bf16 v[64:79], a[208:211], v[248:251], v[64:79]
  s_waitcnt lgkmcnt(1)
  s_barrier
  v_mfma_f32_32x32x16_bf16 v[80:95], a[212:215], v[248:251], v[80:95]
  s_add_u32 m0, s52, 0x0
  s_add_u32 s61, s35, 0x10000
  buffer_load_dwordx4 v1, s[8:11], s61 offen sc1 lds
  buffer_load_dwordx4 v1, s[8:11], s61 offen offset:1024 sc1 lds
  buffer_load_dwordx4 v1, s[8:11], s61 offen offset:2048 sc1 lds
  ds_read2_b32 v[56:57], v28 offset0:0 offset1:0
  ds_read2_b32 v[58:59], v28 offset0:32 offset1:32
  s_waitcnt vmcnt(10)
  v_mfma_f32_32x32x16_bf16 v[64:79], a[216:219], v[252:255], v[64:79]
  buffer_load_dwordx4 v1, s[8:11], s61 offen offset:3072 sc1 lds
  s_add_u32 m0, s52, 0x1000
  s_add_u32 s61, s35, 0x11000
  buffer_load_dwordx4 v1, s[8:11], s61 offen sc1 lds
  buffer_load_dwordx4 v1, s[8:11], s61 offen offset:1024 sc1 lds
  v_mfma_f32_32x32x16_bf16 v[80:95], a[220:223], v[252:255], v[80:95]
  buffer_load_dwordx4 v1, s[8:11], s61 offen offset:2048 sc1 lds
  buffer_load_dwordx4 v1, s[8:11], s61 offen offset:3072 sc1 lds
  s_waitcnt lgkmcnt(0)
  v_mfma_f32_32x32x16_bf16 v[64:79], v[56:59], v[60:63], v[64:79]
  v_mfma_f32_32x32x16_bf16 v[80:95], v[58:61], v[60:63], v[80:95]
  s_add_u32 m0, s52, 0x18000
  s_add_u32 s61, s35, 0x18000
  buffer_load_dwordx4 v1, s[8:11], s61 offen sc1 lds
  s_nop 7
  v_max_f32 v64, 0, v64
  v_max_f32 v65, 0, v65
  v_max_f32 v66, 0, v66
  v_max_f32 v67, 0, v67
  v_max_f32 v68, 0, v68
  buffer_load_dwordx4 v1, s[8:11], s61 offen offset:1024 sc1 lds
  v_max_f32 v69, 0, v69
  v_max_f32 v70, 0, v70
  v_max_f32 v71, 0, v71
  v_mul_f32 v64, v64, v72
  v_mul_f32 v65, v65, v73
  buffer_load_dwordx4 v1, s[8:11], s61 offen offset:2048 sc1 lds
  v_mul_f32 v66, v66, v74
  v_mul_f32 v67, v67, v75
  v_mul_f32 v68, v68, v76
  v_mul_f32 v69, v69, v77
  v_mul_f32 v70, v70, v78
  buffer_load_dwordx4 v1, s[8:11], s61 offen offset:3072 sc1 lds
  v_mul_f32 v71, v71, v79
  v_cvt_pk_bf16_f32 v72, v64, v65
  v_cvt_pk_bf16_f32 v73, v66, v67
  v_cvt_pk_bf16_f32 v74, v68, v69
  v_cvt_pk_bf16_f32 v75, v70, v71
  s_add_u32 m0, s52, 0x19000
  s_add_u32 s61, s35, 0x19000
  buffer_load_dwordx4 v1, s[8:11], s61 offen sc1 lds
  buffer_store_dwordx4 v[72:75], v1, s[8:11], s43 offen sc1
  v_max_f32 v80, 0, v80
  v_max_f32 v81, 0, v81
  v_max_f32 v82, 0, v82
  v_max_f32 v83, 0, v83
  buffer_load_dwordx4 v1, s[8:11], s61 offen offset:1024 sc1 lds
  v_max_f32 v84, 0, v84
  v_max_f32 v85, 0, v85
  v_max_f32 v86, 0, v86
  v_max_f32 v87, 0, v87
  v_mul_f32 v80, v80, v88
  buffer_load_dwordx4 v1, s[8:11], s61 offen offset:2048 sc1 lds
  v_mul_f32 v81, v81, v89
  v_mul_f32 v82, v82, v90
  v_mul_f32 v83, v83, v91
  v_mul_f32 v84, v84, v92
  v_mul_f32 v85, v85, v93
  buffer_load_dwordx4 v1, s[8:11], s61 offen offset:3072 sc1 lds
  v_mul_f32 v86, v86, v94
  v_mul_f32 v87, v87, v95
  v_cvt_pk_bf16_f32 v88, v80, v81
  v_cvt_pk_bf16_f32 v89, v82, v83
  v_cvt_pk_bf16_f32 v90, v84, v85
  v_cvt_pk_bf16_f32 v91, v86, v87
  buffer_store_dwordx4 v[88:91], v1, s[8:11], s43 offen offset:1024 sc1
  s_waitcnt vmcnt(10)
  s_barrier
  ds_read_b128 a[192:195], v1 offset:0
  ds_read_b128 a[196:199], v1 offset:1024
  s_waitcnt lgkmcnt(1)
  v_mfma_f32_32x32x16_bf16 v[96:111], a[192:195], v[128:131], 0
  buffer_load_dwordx4 a[72:75], v1, s[8:11], s67 offen offset:2048 sc1
  ds_read_b128 a[200:203], v1 offset:2048
  ds_read_b128 a[204:207], v1 offset:3072
  s_waitcnt lgkmcnt(2)
  v_mfma_f32_32x32x16_bf16 v[96:111], a[196:199], v[132:135], v[96:111]
  ds_read_b128 a[208:211], v1 offset:4096
  ds_read_b128 a[212:215], v1 offset:5120
  s_waitcnt lgkmcnt(3)
  v_mfma_f32_32x32x16_bf16 v[96:111], a[200:203], v[136:139], v[96:111]
  buffer_load_dwordx4 a[76:79], v1, s[8:11], s67 offen offset:3072 sc1
  ds_read_b128 a[216:219], v1 offset:6144
  ds_read_b128 a[220:223], v1 offset:7168
  s_waitcnt lgkmcnt(4)
  v_mfma_f32_32x32x16_bf16 v[96:111], a[204:207], v[140:143], v[96:111]
  ds_read_b128 a[192:195], v1 offset:8192
  ds_read_b128 a[196:199], v1 offset:9216
  s_waitcnt lgkmcnt(5)
  v_mfma_f32_32x32x16_bf16 v[96:111], a[208:211], v[144:147], v[96:111]
  ds_read_b128 a[200:203], v1 offset:10240
  s_waitcnt lgkmcnt(5)
  v_mfma_f32_32x32x16_bf16 v[96:111], a[212:215], v[148:151], v[96:111]
  s_add_u32 s67, s81, 0x2000
  buffer_load_dwordx4 a[80:83], v1, s[8:11], s67 offen sc1
  ds_read_b128 a[204:207], v1 offset:11264
  s_waitcnt lgkmcnt(5)
  v_mfma_f32_32x32x16_bf16 v[96:111], a[216:219], v[152:155], v[96:111]
  ds_read_b128 a[208:211], v1 offset:12288
  s_waitcnt lgkmcnt(5)
  v_mfma_f32_32x32x16_bf16 v[96:111], a[220:223], v[156:159], v[96:111]
  buffer_load_dwordx4 a[84:87], v1, s[8:11], s67 offen offset:1024 sc1
  ds_read_b128 a[212:215], v1 offset:13312
  s_waitcnt lgkmcnt(5)
  v_mfma_f32_32x32x16_bf16 v[96:111], a[192:195], v[160:163], v[96:111]
  ds_read_b128 a[216:219], v1 offset:14336
  s_waitcnt lgkmcnt(5)
  v_mfma_f32_32x32x16_bf16 v[96:111], a[196:199], v[164:167], v[96:111]
  ds_read_b128 a[220:223], v1 offset:15360
  s_waitcnt lgkmcnt(5)
  v_mfma_f32_32x32x16_bf16 v[96:111], a[200:203], v[168:171], v[96:111]
  buffer_load_dwordx4 a[88:91], v1, s[8:11], s67 offen offset:2048 sc1
  ds_read_b128 a[192:195], v1 offset:16384
  s_waitcnt lgkmcnt(5)
  v_mfma_f32_32x32x16_bf16 v[96:111], a[204:207], v[172:175], v[96:111]
  ds_read_b128 a[196:199], v1 offset:17408
  s_waitcnt lgkmcnt(5)
  v_mfma_f32_32x32x16_bf16 v[96:111], a[208:211], v[176:179], v[96:111]
  ds_read_b128 a[200:203], v1 offset:18432
  s_waitcnt lgkmcnt(5)
  v_mfma_f32_32x32x16_bf16 v[96:111], a[212:215], v[180:183], v[96:111]
  buffer_load_dwordx4 a[92:95], v1, s[8:11], s67 offen offset:3072 sc1
  ds_read_b128 a[204:207], v1 offset:19456
  s_waitcnt lgkmcnt(5)
  v_mfma_f32_32x32x16_bf16 v[96:111], a[216:219], v[184:187], v[96:111]
  ds_read_b128 a[208:211], v1 offset:20480
  s_waitcnt lgkmcnt(5)
  v_mfma_f32_32x32x16_bf16 v[96:111], a[220:223], v[188:191], v[96:111]
  buffer_load_dwordx4 a[96:99], v1, s[8:11], s82 offen sc1
  ds_read_b128 a[212:215], v1 offset:21504
  s_waitcnt lgkmcnt(5)
  v_mfma_f32_32x32x16_bf16 v[96:111], a[192:195], v[192:195], v[96:111]
  ds_read_b128 a[216:219], v1 offset:22528
  s_waitcnt lgkmcnt(5)
  v_mfma_f32_32x32x16_bf16 v[96:111], a[196:199], v[196:199], v[96:111]
  ds_read_b128 a[220:223], v1 offset:23552
  s_waitcnt lgkmcnt(5)
  v_mfma_f32_32x32x16_bf16 v[96:111], a[200:203], v[200:203], v[96:111]
  buffer_load_dwordx4 a[100:103], v1, s[8:11], s82 offen offset:1024 sc1
  ds_read_b128 a[192:195], v1 offset:24576
  s_waitcnt lgkmcnt(5)
  v_mfma_f32_32x32x16_bf16 v[96:111], a[204:207], v[204:207], v[96:111]
  ds_read_b128 a[196:199], v1 offset:25600
  s_waitcnt lgkmcnt(5)
  v_mfma_f32_32x32x16_bf16 v[96:111], a[208:211], v[208:211], v[96:111]
  ds_read_b32 v56, v28 offset:256
  ds_read_b128 a[200:203], v1 offset:26624
  s_waitcnt lgkmcnt(6)
  v_mfma_f32_32x32x16_bf16 v[96:111], a[212:215], v[212:215], v[96:111]
  buffer_load_dwordx4 a[104:107], v1, s[8:11], s82 offen offset:2048 sc1
  ds_read_b128 a[204:207], v1 offset:27648
  s_waitcnt lgkmcnt(6)
  v_mfma_f32_32x32x16_bf16 v[96:111], a[216:219], v[216:219], v[96:111]
  ds_read_b128 a[208:211], v1 offset:28672
  s_waitcnt lgkmcnt(6)
  v_mfma_f32_32x32x16_bf16 v[96:111], a[220:223], v[220:223], v[96:111]
  buffer_load_dwordx4 a[108:111], v1, s[8:11], s82 offen offset:3072 sc1
  ds_read_b128 a[212:215], v1 offset:29696
  s_waitcnt lgkmcnt(6)
  v_mfma_f32_32x32x16_bf16 v[96:111], a[192:195], v[224:227], v[96:111]
  s_waitcnt lgkmcnt(4)
  v_mfma_f32_32x32x16_bf16 v[96:111], v[56:59], v[60:63], v[96:111]
  ds_read_b128 a[216:219], v1 offset:30720
  v_mfma_f32_32x32x16_bf16 v[96:111], a[196:199], v[228:231], v[96:111]
  ds_read_b128 a[220:223], v1 offset:31744
  s_waitcnt lgkmcnt(5)
  v_mfma_f32_32x32x16_bf16 v[96:111], a[200:203], v[232:235], v[96:111]
  s_add_u32 s67, s82, 0x1000
  buffer_load_dwordx4 a[112:115], v1, s[8:11], s67 offen sc1
  s_waitcnt lgkmcnt(4)
  v_mfma_f32_32x32x16_bf16 v[96:111], a[204:207], v[236:239], v[96:111]
  s_waitcnt lgkmcnt(3)
  v_mfma_f32_32x32x16_bf16 v[96:111], a[208:211], v[240:243], v[96:111]
  s_waitcnt lgkmcnt(0)
  s_waitcnt vmcnt(12)
  s_barrier
  ds_read_b128 a[192:195], v2 offset:32768
  ds_read_b128 a[196:199], v2 offset:33792
  v_mfma_f32_32x32x16_bf16 v[96:111], a[212:215], v[244:247], v[96:111]
  s_add_u32 m0, s52, 0x0
  s_add_u32 s61, s35, 0x20000
  buffer_load_dwordx4 v1, s[8:11], s61 offen sc1 lds
  ds_read_b128 a[200:203], v2 offset:34816
  ds_read_b128 a[204:207], v2 offset:35840
  v_mfma_f32_32x32x16_bf16 v[96:111], a[216:219], v[248:251], v[96:111]
  buffer_load_dwordx4 v1, s[8:11], s61 offen offset:1024 sc1 lds
  ds_read_b128 a[208:211], v2 offset:36864
  v_mfma_f32_32x32x16_bf16 v[96:111], a[220:223], v[252:255], v[96:111]
  ds_read_b128 a[212:215], v2 offset:37888
  s_waitcnt lgkmcnt(5)
  v_mfma_f32_32x32x16_bf16 v[112:127], a[192:195], v[128:131], 0
  buffer_load_dwordx4 v1, s[8:11], s61 offen offset:2048 sc1 lds
  ds_read_b128 a[216:219], v2 offset:38912
  s_waitcnt lgkmcnt(5)
  v_mfma_f32_32x32x16_bf16 v[112:127], a[196:199], v[132:135], v[112:127]
  ds_read_b128 a[220:223], v2 offset:39936
  s_waitcnt lgkmcnt(5)
  v_mfma_f32_32x32x16_bf16 v[112:127], a[200:203], v[136:139], v[112:127]
  buffer_load_dwordx4 v1, s[8:11], s61 offen offset:3072 sc1 lds
  ds_read_b128 a[192:195], v2 offset:40960
  s_waitcnt lgkmcnt(5)
  v_mfma_f32_32x32x16_bf16 v[112:127], a[204:207], v[140:143], v[112:127]
  ds_read_b128 a[196:199], v2 offset:41984
  s_waitcnt lgkmcnt(5)
  v_mfma_f32_32x32x16_bf16 v[112:127], a[208:211], v[144:147], v[112:127]
  s_add_u32 m0, s52, 0x1000
  s_add_u32 s61, s35, 0x21000
  buffer_load_dwordx4 v1, s[8:11], s61 offen sc1 lds
  v_max_f32 v96, 0, v96
  v_max_f32 v97, 0, v97
  ds_read_b128 a[200:203], v2 offset:43008
  s_waitcnt lgkmcnt(5)
  v_mfma_f32_32x32x16_bf16 v[112:127], a[212:215], v[148:151], v[112:127]
  v_max_f32 v98, 0, v98
  v_max_f32 v99, 0, v99
  ds_read_b128 a[204:207], v2 offset:44032
  s_waitcnt lgkmcnt(5)
  v_mfma_f32_32x32x16_bf16 v[112:127], a[216:219], v[152:155], v[112:127]
  buffer_load_dwordx4 v1, s[8:11], s61 offen offset:1024 sc1 lds
  v_max_f32 v100, 0, v100
  v_max_f32 v101, 0, v101
  ds_read_b128 a[208:211], v2 offset:45056
  s_waitcnt lgkmcnt(5)
  v_mfma_f32_32x32x16_bf16 v[112:127], a[220:223], v[156:159], v[112:127]
  v_max_f32 v102, 0, v102
  v_max_f32 v103, 0, v103
  ds_read_b128 a[212:215], v2 offset:46080
  s_waitcnt lgkmcnt(5)
  v_mfma_f32_32x32x16_bf16 v[112:127], a[192:195], v[160:163], v[112:127]
  buffer_load_dwordx4 v1, s[8:11], s61 offen offset:2048 sc1 lds
  v_mul_f32 v96, v96, v104
  v_mul_f32 v97, v97, v105
  ds_read_b128 a[216:219], v2 offset:47104
  s_waitcnt lgkmcnt(5)
  v_mfma_f32_32x32x16_bf16 v[112:127], a[196:199], v[164:167], v[112:127]
  v_mul_f32 v98, v98, v106
  v_mul_f32 v99, v99, v107
  ds_read_b128 a[220:223], v2 offset:48128
  s_waitcnt lgkmcnt(5)
  v_mfma_f32_32x32x16_bf16 v[112:127], a[200:203], v[168:171], v[112:127]
  buffer_load_dwordx4 v1, s[8:11], s61 offen offset:3072 sc1 lds
  v_mul_f32 v100, v100, v108
  v_mul_f32 v101, v101, v109
  ds_read_b128 a[192:195], v2 offset:49152
  s_waitcnt lgkmcnt(5)
  v_mfma_f32_32x32x16_bf16 v[112:127], a[204:207], v[172:175], v[112:127]
  v_mul_f32 v102, v102, v110
  v_mul_f32 v103, v103, v111
  ds_read_b128 a[196:199], v2 offset:50176
  s_waitcnt lgkmcnt(5)
  v_mfma_f32_32x32x16_bf16 v[112:127], a[208:211], v[176:179], v[112:127]
  v_cvt_pk_bf16_f32 v104, v96, v97
  v_cvt_pk_bf16_f32 v105, v98, v99
  buffer_load_dwordx4 a[116:119], v1, s[8:11], s67 offen offset:1024 sc1
  ds_read_b128 a[200:203], v2 offset:51200
  s_waitcnt lgkmcnt(5)
  v_mfma_f32_32x32x16_bf16 v[112:127], a[212:215], v[180:183], v[112:127]
  v_cvt_pk_bf16_f32 v106, v100, v101
  v_cvt_pk_bf16_f32 v107, v102, v103
  ds_read_b128 a[204:207], v2 offset:52224
  s_waitcnt lgkmcnt(5)
  v_mfma_f32_32x32x16_bf16 v[112:127], a[216:219], v[184:187], v[112:127]
  buffer_store_dwordx4 v[104:107], v1, s[8:11], s43 offen offset:2048 sc1
  buffer_load_dwordx4 a[120:123], v1, s[8:11], s67 offen offset:2048 sc1
  ds_read_b128 a[208:211], v2 offset:53248
  s_waitcnt lgkmcnt(5)
  v_mfma_f32_32x32x16_bf16 v[112:127], a[220:223], v[188:191], v[112:127]
  ds_read_b128 a[212:215], v2 offset:54272
  s_waitcnt lgkmcnt(5)
  v_mfma_f32_32x32x16_bf16 v[112:127], a[192:195], v[192:195], v[112:127]
  buffer_load_dwordx4 a[124:127], v1, s[8:11], s67 offen offset:3072 sc1
  ds_read_b128 a[216:219], v2 offset:55296
  s_waitcnt lgkmcnt(5)
  v_mfma_f32_32x32x16_bf16 v[112:127], a[196:199], v[196:199], v[112:127]
  ds_read_b128 a[220:223], v2 offset:56320
  s_waitcnt lgkmcnt(5)
  v_mfma_f32_32x32x16_bf16 v[112:127], a[200:203], v[200:203], v[112:127]
  ds_read_b128 a[192:195], v2 offset:57344
  s_waitcnt lgkmcnt(5)
  v_mfma_f32_32x32x16_bf16 v[112:127], a[204:207], v[204:207], v[112:127]
  s_add_u32 s67, s82, 0x2000
  buffer_load_dwordx4 a[128:131], v1, s[8:11], s67 offen sc1
  ds_read_b128 a[196:199], v2 offset:58368
  s_waitcnt lgkmcnt(5)
  v_mfma_f32_32x32x16_bf16 v[112:127], a[208:211], v[208:211], v[112:127]
  ds_read_b32 v56, v28 offset:384
  ds_read_b128 a[200:203], v2 offset:59392
  s_waitcnt lgkmcnt(6)
  v_mfma_f32_32x32x16_bf16 v[112:127], a[212:215], v[212:215], v[112:127]
  buffer_load_dwordx4 a[132:135], v1, s[8:11], s67 offen offset:1024 sc1
  ds_read_b128 a[204:207], v2 offset:60416
  s_waitcnt lgkmcnt(6)
  v_mfma_f32_32x32x16_bf16 v[112:127], a[216:219], v[216:219], v[112:127]
  ds_read_b128 a[208:211], v2 offset:61440
  s_waitcnt lgkmcnt(6)
  v_mfma_f32_32x32x16_bf16 v[112:127], a[220:223], v[220:223], v[112:127]
  ds_read_b128 a[212:215], v2 offset:62464
  s_waitcnt lgkmcnt(6)
  v_mfma_f32_32x32x16_bf16 v[112:127], a[192:195], v[224:227], v[112:127]
  s_waitcnt lgkmcnt(4)
  v_mfma_f32_32x32x16_bf16 v[112:127], v[56:59], v[60:63], v[112:127]
  buffer_load_dwordx4 a[136:139], v1, s[8:11], s67 offen offset:2048 sc1
  ds_read_b128 a[216:219], v2 offset:63488
  v_mfma_f32_32x32x16_bf16 v[112:127], a[196:199], v[228:231], v[112:127]
  ds_read_b128 a[220:223], v2 offset:64512
  s_waitcnt lgkmcnt(5)
  v_mfma_f32_32x32x16_bf16 v[112:127], a[200:203], v[232:235], v[112:127]
  buffer_load_dwordx4 a[140:143], v1, s[8:11], s67 offen offset:3072 sc1
  s_waitcnt lgkmcnt(4)
  v_mfma_f32_32x32x16_bf16 v[112:127], a[204:207], v[236:239], v[112:127]
  s_waitcnt lgkmcnt(3)
  v_mfma_f32_32x32x16_bf16 v[112:127], a[208:211], v[240:243], v[112:127]
  s_waitcnt lgkmcnt(0)
  s_waitcnt vmcnt(8)
  s_barrier
  ds_read_b128 a[192:195], v1 offset:0
  ds_read_b128 a[196:199], v1 offset:1024
  v_mfma_f32_32x32x16_bf16 v[112:127], a[212:215], v[244:247], v[112:127]
  s_add_u32 m0, s52, 0x18000
  s_add_u32 s61, s35, 0x28000
  buffer_load_dwordx4 v1, s[8:11], s61 offen sc1 lds
  ds_read_b128 a[200:203], v1 offset:2048
  ds_read_b128 a[204:207], v1 offset:3072
  v_mfma_f32_32x32x16_bf16 v[112:127], a[216:219], v[248:251], v[112:127]
  buffer_load_dwordx4 v1, s[8:11], s61 offen offset:1024 sc1 lds
  ds_read_b128 a[208:211], v1 offset:4096
  v_mfma_f32_32x32x16_bf16 v[112:127], a[220:223], v[252:255], v[112:127]
  ds_read_b128 a[212:215], v1 offset:5120
  s_waitcnt lgkmcnt(5)
  v_mfma_f32_32x32x16_bf16 v[64:79], a[192:195], v[128:131], 0
  buffer_load_dwordx4 v1, s[8:11], s61 offen offset:2048 sc1 lds
  ds_read_b128 a[216:219], v1 offset:6144
  s_waitcnt lgkmcnt(5)
  v_mfma_f32_32x32x16_bf16 v[64:79], a[196:199], v[132:135], v[64:79]
  ds_read_b128 a[220:223], v1 offset:7168
  s_waitcnt lgkmcnt(5)
  v_mfma_f32_32x32x16_bf16 v[64:79], a[200:203], v[136:139], v[64:79]
  buffer_load_dwordx4 v1, s[8:11], s61 offen offset:3072 sc1 lds
  ds_read_b128 a[192:195], v1 offset:8192
  s_waitcnt lgkmcnt(5)
  v_mfma_f32_32x32x16_bf16 v[64:79], a[204:207], v[140:143], v[64:79]
  ds_read_b128 a[196:199], v1 offset:9216
  s_waitcnt lgkmcnt(5)
  v_mfma_f32_32x32x16_bf16 v[64:79], a[208:211], v[144:147], v[64:79]
  s_add_u32 m0, s52, 0x19000
  s_add_u32 s61, s35, 0x29000
  s_branch PGS5
.p2align 12
PG5:
  s_branch PG9
PGS5:
  buffer_load_dwordx4 v1, s[8:11], s61 offen sc1 lds
  v_max_f32 v112, 0, v112
  v_max_f32 v113, 0, v113
  ds_read_b128 a[200:203], v1 offset:10240
  s_waitcnt lgkmcnt(5)
  v_mfma_f32_32x32x16_bf16 v[64:79], a[212:215], v[148:151], v[64:79]
  v_max_f32 v114, 0, v114
  v_max_f32 v115, 0, v115
  ds_read_b128 a[204:207], v1 offset:11264
  s_waitcnt lgkmcnt(5)
  v_mfma_f32_32x32x16_bf16 v[64:79], a[216:219], v[152:155], v[64:79]
  buffer_load_dwordx4 v1, s[8:11], s61 offen offset:1024 sc1 lds
  v_max_f32 v116, 0, v116
  v_max_f32 v117, 0, v117
  ds_read_b128 a[208:211], v1 offset:12288
  s_waitcnt lgkmcnt(5)
  v_mfma_f32_32x32x16_bf16 v[64:79], a[220:223], v[156:159], v[64:79]
  v_max_f32 v118, 0, v118
  v_max_f32 v119, 0, v119
  ds_read_b128 a[212:215], v1 offset:13312
  s_waitcnt lgkmcnt(5)
  v_mfma_f32_32x32x16_bf16 v[64:79], a[192:195], v[160:163], v[64:79]
  buffer_load_dwordx4 v1, s[8:11], s61 offen offset:2048 sc1 lds
  v_mul_f32 v112, v112, v120
  v_mul_f32 v113, v113, v121
  ds_read_b128 a[216:219], v1 offset:14336
  s_waitcnt lgkmcnt(5)
  v_mfma_f32_32x32x16_bf16 v[64:79], a[196:199], v[164:167], v[64:79]
  v_mul_f32 v114, v114, v122
  v_mul_f32 v115, v115, v123
  ds_read_b128 a[220:223], v1 offset:15360
  s_waitcnt lgkmcnt(5)
  v_mfma_f32_32x32x16_bf16 v[64:79], a[200:203], v[168:171], v[64:79]
  buffer_load_dwordx4 v1, s[8:11], s61 offen offset:3072 sc1 lds
  v_mul_f32 v116, v116, v124
  v_mul_f32 v117, v117, v125
  ds_read_b128 a[192:195], v1 offset:16384
  s_waitcnt lgkmcnt(5)
  v_mfma_f32_32x32x16_bf16 v[64:79], a[204:207], v[172:175], v[64:79]
  v_mul_f32 v118, v118, v126
  v_mul_f32 v119, v119, v127
  ds_read_b128 a[196:199], v1 offset:17408
  s_waitcnt lgkmcnt(5)
  v_mfma_f32_32x32x16_bf16 v[64:79], a[208:211], v[176:179], v[64:79]
  v_cvt_pk_bf16_f32 v120, v112, v113
  v_cvt_pk_bf16_f32 v121, v114, v115
  buffer_load_dwordx4 a[144:147], v1, s[8:11], s83 offen sc1
  ds_read_b128 a[200:203], v1 offset:18432
  s_waitcnt lgkmcnt(5)
  v_mfma_f32_32x32x16_bf16 v[64:79], a[212:215], v[180:183], v[64:79]
  v_cvt_pk_bf16_f32 v122, v116, v117
  v_cvt_pk_bf16_f32 v123, v118, v119
  ds_read_b128 a[204:207], v1 offset:19456
  s_waitcnt lgkmcnt(5)
  v_mfma_f32_32x32x16_bf16 v[64:79], a[216:219], v[184:187], v[64:79]
  buffer_store_dwordx4 v[120:123], v1, s[8:11], s43 offen offset:3072 sc1
  buffer_load_dwordx4 a[148:151], v1, s[8:11], s83 offen offset:1024 sc1
  ds_read_b128 a[208:211], v1 offset:20480
  s_waitcnt lgkmcnt(5)
  v_mfma_f32_32x32x16_bf16 v[64:79], a[220:223], v[188:191], v[64:79]
  ds_read_b128 a[212:215], v1 offset:21504
  s_waitcnt lgkmcnt(5)
  v_mfma_f32_32x32x16_bf16 v[64:79], a[192:195], v[192:195], v[64:79]
  buffer_load_dwordx4 a[152:155], v1, s[8:11], s83 offen offset:2048 sc1
  ds_read_b128 a[216:219], v1 offset:22528
  s_waitcnt lgkmcnt(5)
  v_mfma_f32_32x32x16_bf16 v[64:79], a[196:199], v[196:199], v[64:79]
  ds_read_b128 a[220:223], v1 offset:23552
  s_waitcnt lgkmcnt(5)
  v_mfma_f32_32x32x16_bf16 v[64:79], a[200:203], v[200:203], v[64:79]
  ds_read_b128 a[192:195], v1 offset:24576
  s_waitcnt lgkmcnt(5)
  v_mfma_f32_32x32x16_bf16 v[64:79], a[204:207], v[204:207], v[64:79]
  buffer_load_dwordx4 a[156:159], v1, s[8:11], s83 offen offset:3072 sc1
  ds_read_b128 a[196:199], v1 offset:25600
  s_waitcnt lgkmcnt(5)
  v_mfma_f32_32x32x16_bf16 v[64:79], a[208:211], v[208:211], v[64:79]
  ds_read_b32 v56, v28 offset:512
  ds_read_b128 a[200:203], v1 offset:26624
  s_waitcnt lgkmcnt(6)
  v_mfma_f32_32x32x16_bf16 v[64:79], a[212:215], v[212:215], v[64:79]
  s_add_u32 s67, s83, 0x1000
  buffer_load_dwordx4 a[160:163], v1, s[8:11], s67 offen sc1
  ds_read_b128 a[204:207], v1 offset:27648
  s_waitcnt lgkmcnt(6)
  v_mfma_f32_32x32x16_bf16 v[64:79], a[216:219], v[216:219], v[64:79]
  ds_read_b128 a[208:211], v1 offset:28672
  s_waitcnt lgkmcnt(6)
  v_mfma_f32_32x32x16_bf16 v[64:79], a[220:223], v[220:223], v[64:79]
  ds_read_b128 a[212:215], v1 offset:29696
  s_waitcnt lgkmcnt(6)
  v_mfma_f32_32x32x16_bf16 v[64:79], a[192:195], v[224:227], v[64:79]
  s_waitcnt lgkmcnt(4)
  v_mfma_f32_32x32x16_bf16 v[64:79], v[56:59], v[60:63], v[64:79]
  buffer_load_dwordx4 a[164:167], v1, s[8:11], s67 offen offset:1024 sc1
  ds_read_b128 a[216:219], v1 offset:30720
  v_mfma_f32_32x32x16_bf16 v[64:79], a[196:199], v[228:231], v[64:79]
  ds_read_b128 a[220:223], v1 offset:31744
  s_waitcnt lgkmcnt(5)
  v_mfma_f32_32x32x16_bf16 v[64:79], a[200:203], v[232:235], v[64:79]
  buffer_load_dwordx4 a[168:171], v1, s[8:11], s67 offen offset:2048 sc1
  s_waitcnt lgkmcnt(4)
  v_mfma_f32_32x32x16_bf16 v[64:79], a[204:207], v[236:239], v[64:79]
  s_waitcnt lgkmcnt(3)
  v_mfma_f32_32x32x16_bf16 v[64:79], a[208:211], v[240:243], v[64:79]
  s_waitcnt lgkmcnt(0)
  s_waitcnt vmcnt(8)
  s_barrier
  ds_read_b128 a[192:195], v2 offset:32768
  ds_read_b128 a[196:199], v2 offset:33792
  v_mfma_f32_32x32x16_bf16 v[64:79], a[212:215], v[244:247], v[64:79]
  s_add_u32 m0, s52, 0x0
  s_add_u32 s61, s35, 0x30000
  buffer_load_dwordx4 v1, s[8:11], s61 offen sc1 lds
  ds_read_b128 a[200:203], v2 offset:34816
  ds_read_b128 a[204:207], v2 offset:35840
  v_mfma_f32_32x32x16_bf16 v[64:79], a[216:219], v[248:251], v[64:79]
  buffer_load_dwordx4 v1, s[8:11], s61 offen offset:1024 sc1 lds
  ds_read_b128 a[208:211], v2 offset:36864
  v_mfma_f32_32x32x16_bf16 v[64:79], a[220:223], v[252:255], v[64:79]
  ds_read_b128 a[212:215], v2 offset:37888
  s_waitcnt lgkmcnt(5)
  v_mfma_f32_32x32x16_bf16 v[80:95], a[192:195], v[128:131], 0
  buffer_load_dwordx4 v1, s[8:11], s61 offen offset:2048 sc1 lds
  ds_read_b128 a[216:219], v2 offset:38912
  s_waitcnt lgkmcnt(5)
  v_mfma_f32_32x32x16_bf16 v[80:95], a[196:199], v[132:135], v[80:95]
  ds_read_b128 a[220:223], v2 offset:39936
  s_waitcnt lgkmcnt(5)
  v_mfma_f32_32x32x16_bf16 v[80:95], a[200:203], v[136:139], v[80:95]
  buffer_load_dwordx4 v1, s[8:11], s61 offen offset:3072 sc1 lds
  ds_read_b128 a[192:195], v2 offset:40960
  s_waitcnt lgkmcnt(5)
  v_mfma_f32_32x32x16_bf16 v[80:95], a[204:207], v[140:143], v[80:95]
  ds_read_b128 a[196:199], v2 offset:41984
  s_waitcnt lgkmcnt(5)
  v_mfma_f32_32x32x16_bf16 v[80:95], a[208:211], v[144:147], v[80:95]
  s_add_u32 m0, s52, 0x1000
  s_add_u32 s61, s35, 0x31000
  buffer_load_dwordx4 v1, s[8:11], s61 offen sc1 lds
  v_max_f32 v64, 0, v64
  v_max_f32 v65, 0, v65
  ds_read_b128 a[200:203], v2 offset:43008
  s_waitcnt lgkmcnt(5)
  v_mfma_f32_32x32x16_bf16 v[80:95], a[212:215], v[148:151], v[80:95]
  v_max_f32 v66, 0, v66
  v_max_f32 v67, 0, v67
  ds_read_b128 a[204:207], v2 offset:44032
  s_waitcnt lgkmcnt(5)
  v_mfma_f32_32x32x16_bf16 v[80:95], a[216:219], v[152:155], v[80:95]
  buffer_load_dwordx4 v1, s[8:11], s61 offen offset:1024 sc1 lds
  v_max_f32 v68, 0, v68
  v_max_f32 v69, 0, v69
  ds_read_b128 a[208:211], v2 offset:45056
  s_waitcnt lgkmcnt(5)
  v_mfma_f32_32x32x16_bf16 v[80:95], a[220:223], v[156:159], v[80:95]
  v_max_f32 v70, 0, v70
  v_max_f32 v71, 0, v71
  ds_read_b128 a[212:215], v2 offset:46080
  s_waitcnt lgkmcnt(5)
  v_mfma_f32_32x32x16_bf16 v[80:95], a[192:195], v[160:163], v[80:95]
  buffer_load_dwordx4 v1, s[8:11], s61 offen offset:2048 sc1 lds
  v_mul_f32 v64, v64, v72
  v_mul_f32 v65, v65, v73
  ds_read_b128 a[216:219], v2 offset:47104
  s_waitcnt lgkmcnt(5)
  v_mfma_f32_32x32x16_bf16 v[80:95], a[196:199], v[164:167], v[80:95]
  v_mul_f32 v66, v66, v74
  v_mul_f32 v67, v67, v75
  ds_read_b128 a[220:223], v2 offset:48128
  s_waitcnt lgkmcnt(5)
  v_mfma_f32_32x32x16_bf16 v[80:95], a[200:203], v[168:171], v[80:95]
  buffer_load_dwordx4 v1, s[8:11], s61 offen offset:3072 sc1 lds
  v_mul_f32 v68, v68, v76
  v_mul_f32 v69, v69, v77
  ds_read_b128 a[192:195], v2 offset:49152
  s_waitcnt lgkmcnt(5)
  v_mfma_f32_32x32x16_bf16 v[80:95], a[204:207], v[172:175], v[80:95]
  v_mul_f32 v70, v70, v78
  v_mul_f32 v71, v71, v79
  ds_read_b128 a[196:199], v2 offset:50176
  s_waitcnt lgkmcnt(5)
  v_mfma_f32_32x32x16_bf16 v[80:95], a[208:211], v[176:179], v[80:95]
  v_cvt_pk_bf16_f32 v72, v64, v65
  v_cvt_pk_bf16_f32 v73, v66, v67
  buffer_load_dwordx4 a[172:175], v1, s[8:11], s67 offen offset:3072 sc1
  ds_read_b128 a[200:203], v2 offset:51200
  s_waitcnt lgkmcnt(5)
  v_mfma_f32_32x32x16_bf16 v[80:95], a[212:215], v[180:183], v[80:95]
  v_cvt_pk_bf16_f32 v74, v68, v69
  v_cvt_pk_bf16_f32 v75, v70, v71
  ds_read_b128 a[204:207], v2 offset:52224
  s_waitcnt lgkmcnt(5)
  v_mfma_f32_32x32x16_bf16 v[80:95], a[216:219], v[184:187], v[80:95]
  s_add_u32 s64, s43, 0x1000
  buffer_store_dwordx4 v[72:75], v1, s[8:11], s64 offen sc1
  ds_read_b128 a[208:211], v2 offset:53248
  s_waitcnt lgkmcnt(5)
  v_mfma_f32_32x32x16_bf16 v[80:95], a[220:223], v[188:191], v[80:95]
  s_add_u32 s67, s83, 0x2000
  buffer_load_dwordx4 a[176:179], v1, s[8:11], s67 offen sc1
  s_add_u32 s65, s48, 0x2000
  s_add_u32 s66, s47, 0x2000
  s_waitcnt vmcnt(17)
  s_add_u32 s70, s31, 4
  v_mov_b32 v31, s70
  s_cmp_lg_u32 s58, 0
  s_cbranch_scc1 ALT_7
  buffer_store_dword v31, v5, s[8:11], s65 offen
ALTB_7:
  ds_read_b128 a[212:215], v2 offset:54272
  s_waitcnt lgkmcnt(5)
  v_mfma_f32_32x32x16_bf16 v[80:95], a[192:195], v[192:195], v[80:95]
  ds_read_b128 a[216:219], v2 offset:55296
  s_waitcnt lgkmcnt(5)
  v_mfma_f32_32x32x16_bf16 v[80:95], a[196:199], v[196:199], v[80:95]
  ds_read_b128 a[220:223], v2 offset:56320
  s_waitcnt lgkmcnt(5)
  v_mfma_f32_32x32x16_bf16 v[80:95], a[200:203], v[200:203], v[80:95]
  buffer_load_dwordx4 a[180:183], v1, s[8:11], s67 offen offset:1024 sc1
  ds_read_b128 a[192:195], v2 offset:57344
  s_waitcnt lgkmcnt(5)
  v_mfma_f32_32x32x16_bf16 v[80:95], a[204:207], v[204:207], v[80:95]
  ds_read_b128 a[196:199], v2 offset:58368
  s_waitcnt lgkmcnt(5)
  v_mfma_f32_32x32x16_bf16 v[80:95], a[208:211], v[208:211], v[80:95]
  ds_read_b32 v56, v28 offset:640
  ds_read_b128 a[200:203], v2 offset:59392
  s_waitcnt lgkmcnt(6)
  v_mfma_f32_32x32x16_bf16 v[80:95], a[212:215], v[212:215], v[80:95]
  ds_read_b128 a[204:207], v2 offset:60416
  s_waitcnt lgkmcnt(6)
  v_mfma_f32_32x32x16_bf16 v[80:95], a[216:219], v[216:219], v[80:95]
  buffer_load_dwordx4 a[184:187], v1, s[8:11], s67 offen offset:2048 sc1
  ds_read_b128 a[208:211], v2 offset:61440
  s_waitcnt lgkmcnt(6)
  v_mfma_f32_32x32x16_bf16 v[80:95], a[220:223], v[220:223], v[80:95]
  ds_read_b128 a[212:215], v2 offset:62464
  s_waitcnt lgkmcnt(6)
  v_mfma_f32_32x32x16_bf16 v[80:95], a[192:195], v[224:227], v[80:95]
  s_waitcnt lgkmcnt(4)
  v_mfma_f32_32x32x16_bf16 v[80:95], v[56:59], v[60:63], v[80:95]
  ds_read_b128 a[216:219], v2 offset:63488
  v_mfma_f32_32x32x16_bf16 v[80:95], a[196:199], v[228:231], v[80:95]
  buffer_load_dwordx4 a[188:191], v1, s[8:11], s67 offen offset:3072 sc1
  ds_read_b128 a[220:223], v2 offset:64512
  s_waitcnt lgkmcnt(5)
  v_mfma_f32_32x32x16_bf16 v[80:95], a[200:203], v[232:235], v[80:95]
  s_waitcnt lgkmcnt(4)
  v_mfma_f32_32x32x16_bf16 v[80:95], a[204:207], v[236:239], v[80:95]
  s_waitcnt lgkmcnt(3)
  v_mfma_f32_32x32x16_bf16 v[80:95], a[208:211], v[240:243], v[80:95]
  buffer_load_dword v26, v4, s[8:11], s66 offen sc1
  s_waitcnt lgkmcnt(0)
  s_waitcnt vmcnt(8)
  s_barrier
  ds_read_b128 a[192:195], v1 offset:0
  ds_read_b128 a[196:199], v1 offset:1024
  v_mfma_f32_32x32x16_bf16 v[80:95], a[212:215], v[244:247], v[80:95]
  ds_read_b128 a[200:203], v1 offset:2048
  ds_read_b128 a[204:207], v1 offset:3072
  v_mfma_f32_32x32x16_bf16 v[80:95], a[216:219], v[248:251], v[80:95]
  s_lshl_b32 s71, s28, 11
  s_add_u32 s71, s71, s38
  s_add_u32 s71, s71, 0x200000
  v_lshlrev_b32 v29, 5, v3
  buffer_load_dword v21, v29, s[8:11], s71 offen sc1
  ds_read_b128 a[208:211], v1 offset:4096
  v_mfma_f32_32x32x16_bf16 v[80:95], a[220:223], v[252:255], v[80:95]
  s_lshl_b32 s71, s28, 7
  s_add_u32 s71, s71, s41
  s_add_u32 s71, s71, 0x20000
  buffer_load_dword v21, v5, s[8:11], s71 offen sc1
  ds_read_b128 a[212:215], v1 offset:5120
  s_waitcnt lgkmcnt(5)
  v_mfma_f32_32x32x16_bf16 v[96:111], a[192:195], v[128:131], 0
  s_and_b32 s71, s28, 3
  s_lshl_b32 s71, s71, 13
  s_add_u32 s71, s71, s45
  buffer_load_dword v21, v5, s[8:11], s71 offen sc1
  ds_read_b128 a[216:219], v1 offset:6144
  s_waitcnt lgkmcnt(5)
  v_mfma_f32_32x32x16_bf16 v[96:111], a[196:199], v[132:135], v[96:111]
  ds_read_b128 a[220:223], v1 offset:7168
  s_waitcnt lgkmcnt(5)
  v_mfma_f32_32x32x16_bf16 v[96:111], a[200:203], v[136:139], v[96:111]
  ds_read_b128 a[192:195], v1 offset:8192
  s_waitcnt lgkmcnt(5)
  v_mfma_f32_32x32x16_bf16 v[96:111], a[204:207], v[140:143], v[96:111]
  ds_read_b128 a[196:199], v1 offset:9216
  s_waitcnt lgkmcnt(5)
  v_mfma_f32_32x32x16_bf16 v[96:111], a[208:211], v[144:147], v[96:111]
  v_max_f32 v80, 0, v80
  v_max_f32 v81, 0, v81
  ds_read_b128 a[200:203], v1 offset:10240
  s_waitcnt lgkmcnt(5)
  v_mfma_f32_32x32x16_bf16 v[96:111], a[212:215], v[148:151], v[96:111]
  v_max_f32 v82, 0, v82
  v_max_f32 v83, 0, v83
  ds_read_b128 a[204:207], v1 offset:11264
  s_waitcnt lgkmcnt(5)
  v_mfma_f32_32x32x16_bf16 v[96:111], a[216:219], v[152:155], v[96:111]
  v_max_f32 v84, 0, v84
  v_max_f32 v85, 0, v85
  ds_read_b128 a[208:211], v1 offset:12288
  s_waitcnt lgkmcnt(5)
  v_mfma_f32_32x32x16_bf16 v[96:111], a[220:223], v[156:159], v[96:111]
  v_max_f32 v86, 0, v86
  v_max_f32 v87, 0, v87
  ds_read_b128 a[212:215], v1 offset:13312
  s_waitcnt lgkmcnt(5)
  v_mfma_f32_32x32x16_bf16 v[96:111], a[192:195], v[160:163], v[96:111]
  v_mul_f32 v80, v80, v88
  v_mul_f32 v81, v81, v89
  s_add_u32 s68, s31, 4
  s_waitcnt vmcnt(3)
  v_subrev_u32 v26, s68, v26
  v_cmp_lt_u32 vcc, 15, v26
  s_cbranch_vccz HC_11
  s_mov_b32 s69, 0
POLL_12:
  buffer_load_dword v26, v4, s[8:11], s66 offen sc1
  s_waitcnt vmcnt(0)
  s_add_u32 s68, s31, 4
  s_waitcnt vmcnt(0)
  v_subrev_u32 v26, s68, v26
  s_waitcnt vmcnt(0)
  v_cmp_lt_u32 vcc, 15, v26
  s_cbranch_vccz PD_13
  s_add_u32 s69, s69, 1
  s_cmp_lt_u32 s69, s33
  s_cbranch_scc1 POLL_12
  s_mov_b32 s33, 1
PD_13:
HC_11:
  ds_read_b128 a[216:219], v1 offset:14336
  s_waitcnt lgkmcnt(5)
  v_mfma_f32_32x32x16_bf16 v[96:111], a[196:199], v[164:167], v[96:111]
  v_mul_f32 v82, v82, v90
  v_mul_f32 v83, v83, v91
  buffer_load_dwordx4 v[128:131], v1, s[8:11], s72 offen sc1
  ds_read_b128 a[220:223], v1 offset:15360
  s_waitcnt lgkmcnt(5)
  v_mfma_f32_32x32x16_bf16 v[96:111], a[200:203], v[168:171], v[96:111]
  v_mul_f32 v84, v84, v92
  v_mul_f32 v85, v85, v93
  buffer_load_dwordx4 v[132:135], v1, s[8:11], s73 offen sc1
  ds_read_b128 a[192:195], v1 offset:16384
  s_waitcnt lgkmcnt(5)
  v_mfma_f32_32x32x16_bf16 v[96:111], a[204:207], v[172:175], v[96:111]
  v_mul_f32 v86, v86, v94
  v_mul_f32 v87, v87, v95
  ds_read_b128 a[196:199], v1 offset:17408
  s_waitcnt lgkmcnt(5)
  v_mfma_f32_32x32x16_bf16 v[96:111], a[208:211], v[176:179], v[96:111]
  v_cvt_pk_bf16_f32 v88, v80, v81
  v_cvt_pk_bf16_f32 v89, v82, v83
  buffer_load_dwordx4 v[136:139], v1, s[8:11], s74 offen sc1
  ds_read_b128 a[200:203], v1 offset:18432
  s_waitcnt lgkmcnt(5)
  v_mfma_f32_32x32x16_bf16 v[96:111], a[212:215], v[180:183], v[96:111]
  v_cvt_pk_bf16_f32 v90, v84, v85
  v_cvt_pk_bf16_f32 v91, v86, v87
  ds_read_b128 a[204:207], v1 offset:19456
  s_waitcnt lgkmcnt(5)
  v_mfma_f32_32x32x16_bf16 v[96:111], a[216:219], v[184:187], v[96:111]
  buffer_store_dwordx4 v[88:91], v1, s[8:11], s64 offen offset:1024 sc1
  buffer_load_dwordx4 v[140:143], v1, s[8:11], s75 offen sc1
  ds_read_b128 a[208:211], v1 offset:20480
  s_waitcnt lgkmcnt(5)
  v_mfma_f32_32x32x16_bf16 v[96:111], a[220:223], v[188:191], v[96:111]
  ds_read_b128 a[212:215], v1 offset:21504
  s_waitcnt lgkmcnt(5)
  v_mfma_f32_32x32x16_bf16 v[96:111], a[192:195], v[192:195], v[96:111]
  s_add_u32 s62, s72, 0x1c000
  buffer_load_dwordx4 v[144:147], v1, s[8:11], s62 offen sc1
  ds_read_b128 a[216:219], v1 offset:22528
  s_waitcnt lgkmcnt(5)
  v_mfma_f32_32x32x16_bf16 v[96:111], a[196:199], v[196:199], v[96:111]
  ds_read_b128 a[220:223], v1 offset:23552
  s_waitcnt lgkmcnt(5)
  v_mfma_f32_32x32x16_bf16 v[96:111], a[200:203], v[200:203], v[96:111]
  s_add_u32 s62, s73, 0x1c000
  buffer_load_dwordx4 v[148:151], v1, s[8:11], s62 offen sc1
  ds_read_b128 a[192:195], v1 offset:24576
  s_waitcnt lgkmcnt(5)
  v_mfma_f32_32x32x16_bf16 v[96:111], a[204:207], v[204:207], v[96:111]
  ds_read_b128 a[196:199], v1 offset:25600
  s_waitcnt lgkmcnt(5)
  v_mfma_f32_32x32x16_bf16 v[96:111], a[208:211], v[208:211], v[96:111]
  ds_read_b32 v56, v28 offset:768
  s_add_u32 s62, s74, 0x1c000
  buffer_load_dwordx4 v[152:155], v1, s[8:11], s62 offen sc1
  ds_read_b128 a[200:203], v1 offset:26624
  s_waitcnt lgkmcnt(6)
  v_mfma_f32_32x32x16_bf16 v[96:111], a[212:215], v[212:215], v[96:111]
  ds_read_b128 a[204:207], v1 offset:27648
  s_waitcnt lgkmcnt(6)
  v_mfma_f32_32x32x16_bf16 v[96:111], a[216:219], v[216:219], v[96:111]
  s_add_u32 s62, s75, 0x1c000
  buffer_load_dwordx4 v[156:159], v1, s[8:11], s62 offen sc1
  ds_read_b128 a[208:211], v1 offset:28672
  s_waitcnt lgkmcnt(6)
  v_mfma_f32_32x32x16_bf16 v[96:111], a[220:223], v[220:223], v[96:111]
  ds_read_b128 a[212:215], v1 offset:29696
  s_waitcnt lgkmcnt(6)
  v_mfma_f32_32x32x16_bf16 v[96:111], a[192:195], v[224:227], v[96:111]
  s_waitcnt lgkmcnt(4)
  v_mfma_f32_32x32x16_bf16 v[96:111], v[56:59], v[60:63], v[96:111]
  buffer_load_dwordx4 v[160:163], v1, s[8:11], s72 offen offset:1024 sc1
  ds_read_b128 a[216:219], v1 offset:30720
  v_mfma_f32_32x32x16_bf16 v[96:111], a[196:199], v[228:231], v[96:111]
  ds_read_b128 a[220:223], v1 offset:31744
  s_waitcnt lgkmcnt(5)
  v_mfma_f32_32x32x16_bf16 v[96:111], a[200:203], v[232:235], v[96:111]
  s_add_u32 s62, s72, 0x1c000
  buffer_load_dwordx4 v[164:167], v1, s[8:11], s62 offen offset:1024 sc1
  s_waitcnt lgkmcnt(4)
  v_mfma_f32_32x32x16_bf16 v[96:111], a[204:207], v[236:239], v[96:111]
  s_waitcnt vmcnt(7)
  s_add_u32 s70, s31, 6
  v_mov_b32 v31, s70
  s_cmp_lg_u32 s58, 0
  s_cbranch_scc1 ALT_8
  buffer_store_dword v31, v5, s[8:11], s65 offen
ALTB_8:
  s_waitcnt lgkmcnt(3)
  v_mfma_f32_32x32x16_bf16 v[96:111], a[208:211], v[240:243], v[96:111]
  buffer_load_dwordx4 v[168:171], v1, s[8:11], s73 offen offset:1024 sc1
  s_waitcnt lgkmcnt(2)
  v_mfma_f32_32x32x16_bf16 v[96:111], a[212:215], v[244:247], v[96:111]
  s_waitcnt lgkmcnt(1)
  v_mfma_f32_32x32x16_bf16 v[96:111], a[216:219], v[248:251], v[96:111]
  s_add_u32 s62, s73, 0x1c000
  buffer_load_dwordx4 v[172:175], v1, s[8:11], s62 offen offset:1024 sc1
  s_waitcnt lgkmcnt(0)
  v_mfma_f32_32x32x16_bf16 v[96:111], a[220:223], v[252:255], v[96:111]
  v_add_u32 v27, 0x0, v15
  v_mfma_f32_32x32x16_bf16 v[64:79], a[0:3], v[128:131], 0
  v_mfma_f32_32x32x16_bf16 v[80:95], a[4:7], v[128:131], 0
  s_nop 8
  v_max_f32 v96, 0, v96
  v_max_f32 v97, 0, v97
  v_max_f32 v98, 0, v98
  buffer_load_dwordx4 v[176:179], v1, s[8:11], s74 offen offset:1024 sc1
  v_mfma_f32_32x32x16_bf16 v[64:79], a[48:51], v[132:135], v[64:79]
  v_max_f32 v99, 0, v99
  v_max_f32 v100, 0, v100
  v_max_f32 v101, 0, v101
  v_mfma_f32_32x32x16_bf16 v[80:95], a[52:55], v[132:135], v[80:95]
  v_max_f32 v102, 0, v102
  v_max_f32 v103, 0, v103
  v_mul_f32 v96, v96, v104
  s_add_u32 s62, s74, 0x1c000
  buffer_load_dwordx4 v[180:183], v1, s[8:11], s62 offen offset:1024 sc1
  v_mfma_f32_32x32x16_bf16 v[64:79], a[96:99], v[136:139], v[64:79]
  v_mul_f32 v97, v97, v105
  v_mul_f32 v98, v98, v106
  v_mul_f32 v99, v99, v107
  v_mfma_f32_32x32x16_bf16 v[80:95], a[100:103], v[136:139], v[80:95]
  v_mul_f32 v100, v100, v108
  v_mul_f32 v101, v101, v109
  v_mul_f32 v102, v102, v110
  buffer_load_dwordx4 v[184:187], v1, s[8:11], s75 offen offset:1024 sc1
  s_waitcnt vmcnt(12)
  v_mfma_f32_32x32x16_bf16 v[64:79], a[144:147], v[140:143], v[64:79]
  v_mul_f32 v103, v103, v111
  v_cvt_pk_bf16_f32 v104, v96, v97
  v_cvt_pk_bf16_f32 v105, v98, v99
  v_mfma_f32_32x32x16_bf16 v[80:95], a[148:151], v[140:143], v[80:95]
  v_cvt_pk_bf16_f32 v106, v100, v101
  v_cvt_pk_bf16_f32 v107, v102, v103
  buffer_store_dwordx4 v[104:107], v1, s[8:11], s64 offen offset:2048 sc1
  s_add_u32 s62, s75, 0x1c000
  buffer_load_dwordx4 v[188:191], v1, s[8:11], s62 offen offset:1024 sc1
  s_waitcnt vmcnt(13)
  v_mfma_f32_32x32x16_bf16 v[96:111], a[0:3], v[144:147], 0
  v_mfma_f32_32x32x16_bf16 v[112:127], a[4:7], v[144:147], 0
  buffer_load_dwordx4 v[192:195], v1, s[8:11], s72 offen offset:2048 sc1
  s_waitcnt vmcnt(13)
  v_mfma_f32_32x32x16_bf16 v[96:111], a[48:51], v[148:151], v[96:111]
  v_mfma_f32_32x32x16_bf16 v[112:127], a[52:55], v[148:151], v[112:127]
  s_add_u32 s62, s72, 0x1c000
  buffer_load_dwordx4 v[196:199], v1, s[8:11], s62 offen offset:2048 sc1
  s_waitcnt vmcnt(13)
  v_mfma_f32_32x32x16_bf16 v[96:111], a[96:99], v[152:155], v[96:111]
  v_mfma_f32_32x32x16_bf16 v[112:127], a[100:103], v[152:155], v[112:127]
  buffer_load_dwordx4 v[200:203], v1, s[8:11], s73 offen offset:2048 sc1
  s_waitcnt vmcnt(13)
  v_mfma_f32_32x32x16_bf16 v[96:111], a[144:147], v[156:159], v[96:111]
  v_mfma_f32_32x32x16_bf16 v[112:127], a[148:151], v[156:159], v[112:127]
  s_add_u32 s62, s73, 0x1c000
  buffer_load_dwordx4 v[204:207], v1, s[8:11], s62 offen offset:2048 sc1
  s_waitcnt vmcnt(13)
  v_mfma_f32_32x32x16_bf16 v[64:79], a[8:11], v[160:163], v[64:79]
  v_mfma_f32_32x32x16_bf16 v[80:95], a[12:15], v[160:163], v[80:95]
  buffer_load_dwordx4 v[208:211], v1, s[8:11], s74 offen offset:2048 sc1
  s_waitcnt vmcnt(13)
  v_mfma_f32_32x32x16_bf16 v[96:111], a[8:11], v[164:167], v[96:111]
  v_mfma_f32_32x32x16_bf16 v[112:127], a[12:15], v[164:167], v[112:127]
  s_add_u32 s62, s74, 0x1c000
  buffer_load_dwordx4 v[212:215], v1, s[8:11], s62 offen offset:2048 sc1
  s_waitcnt vmcnt(12)
  v_mfma_f32_32x32x16_bf16 v[64:79], a[56:59], v[168:171], v[64:79]
  v_mfma_f32_32x32x16_bf16 v[80:95], a[60:63], v[168:171], v[80:95]
  buffer_load_dword v26, v4, s[8:11], s66 offen sc1
  buffer_load_dwordx4 v[216:219], v1, s[8:11], s75 offen offset:2048 sc1
  s_add_u32 s67, s80, 0x3000
  buffer_load_dwordx4 a[192:195], v1, s[8:11], s67 offen sc1
  s_waitcnt vmcnt(14)
  v_mfma_f32_32x32x16_bf16 v[96:111], a[56:59], v[172:175], v[96:111]
  v_mfma_f32_32x32x16_bf16 v[112:127], a[60:63], v[172:175], v[112:127]
  s_add_u32 s62, s75, 0x1c000
  buffer_load_dwordx4 v[220:223], v1, s[8:11], s62 offen offset:2048 sc1
  s_waitcnt vmcnt(14)
  v_mfma_f32_32x32x16_bf16 v[64:79], a[104:107], v[176:179], v[64:79]
  v_mfma_f32_32x32x16_bf16 v[80:95], a[108:111], v[176:179], v[80:95]
  buffer_load_dwordx4 v[224:227], v1, s[8:11], s72 offen offset:3072 sc1
  s_waitcnt vmcnt(14)
  v_mfma_f32_32x32x16_bf16 v[96:111], a[104:107], v[180:183], v[96:111]
  v_mfma_f32_32x32x16_bf16 v[112:127], a[108:111], v[180:183], v[112:127]
  s_add_u32 s62, s72, 0x1c000
  buffer_load_dwordx4 v[228:231], v1, s[8:11], s62 offen offset:3072 sc1
  s_waitcnt vmcnt(14)
  v_mfma_f32_32x32x16_bf16 v[64:79], a[152:155], v[184:187], v[64:79]
  v_mfma_f32_32x32x16_bf16 v[80:95], a[156:159], v[184:187], v[80:95]
  buffer_load_dwordx4 v[232:235], v1, s[8:11], s73 offen offset:3072 sc1
  s_waitcnt vmcnt(13)
  v_mfma_f32_32x32x16_bf16 v[96:111], a[152:155], v[188:191], v[96:111]
  v_mfma_f32_32x32x16_bf16 v[112:127], a[156:159], v[188:191], v[112:127]
  s_add_u32 s62, s73, 0x1c000
  buffer_load_dwordx4 v[236:239], v1, s[8:11], s62 offen offset:3072 sc1
  buffer_load_dwordx4 a[196:199], v1, s[8:11], s67 offen offset:1024 sc1
  s_waitcnt vmcnt(14)
  v_mfma_f32_32x32x16_bf16 v[64:79], a[16:19], v[192:195], v[64:79]
  v_mfma_f32_32x32x16_bf16 v[80:95], a[20:23], v[192:195], v[80:95]
  buffer_load_dwordx4 v[240:243], v1, s[8:11], s74 offen offset:3072 sc1
  s_waitcnt vmcnt(14)
  v_mfma_f32_32x32x16_bf16 v[96:111], a[16:19], v[196:199], v[96:111]
  v_mfma_f32_32x32x16_bf16 v[112:127], a[20:23], v[196:199], v[112:127]
  s_add_u32 s70, s31, 7
  v_mov_b32 v31, s70
  s_cmp_lg_u32 s58, 0
  s_cbranch_scc1 ALT_9
  buffer_store_dword v31, v5, s[8:11], s65 offen
ALTB_9:
  s_add_u32 s62, s74, 0x1c000
  buffer_load_dwordx4 v[244:247], v1, s[8:11], s62 offen offset:3072 sc1
  s_waitcnt vmcnt(15)
  v_mfma_f32_32x32x16_bf16 v[64:79], a[64:67], v[200:203], v[64:79]
  v_mfma_f32_32x32x16_bf16 v[80:95], a[68:71], v[200:203], v[80:95]
  buffer_load_dwordx4 v[248:251], v1, s[8:11], s75 offen offset:3072 sc1
  s_waitcnt vmcnt(15)
  v_mfma_f32_32x32x16_bf16 v[96:111], a[64:67], v[204:207], v[96:111]
  v_mfma_f32_32x32x16_bf16 v[112:127], a[68:71], v[204:207], v[112:127]
  s_add_u32 s62, s75, 0x1c000
  buffer_load_dwordx4 v[252:255], v1, s[8:11], s62 offen offset:3072 sc1
  s_waitcnt vmcnt(15)
  v_mfma_f32_32x32x16_bf16 v[64:79], a[112:115], v[208:211], v[64:79]
  v_mfma_f32_32x32x16_bf16 v[80:95], a[116:119], v[208:211], v[80:95]
  s_add_u32 s68, s31, 6
  s_waitcnt vmcnt(13)
  v_subrev_u32 v26, s68, v26
  v_cmp_lt_u32 vcc, 15, v26
  s_cbranch_vccz HC_14
  s_mov_b32 s69, 0
POLL_15:
  buffer_load_dword v26, v4, s[8:11], s66 offen sc1
  s_waitcnt vmcnt(0)
  s_add_u32 s68, s31, 6
  s_waitcnt vmcnt(0)
  v_subrev_u32 v26, s68, v26
  s_waitcnt vmcnt(0)
  v_cmp_lt_u32 vcc, 15, v26
  s_cbranch_vccz PD_16
  s_add_u32 s69, s69, 1
  s_cmp_lt_u32 s69, s33
  s_cbranch_scc1 POLL_15
  s_mov_b32 s33, 1
PD_16:
HC_14:
  s_add_u32 s60, s72, 0x1000
  buffer_load_dwordx4 v[128:131], v1, s[8:11], s60 offen sc1
  s_add_u32 s67, s81, 0x3000
  buffer_load_dwordx4 a[200:203], v1, s[8:11], s67 offen sc1
  v_mfma_f32_32x32x16_bf16 v[96:111], a[112:115], v[212:215], v[96:111]
  v_mfma_f32_32x32x16_bf16 v[112:127], a[116:119], v[212:215], v[112:127]
  s_add_u32 s62, s72, 0x1d000
  buffer_load_dwordx4 v[132:135], v1, s[8:11], s62 offen sc1
  s_waitcnt vmcnt(15)
  v_mfma_f32_32x32x16_bf16 v[64:79], a[160:163], v[216:219], v[64:79]
  v_mfma_f32_32x32x16_bf16 v[80:95], a[164:167], v[216:219], v[80:95]
  s_add_u32 s60, s73, 0x1000
  buffer_load_dwordx4 v[136:139], v1, s[8:11], s60 offen sc1
  s_waitcnt vmcnt(14)
  v_mfma_f32_32x32x16_bf16 v[96:111], a[160:163], v[220:223], v[96:111]
  v_mfma_f32_32x32x16_bf16 v[112:127], a[164:167], v[220:223], v[112:127]
  s_add_u32 s62, s73, 0x1d000
  buffer_load_dwordx4 v[140:143], v1, s[8:11], s62 offen sc1
  s_waitcnt vmcnt(14)
  v_mfma_f32_32x32x16_bf16 v[64:79], a[24:27], v[224:227], v[64:79]
  v_mfma_f32_32x32x16_bf16 v[80:95], a[28:31], v[224:227], v[80:95]
  s_add_u32 s60, s74, 0x1000
  buffer_load_dwordx4 v[144:147], v1, s[8:11], s60 offen sc1
  s_waitcnt vmcnt(14)
  v_mfma_f32_32x32x16_bf16 v[96:111], a[24:27], v[228:231], v[96:111]
  v_mfma_f32_32x32x16_bf16 v[112:127], a[28:31], v[228:231], v[112:127]
  s_add_u32 s62, s74, 0x1d000
  buffer_load_dwordx4 v[148:151], v1, s[8:11], s62 offen sc1
  buffer_load_dwordx4 a[204:207], v1, s[8:11], s67 offen offset:1024 sc1
  s_waitcnt vmcnt(15)
  v_mfma_f32_32x32x16_bf16 v[64:79], a[72:75], v[232:235], v[64:79]
  v_mfma_f32_32x32x16_bf16 v[80:95], a[76:79], v[232:235], v[80:95]
  buffer_load_dword v26, v4, s[8:11], s66 offen sc1
  s_add_u32 s60, s75, 0x1000
  buffer_load_dwordx4 v[152:155], v1, s[8:11], s60 offen sc1
  s_waitcnt vmcnt(16)
  v_mfma_f32_32x32x16_bf16 v[96:111], a[72:75], v[236:239], v[96:111]
  v_mfma_f32_32x32x16_bf16 v[112:127], a[76:79], v[236:239], v[112:127]
  s_add_u32 s62, s75, 0x1d000
  buffer_load_dwordx4 v[156:159], v1, s[8:11], s62 offen sc1
  s_waitcnt vmcnt(15)
  v_mfma_f32_32x32x16_bf16 v[64:79], a[120:123], v[240:243], v[64:79]
  v_mfma_f32_32x32x16_bf16 v[80:95], a[124:127], v[240:243], v[80:95]
  s_add_u32 s60, s72, 0x1000
  buffer_load_dwordx4 v[160:163], v1, s[8:11], s60 offen offset:1024 sc1
  s_waitcnt vmcnt(14)
  v_mfma_f32_32x32x16_bf16 v[96:111], a[120:123], v[244:247], v[96:111]
  v_mfma_f32_32x32x16_bf16 v[112:127], a[124:127], v[244:247], v[112:127]
  s_add_u32 s62, s72, 0x1d000
  buffer_load_dwordx4 v[164:167], v1, s[8:11], s62 offen offset:1024 sc1
  s_waitcnt vmcnt(14)
  v_mfma_f32_32x32x16_bf16 v[64:79], a[168:171], v[248:251], v[64:79]
  v_mfma_f32_32x32x16_bf16 v[80:95], a[172:175], v[248:251], v[80:95]
  s_add_u32 s60, s73, 0x1000
  buffer_load_dwordx4 v[168:171], v1, s[8:11], s60 offen offset:1024 sc1
  s_add_u32 s67, s82, 0x3000
  buffer_load_dwordx4 a[208:211], v1, s[8:11], s67 offen sc1
  s_waitcnt vmcnt(15)
  v_mfma_f32_32x32x16_bf16 v[96:111], a[168:171], v[252:255], v[96:111]
  v_mfma_f32_32x32x16_bf16 v[112:127], a[172:175], v[252:255], v[112:127]
  s_branch PGS6
.p2align 12
PG6:
  s_branch PG10
PGS6:
  s_add_u32 s62, s73, 0x1d000
  buffer_load_dwordx4 v[172:175], v1, s[8:11], s62 offen offset:1024 sc1
  s_waitcnt vmcnt(15)
  v_mfma_f32_32x32x16_bf16 v[64:79], a[32:35], v[128:131], v[64:79]
  v_mfma_f32_32x32x16_bf16 v[80:95], a[36:39], v[128:131], v[80:95]
  s_add_u32 s60, s74, 0x1000
  buffer_load_dwordx4 v[176:179], v1, s[8:11], s60 offen offset:1024 sc1
  s_waitcnt vmcnt(14)
  v_mfma_f32_32x32x16_bf16 v[96:111], a[32:35], v[132:135], v[96:111]
  v_mfma_f32_32x32x16_bf16 v[112:127], a[36:39], v[132:135], v[112:127]
  s_add_u32 s62, s74, 0x1d000
  buffer_load_dwordx4 v[180:183], v1, s[8:11], s62 offen offset:1024 sc1
  s_waitcnt vmcnt(14)
  v_mfma_f32_32x32x16_bf16 v[64:79], a[80:83], v[136:139], v[64:79]
  v_mfma_f32_32x32x16_bf16 v[80:95], a[84:87], v[136:139], v[80:95]
  s_add_u32 s60, s75, 0x1000
  buffer_load_dwordx4 v[184:187], v1, s[8:11], s60 offen offset:1024 sc1
  s_waitcnt vmcnt(14)
  v_mfma_f32_32x32x16_bf16 v[96:111], a[80:83], v[140:143], v[96:111]
  v_mfma_f32_32x32x16_bf16 v[112:127], a[84:87], v[140:143], v[112:127]
  s_add_u32 s62, s75, 0x1d000
  buffer_load_dwordx4 v[188:191], v1, s[8:11], s62 offen offset:1024 sc1
  buffer_load_dwordx4 a[212:215], v1, s[8:11], s67 offen offset:1024 sc1
  s_waitcnt vmcnt(15)
  v_mfma_f32_32x32x16_bf16 v[64:79], a[128:131], v[144:147], v[64:79]
  v_mfma_f32_32x32x16_bf16 v[80:95], a[132:135], v[144:147], v[80:95]
  s_add_u32 s68, s31, 7
  s_waitcnt vmcnt(12)
  v_subrev_u32 v26, s68, v26
  v_cmp_lt_u32 vcc, 15, v26
  s_cbranch_vccz HC_17
  s_mov_b32 s69, 0
POLL_18:
  buffer_load_dword v26, v4, s[8:11], s66 offen sc1
  s_waitcnt vmcnt(0)
  s_add_u32 s68, s31, 7
  s_waitcnt vmcnt(0)
  v_subrev_u32 v26, s68, v26
  s_waitcnt vmcnt(0)
  v_cmp_lt_u32 vcc, 15, v26
  s_cbranch_vccz PD_19
  s_add_u32 s69, s69, 1
  s_cmp_lt_u32 s69, s33
  s_cbranch_scc1 POLL_18
  s_mov_b32 s33, 1
PD_19:
HC_17:
  s_add_u32 s60, s72, 0x1000
  buffer_load_dwordx4 v[192:195], v1, s[8:11], s60 offen offset:2048 sc1
  v_mfma_f32_32x32x16_bf16 v[96:111], a[128:131], v[148:151], v[96:111]
  v_mfma_f32_32x32x16_bf16 v[112:127], a[132:135], v[148:151], v[112:127]
  s_add_u32 s60, s73, 0x1000
  buffer_load_dwordx4 v[196:199], v1, s[8:11], s60 offen offset:2048 sc1
  s_waitcnt vmcnt(13)
  v_mfma_f32_32x32x16_bf16 v[64:79], a[176:179], v[152:155], v[64:79]
  v_mfma_f32_32x32x16_bf16 v[80:95], a[180:183], v[152:155], v[80:95]
  s_add_u32 s60, s74, 0x1000
  buffer_load_dwordx4 v[200:203], v1, s[8:11], s60 offen offset:2048 sc1
  s_waitcnt vmcnt(13)
  v_mfma_f32_32x32x16_bf16 v[96:111], a[176:179], v[156:159], v[96:111]
  v_mfma_f32_32x32x16_bf16 v[112:127], a[180:183], v[156:159], v[112:127]
  s_add_u32 s60, s75, 0x1000
  buffer_load_dwordx4 v[204:207], v1, s[8:11], s60 offen offset:2048 sc1
  s_waitcnt vmcnt(13)
  v_mfma_f32_32x32x16_bf16 v[64:79], a[40:43], v[160:163], v[64:79]
  v_mfma_f32_32x32x16_bf16 v[80:95], a[44:47], v[160:163], v[80:95]
  s_barrier
  s_add_u32 s62, s72, 0x1d000
  buffer_load_dwordx4 v[208:211], v1, s[8:11], s62 offen offset:2048 sc1
  s_add_u32 s67, s83, 0x3000
  buffer_load_dwordx4 a[216:219], v1, s[8:11], s67 offen sc1
  s_waitcnt vmcnt(14)
  v_mfma_f32_32x32x16_bf16 v[96:111], a[40:43], v[164:167], v[96:111]
  v_mfma_f32_32x32x16_bf16 v[112:127], a[44:47], v[164:167], v[112:127]
  s_add_u32 s62, s73, 0x1d000
  buffer_load_dwordx4 v[212:215], v1, s[8:11], s62 offen offset:2048 sc1
  s_waitcnt vmcnt(14)
  v_mfma_f32_32x32x16_bf16 v[64:79], a[88:91], v[168:171], v[64:79]
  v_mfma_f32_32x32x16_bf16 v[80:95], a[92:95], v[168:171], v[80:95]
  s_add_u32 s62, s74, 0x1d000
  buffer_load_dwordx4 v[216:219], v1, s[8:11], s62 offen offset:2048 sc1
  s_waitcnt vmcnt(13)
  v_mfma_f32_32x32x16_bf16 v[96:111], a[88:91], v[172:175], v[96:111]
  v_mfma_f32_32x32x16_bf16 v[112:127], a[92:95], v[172:175], v[112:127]
  s_add_u32 s62, s75, 0x1d000
  buffer_load_dwordx4 v[220:223], v1, s[8:11], s62 offen offset:2048 sc1
  s_waitcnt vmcnt(13)
  v_mfma_f32_32x32x16_bf16 v[64:79], a[136:139], v[176:179], v[64:79]
  v_mfma_f32_32x32x16_bf16 v[80:95], a[140:143], v[176:179], v[80:95]
  s_waitcnt vmcnt(12)
  v_mfma_f32_32x32x16_bf16 v[96:111], a[136:139], v[180:183], v[96:111]
  v_mfma_f32_32x32x16_bf16 v[112:127], a[140:143], v[180:183], v[112:127]
  buffer_load_dwordx4 a[220:223], v1, s[8:11], s67 offen offset:1024 sc1
  s_waitcnt vmcnt(12)
  v_mfma_f32_32x32x16_bf16 v[64:79], a[184:187], v[184:187], v[64:79]
  v_mfma_f32_32x32x16_bf16 v[80:95], a[188:191], v[184:187], v[80:95]
  s_waitcnt vmcnt(11)
  v_mfma_f32_32x32x16_bf16 v[96:111], a[184:187], v[188:191], v[96:111]
  v_mfma_f32_32x32x16_bf16 v[112:127], a[188:191], v[188:191], v[112:127]
  s_waitcnt vmcnt(9)
  v_mfma_f32_32x32x16_bf16 v[64:79], a[192:195], v[192:195], v[64:79]
  v_mfma_f32_32x32x16_bf16 v[80:95], a[196:199], v[192:195], v[80:95]
  s_waitcnt vmcnt(8)
  v_mfma_f32_32x32x16_bf16 v[64:79], a[200:203], v[196:199], v[64:79]
  v_mfma_f32_32x32x16_bf16 v[80:95], a[204:207], v[196:199], v[80:95]
  s_waitcnt vmcnt(7)
  v_mfma_f32_32x32x16_bf16 v[64:79], a[208:211], v[200:203], v[64:79]
  v_mfma_f32_32x32x16_bf16 v[80:95], a[212:215], v[200:203], v[80:95]
  s_waitcnt vmcnt(4)
  v_mfma_f32_32x32x16_bf16 v[64:79], a[216:219], v[204:207], v[64:79]
  s_waitcnt vmcnt(0)
  v_mfma_f32_32x32x16_bf16 v[80:95], a[220:223], v[204:207], v[80:95]
  v_mfma_f32_32x32x16_bf16 v[96:111], a[192:195], v[208:211], v[96:111]
  v_mfma_f32_32x32x16_bf16 v[96:111], a[200:203], v[212:215], v[96:111]
  s_nop 7
  v_cvt_pk_bf16_f32 v64, v64, v65
  v_cvt_pk_bf16_f32 v65, v66, v67
  v_cvt_pk_bf16_f32 v66, v68, v69
  v_cvt_pk_bf16_f32 v67, v70, v71
  ds_write_b128 v27, v[64:67] offset:0
  v_mfma_f32_32x32x16_bf16 v[96:111], a[208:211], v[216:219], v[96:111]
  v_cvt_pk_bf16_f32 v72, v72, v73
  v_cvt_pk_bf16_f32 v73, v74, v75
  v_cvt_pk_bf16_f32 v74, v76, v77
  v_cvt_pk_bf16_f32 v75, v78, v79
  ds_write_b128 v27, v[72:75] offset:512
  v_mfma_f32_32x32x16_bf16 v[96:111], a[216:219], v[220:223], v[96:111]
  v_cvt_pk_bf16_f32 v80, v80, v81
  v_cvt_pk_bf16_f32 v81, v82, v83
  v_cvt_pk_bf16_f32 v82, v84, v85
  v_cvt_pk_bf16_f32 v83, v86, v87
  ds_write_b128 v27, v[80:83] offset:1024
  v_mfma_f32_32x32x16_bf16 v[112:127], a[196:199], v[208:211], v[112:127]
  v_cvt_pk_bf16_f32 v88, v88, v89
  v_cvt_pk_bf16_f32 v89, v90, v91
  v_cvt_pk_bf16_f32 v90, v92, v93
  v_cvt_pk_bf16_f32 v91, v94, v95
  ds_write_b128 v27, v[88:91] offset:1536
  v_mfma_f32_32x32x16_bf16 v[112:127], a[204:207], v[212:215], v[112:127]
  v_cvt_pk_bf16_f32 v96, v96, v97
  v_cvt_pk_bf16_f32 v97, v98, v99
  v_cvt_pk_bf16_f32 v98, v100, v101
  v_cvt_pk_bf16_f32 v99, v102, v103
  v_mfma_f32_32x32x16_bf16 v[112:127], a[212:215], v[216:219], v[112:127]
  ds_write_b128 v27, v[96:99] offset:16384
  v_cvt_pk_bf16_f32 v104, v104, v105
  v_cvt_pk_bf16_f32 v105, v106, v107
  v_mfma_f32_32x32x16_bf16 v[112:127], a[220:223], v[220:223], v[112:127]
  v_cvt_pk_bf16_f32 v106, v108, v109
  v_cvt_pk_bf16_f32 v107, v110, v111
  ds_write_b128 v27, v[104:107] offset:16896
  s_nop 8
  v_cvt_pk_bf16_f32 v112, v112, v113
  v_cvt_pk_bf16_f32 v113, v114, v115
  v_cvt_pk_bf16_f32 v114, v116, v117
  v_cvt_pk_bf16_f32 v115, v118, v119
  ds_write_b128 v27, v[112:115] offset:17408
  v_cvt_pk_bf16_f32 v120, v120, v121
  v_cvt_pk_bf16_f32 v121, v122, v123
  v_cvt_pk_bf16_f32 v122, v124, v125
  v_cvt_pk_bf16_f32 v123, v126, v127
  ds_write_b128 v27, v[120:123] offset:17920
  s_add_u32 s63, s52, 0x0
  v_add_u32 v26, s63, v1
  s_waitcnt lgkmcnt(0)
  s_barrier
  ds_read_b32 v28, v19
  ds_read_b128 v[192:195], v26 offset:0
  ds_read_b128 v[196:199], v26 offset:2048
  ds_read_b128 v[200:203], v26 offset:4096
  ds_read_b128 v[204:207], v26 offset:6144
  ds_read_b128 v[208:211], v26 offset:1024
  ds_read_b128 v[212:215], v26 offset:3072
  ds_read_b128 v[216:219], v26 offset:5120
  ds_read_b128 v[220:223], v26 offset:7168
  s_waitcnt lgkmcnt(7)
  v_dot2_f32_bf16 v64, v192, s53, 0
  v_dot2_f32_bf16 v65, v192, s54, 0
  v_dot2_f32_bf16 v66, v193, s53, 0
  v_dot2_f32_bf16 v67, v193, s54, 0
  v_dot2_f32_bf16 v68, v194, s53, 0
  v_dot2_f32_bf16 v69, v194, s54, 0
  v_dot2_f32_bf16 v70, v195, s53, 0
  v_dot2_f32_bf16 v71, v195, s54, 0
  s_waitcnt lgkmcnt(6)
  v_dot2_f32_bf16 v64, v196, s53, v64
  v_dot2_f32_bf16 v65, v196, s54, v65
  v_dot2_f32_bf16 v66, v197, s53, v66
  v_dot2_f32_bf16 v67, v197, s54, v67
  v_dot2_f32_bf16 v68, v198, s53, v68
  v_dot2_f32_bf16 v69, v198, s54, v69
  v_dot2_f32_bf16 v70, v199, s53, v70
  v_dot2_f32_bf16 v71, v199, s54, v71
  s_waitcnt lgkmcnt(5)
  v_dot2_f32_bf16 v64, v200, s53, v64
  v_dot2_f32_bf16 v65, v200, s54, v65
  v_dot2_f32_bf16 v66, v201, s53, v66
  v_dot2_f32_bf16 v67, v201, s54, v67
  v_dot2_f32_bf16 v68, v202, s53, v68
  v_dot2_f32_bf16 v69, v202, s54, v69
  v_dot2_f32_bf16 v70, v203, s53, v70
  v_dot2_f32_bf16 v71, v203, s54, v71
  s_waitcnt lgkmcnt(4)
  v_dot2_f32_bf16 v64, v204, s53, v64
  v_dot2_f32_bf16 v65, v204, s54, v65
  v_dot2_f32_bf16 v66, v205, s53, v66
  v_dot2_f32_bf16 v67, v205, s54, v67
  v_dot2_f32_bf16 v68, v206, s53, v68
  v_dot2_f32_bf16 v69, v206, s54, v69
  v_dot2_f32_bf16 v70, v207, s53, v70
  v_dot2_f32_bf16 v71, v207, s54, v71
  v_pk_fma_f32 v[32:33], v[64:65], v[28:29], v[32:33] op_sel_hi:[1,0,1]
  v_pk_fma_f32 v[34:35], v[66:67], v[28:29], v[34:35] op_sel_hi:[1,0,1]
  v_pk_fma_f32 v[36:37], v[68:69], v[28:29], v[36:37] op_sel_hi:[1,0,1]
  v_pk_fma_f32 v[38:39], v[70:71], v[28:29], v[38:39] op_sel_hi:[1,0,1]
  v_cvt_pk_bf16_f32 v48, v32, v33
  v_cvt_pk_bf16_f32 v49, v34, v35
  v_cvt_pk_bf16_f32 v50, v36, v37
  v_cvt_pk_bf16_f32 v51, v38, v39
  s_add_u32 s60, s40, 0x200000
  s_cmp_lg_u32 s58, 0
  s_cbranch_scc1 ALT_10
  buffer_store_dwordx4 v[48:51], v7, s[8:11], s60 offen
ALTB_10:
  s_waitcnt lgkmcnt(3)
  v_dot2_f32_bf16 v72, v208, s53, 0
  v_dot2_f32_bf16 v73, v208, s54, 0
  v_dot2_f32_bf16 v74, v209, s53, 0
  v_dot2_f32_bf16 v75, v209, s54, 0
  v_dot2_f32_bf16 v76, v210, s53, 0
  v_dot2_f32_bf16 v77, v210, s54, 0
  v_dot2_f32_bf16 v78, v211, s53, 0
  v_dot2_f32_bf16 v79, v211, s54, 0
  s_waitcnt lgkmcnt(2)
  v_dot2_f32_bf16 v72, v212, s53, v72
  v_dot2_f32_bf16 v73, v212, s54, v73
  v_dot2_f32_bf16 v74, v213, s53, v74
  v_dot2_f32_bf16 v75, v213, s54, v75
  v_dot2_f32_bf16 v76, v214, s53, v76
  v_dot2_f32_bf16 v77, v214, s54, v77
  v_dot2_f32_bf16 v78, v215, s53, v78
  v_dot2_f32_bf16 v79, v215, s54, v79
  s_waitcnt lgkmcnt(1)
  v_dot2_f32_bf16 v72, v216, s53, v72
  v_dot2_f32_bf16 v73, v216, s54, v73
  v_dot2_f32_bf16 v74, v217, s53, v74
  v_dot2_f32_bf16 v75, v217, s54, v75
  v_dot2_f32_bf16 v76, v218, s53, v76
  v_dot2_f32_bf16 v77, v218, s54, v77
  v_dot2_f32_bf16 v78, v219, s53, v78
  v_dot2_f32_bf16 v79, v219, s54, v79
  s_waitcnt lgkmcnt(0)
  v_dot2_f32_bf16 v72, v220, s53, v72
  v_dot2_f32_bf16 v73, v220, s54, v73
  v_dot2_f32_bf16 v74, v221, s53, v74
  v_dot2_f32_bf16 v75, v221, s54, v75
  v_dot2_f32_bf16 v76, v222, s53, v76
  v_dot2_f32_bf16 v77, v222, s54, v77
  v_dot2_f32_bf16 v78, v223, s53, v78
  v_dot2_f32_bf16 v79, v223, s54, v79
  v_pk_fma_f32 v[40:41], v[72:73], v[28:29], v[40:41] op_sel_hi:[1,0,1]
  v_pk_fma_f32 v[42:43], v[74:75], v[28:29], v[42:43] op_sel_hi:[1,0,1]
  v_pk_fma_f32 v[44:45], v[76:77], v[28:29], v[44:45] op_sel_hi:[1,0,1]
  v_pk_fma_f32 v[46:47], v[78:79], v[28:29], v[46:47] op_sel_hi:[1,0,1]
  v_cvt_pk_bf16_f32 v52, v40, v41
  v_cvt_pk_bf16_f32 v53, v42, v43
  v_cvt_pk_bf16_f32 v54, v44, v45
  v_cvt_pk_bf16_f32 v55, v46, v47
  s_cmp_lg_u32 s58, 0
  s_cbranch_scc1 ALT_11
  buffer_store_dwordx4 v[52:55], v7, s[8:11], s60 offen offset:2048
ALTB_11:
  v_dot2_f32_bf16 v28, v48, s55, 0
  v_dot2_f32_bf16 v29, v48, v48, 0
  v_dot2_f32_bf16 v28, v49, s55, v28
  v_dot2_f32_bf16 v29, v49, v49, v29
  v_dot2_f32_bf16 v28, v50, s55, v28
  v_dot2_f32_bf16 v29, v50, v50, v29
  v_dot2_f32_bf16 v28, v51, s55, v28
  v_dot2_f32_bf16 v29, v51, v51, v29
  v_dot2_f32_bf16 v28, v52, s55, v28
  v_dot2_f32_bf16 v29, v52, v52, v29
  v_dot2_f32_bf16 v28, v53, s55, v28
  v_dot2_f32_bf16 v29, v53, v53, v29
  v_dot2_f32_bf16 v28, v54, s55, v28
  v_dot2_f32_bf16 v29, v54, v54, v29
  v_dot2_f32_bf16 v28, v55, s55, v28
  v_dot2_f32_bf16 v29, v55, v55, v29
  s_nop 2
  v_permlane32_swap_b32 v28, v29
  v_add_f32 v28, v28, v29
  v_mov_b32 v29, v28
  s_nop 1
  v_permlane16_swap_b32 v28, v29
  v_add_f32 v28, v28, v29
  s_add_u32 s60, s42, 0x20000
  s_cmp_lg_u32 s58, 0
  s_cbranch_scc1 ALT_12
  buffer_store_dword v28, v17, s[8:11], s60 offen
ALTB_12:
  ds_write_b128 v26, a[224:227] offset:0
  ds_write_b128 v26, a[228:231] offset:1024
  ds_write_b128 v26, a[232:235] offset:2048
  ds_write_b128 v26, a[236:239] offset:3072
  ds_write_b128 v26, a[240:243] offset:4096
  ds_write_b128 v26, a[244:247] offset:5120
  ds_write_b128 v26, a[248:251] offset:6144
  ds_write_b128 v26, a[252:255] offset:7168
  s_waitcnt vmcnt(0)
  s_add_u32 s70, s31, 2
  v_mov_b32 v31, s70
  s_cmp_lg_u32 s58, 0
  s_cbranch_scc1 ALT_13
  buffer_store_dword v31, v5, s[8:11], s46 offen
ALTB_13:
  s_lshl_b32 s62, s30, 12
  s_add_u32 s62, s62, s38
  s_add_u32 s62, s62, 0x200000
  s_mov_b32 s69, 0
POLL_20:
  buffer_load_dword v26, v3, s[8:11], s45 offen sc1
  s_waitcnt vmcnt(0)
  s_add_u32 s68, s31, 2
  v_subrev_u32 v26, s68, v26
  v_cmp_lt_u32 vcc, 15, v26
  s_cbranch_vccz PD_21
  s_add_u32 s69, s69, 1
  s_cmp_lt_u32 s69, s33
  s_cbranch_scc1 POLL_20
  s_mov_b32 s33, 1
PD_21:
  buffer_load_dwordx4 v[128:131], v1, s[8:11], s62 offen offset:0 sc1
  buffer_load_dwordx4 v[132:135], v1, s[8:11], s62 offen offset:1024 sc1
  buffer_load_dwordx4 v[136:139], v1, s[8:11], s62 offen offset:2048 sc1
  buffer_load_dwordx4 v[140:143], v1, s[8:11], s62 offen offset:3072 sc1
  s_xor_b32 s62, s62, 0x1000
  buffer_load_dwordx4 v[144:147], v1, s[8:11], s62 offen offset:0 sc1
  buffer_load_dwordx4 v[148:151], v1, s[8:11], s62 offen offset:1024 sc1
  buffer_load_dwordx4 v[152:155], v1, s[8:11], s62 offen offset:2048 sc1
  buffer_load_dwordx4 v[156:159], v1, s[8:11], s62 offen offset:3072 sc1
  s_waitcnt lgkmcnt(0)
  s_barrier
  ds_read_b128 a[224:227], v1 offset:32768
  ds_read_b128 a[228:231], v1 offset:0
  ds_read_b128 a[232:235], v1 offset:33792
  ds_read_b128 a[236:239], v1 offset:1024
  ds_read_b128 a[240:243], v1 offset:34816
  ds_read_b128 a[244:247], v1 offset:2048
  s_waitcnt vmcnt(7) lgkmcnt(5)
  v_mfma_f32_32x32x16_bf16 v[80:95], a[224:227], v[128:131], 0
  s_xor_b32 s62, s62, 0x3000
  buffer_load_dwordx4 v[160:163], v1, s[8:11], s62 offen offset:0 sc1
  ds_read_b128 a[248:251], v1 offset:35840
  s_waitcnt lgkmcnt(5)
  v_mfma_f32_32x32x16_bf16 v[64:79], a[228:231], v[128:131], 0
  buffer_load_dwordx4 v[164:167], v1, s[8:11], s62 offen offset:1024 sc1
  ds_read_b128 a[252:255], v1 offset:3072
  s_waitcnt vmcnt(8) lgkmcnt(5)
  v_mfma_f32_32x32x16_bf16 v[80:95], a[232:235], v[132:135], v[80:95]
  ds_read_b128 a[224:227], v1 offset:36864
  s_waitcnt lgkmcnt(5)
  v_mfma_f32_32x32x16_bf16 v[64:79], a[236:239], v[132:135], v[64:79]
  buffer_load_dwordx4 v[168:171], v1, s[8:11], s62 offen offset:2048 sc1
  ds_read_b128 a[228:231], v1 offset:4096
  s_waitcnt vmcnt(8) lgkmcnt(5)
  v_mfma_f32_32x32x16_bf16 v[80:95], a[240:243], v[136:139], v[80:95]
  ds_read_b128 a[232:235], v1 offset:37888
  s_waitcnt lgkmcnt(5)
  v_mfma_f32_32x32x16_bf16 v[64:79], a[244:247], v[136:139], v[64:79]
  buffer_load_dwordx4 v[172:175], v1, s[8:11], s62 offen offset:3072 sc1
  ds_read_b128 a[236:239], v1 offset:5120
  s_waitcnt vmcnt(8) lgkmcnt(5)
  v_mfma_f32_32x32x16_bf16 v[80:95], a[248:251], v[140:143], v[80:95]
  ds_read_b128 a[240:243], v1 offset:38912
  s_waitcnt lgkmcnt(5)
  v_mfma_f32_32x32x16_bf16 v[64:79], a[252:255], v[140:143], v[64:79]
  s_add_u32 s60, s41, 0x20000
  buffer_load_dwordx4 v[48:51], v1, s[8:11], s60 offen sc1
  ds_read_b128 a[244:247], v1 offset:6144
  s_waitcnt vmcnt(8) lgkmcnt(5)
  v_mfma_f32_32x32x16_bf16 v[80:95], a[224:227], v[144:147], v[80:95]
  ds_read_b128 a[248:251], v1 offset:39936
  s_waitcnt lgkmcnt(5)
  v_mfma_f32_32x32x16_bf16 v[64:79], a[228:231], v[144:147], v[64:79]
  buffer_load_dwordx4 v[52:55], v1, s[8:11], s60 offen offset:1024 sc1
  ds_read_b128 a[252:255], v1 offset:7168
  s_waitcnt vmcnt(8) lgkmcnt(5)
  v_mfma_f32_32x32x16_bf16 v[80:95], a[232:235], v[148:151], v[80:95]
  ds_read_b128 a[224:227], v1 offset:40960
  s_waitcnt lgkmcnt(5)
  v_mfma_f32_32x32x16_bf16 v[64:79], a[236:239], v[148:151], v[64:79]
  s_xor_b32 s62, s62, 0x1000
  buffer_load_dwordx4 v[176:179], v1, s[8:11], s62 offen offset:0 sc1
  ds_read_b128 a[228:231], v1 offset:8192
  s_waitcnt vmcnt(8) lgkmcnt(5)
  v_mfma_f32_32x32x16_bf16 v[80:95], a[240:243], v[152:155], v[80:95]
  buffer_load_dwordx4 v[180:183], v1, s[8:11], s62 offen offset:1024 sc1
  ds_read_b128 a[232:235], v1 offset:41984
  s_waitcnt lgkmcnt(5)
  v_mfma_f32_32x32x16_bf16 v[64:79], a[244:247], v[152:155], v[64:79]
  ds_read_b128 a[236:239], v1 offset:9216
  s_waitcnt vmcnt(8) lgkmcnt(5)
  v_mfma_f32_32x32x16_bf16 v[80:95], a[248:251], v[156:159], v[80:95]
  buffer_load_dwordx4 v[184:187], v1, s[8:11], s62 offen offset:2048 sc1
  ds_read_b128 a[240:243], v1 offset:43008
  s_waitcnt lgkmcnt(5)
  v_mfma_f32_32x32x16_bf16 v[64:79], a[252:255], v[156:159], v[64:79]
  ds_read_b128 a[244:247], v1 offset:10240
  s_waitcnt vmcnt(8) lgkmcnt(5)
  v_mfma_f32_32x32x16_bf16 v[80:95], a[224:227], v[160:163], v[80:95]
  buffer_load_dwordx4 v[188:191], v1, s[8:11], s62 offen offset:3072 sc1
  ds_read_b128 a[248:251], v1 offset:44032
  s_waitcnt lgkmcnt(5)
  v_mfma_f32_32x32x16_bf16 v[64:79], a[228:231], v[160:163], v[64:79]
  ds_read_b128 a[252:255], v1 offset:11264
  s_waitcnt vmcnt(8) lgkmcnt(5)
  v_mfma_f32_32x32x16_bf16 v[80:95], a[232:235], v[164:167], v[80:95]
  s_xor_b32 s62, s62, 0x7000
  buffer_load_dwordx4 v[192:195], v1, s[8:11], s62 offen offset:0 sc1
  ds_read_b128 a[224:227], v1 offset:45056
  s_waitcnt lgkmcnt(5)
  v_mfma_f32_32x32x16_bf16 v[64:79], a[236:239], v[164:167], v[64:79]
  ds_read_b128 a[228:231], v1 offset:12288
  s_waitcnt vmcnt(8) lgkmcnt(5)
  v_mfma_f32_32x32x16_bf16 v[80:95], a[240:243], v[168:171], v[80:95]
  buffer_load_dwordx4 v[196:199], v1, s[8:11], s62 offen offset:1024 sc1
  ds_read_b128 a[232:235], v1 offset:46080
  s_waitcnt lgkmcnt(5)
  v_mfma_f32_32x32x16_bf16 v[64:79], a[244:247], v[168:171], v[64:79]
  ds_read_b128 a[236:239], v1 offset:13312
  s_waitcnt vmcnt(8) lgkmcnt(5)
  v_mfma_f32_32x32x16_bf16 v[80:95], a[248:251], v[172:175], v[80:95]
  buffer_load_dwordx4 v[200:203], v1, s[8:11], s62 offen offset:2048 sc1
  ds_read_b128 a[240:243], v1 offset:47104
  s_waitcnt lgkmcnt(5)
  v_mfma_f32_32x32x16_bf16 v[64:79], a[252:255], v[172:175], v[64:79]
  ds_read_b128 a[244:247], v1 offset:14336
  s_waitcnt vmcnt(6) lgkmcnt(5)
  v_mfma_f32_32x32x16_bf16 v[80:95], a[224:227], v[176:179], v[80:95]
  buffer_load_dwordx4 v[204:207], v1, s[8:11], s62 offen offset:3072 sc1
  ds_read_b128 a[248:251], v1 offset:48128
  s_waitcnt lgkmcnt(5)
  v_mfma_f32_32x32x16_bf16 v[64:79], a[228:231], v[176:179], v[64:79]
  s_xor_b32 s62, s62, 0x1000
  buffer_load_dwordx4 v[208:211], v1, s[8:11], s62 offen offset:0 sc1
  ds_read_b128 a[252:255], v1 offset:15360
  s_waitcnt vmcnt(7) lgkmcnt(5)
  v_mfma_f32_32x32x16_bf16 v[80:95], a[232:235], v[180:183], v[80:95]
  ds_read_b128 a[224:227], v1 offset:49152
  s_waitcnt lgkmcnt(5)
  v_mfma_f32_32x32x16_bf16 v[64:79], a[236:239], v[180:183], v[64:79]
  buffer_load_dwordx4 v[212:215], v1, s[8:11], s62 offen offset:1024 sc1
  ds_read_b128 a[228:231], v1 offset:16384
  s_waitcnt vmcnt(7) lgkmcnt(5)
  v_mfma_f32_32x32x16_bf16 v[80:95], a[240:243], v[184:187], v[80:95]
  ds_read_b128 a[232:235], v1 offset:50176
  s_waitcnt lgkmcnt(5)
  v_mfma_f32_32x32x16_bf16 v[64:79], a[244:247], v[184:187], v[64:79]
  buffer_load_dwordx4 v[216:219], v1, s[8:11], s62 offen offset:2048 sc1
  ds_read_b128 a[236:239], v1 offset:17408
  s_waitcnt vmcnt(7) lgkmcnt(5)
  v_mfma_f32_32x32x16_bf16 v[80:95], a[248:251], v[188:191], v[80:95]
  ds_read_b128 a[240:243], v1 offset:51200
  s_waitcnt lgkmcnt(5)
  v_mfma_f32_32x32x16_bf16 v[64:79], a[252:255], v[188:191], v[64:79]
  buffer_load_dwordx4 v[220:223], v1, s[8:11], s62 offen offset:3072 sc1
  ds_read_b128 a[244:247], v1 offset:18432
  s_waitcnt vmcnt(7) lgkmcnt(5)
  v_mfma_f32_32x32x16_bf16 v[80:95], a[224:227], v[192:195], v[80:95]
  ds_read_b128 a[248:251], v1 offset:52224
  s_waitcnt lgkmcnt(5)
  v_mfma_f32_32x32x16_bf16 v[64:79], a[228:231], v[192:195], v[64:79]
  s_xor_b32 s62, s62, 0x3000
  buffer_load_dwordx4 v[224:227], v1, s[8:11], s62 offen offset:0 sc1
  ds_read_b128 a[252:255], v1 offset:19456
  s_waitcnt vmcnt(7) lgkmcnt(5)
  v_mfma_f32_32x32x16_bf16 v[80:95], a[232:235], v[196:199], v[80:95]
  ds_read_b128 a[224:227], v1 offset:53248
  s_waitcnt lgkmcnt(5)
  v_mfma_f32_32x32x16_bf16 v[64:79], a[236:239], v[196:199], v[64:79]
  buffer_load_dwordx4 v[228:231], v1, s[8:11], s62 offen offset:1024 sc1
  ds_read_b128 a[228:231], v1 offset:20480
  s_waitcnt vmcnt(7) lgkmcnt(5)
  v_mfma_f32_32x32x16_bf16 v[80:95], a[240:243], v[200:203], v[80:95]
  buffer_load_dwordx4 v[232:235], v1, s[8:11], s62 offen offset:2048 sc1
  ds_read_b128 a[232:235], v1 offset:54272
  s_waitcnt lgkmcnt(5)
  v_mfma_f32_32x32x16_bf16 v[64:79], a[244:247], v[200:203], v[64:79]
  ds_read_b128 a[236:239], v1 offset:21504
  s_waitcnt vmcnt(7) lgkmcnt(5)
  v_mfma_f32_32x32x16_bf16 v[80:95], a[248:251], v[204:207], v[80:95]
  buffer_load_dwordx4 v[236:239], v1, s[8:11], s62 offen offset:3072 sc1
  ds_read_b128 a[240:243], v1 offset:55296
  s_waitcnt lgkmcnt(5)
  v_mfma_f32_32x32x16_bf16 v[64:79], a[252:255], v[204:207], v[64:79]
  ds_read_b128 a[244:247], v1 offset:22528
  s_waitcnt vmcnt(7) lgkmcnt(5)
  v_mfma_f32_32x32x16_bf16 v[80:95], a[224:227], v[208:211], v[80:95]
  s_xor_b32 s62, s62, 0x1000
  buffer_load_dwordx4 v[240:243], v1, s[8:11], s62 offen offset:0 sc1
  ds_read_b128 a[248:251], v1 offset:56320
  s_waitcnt lgkmcnt(5)
  v_mfma_f32_32x32x16_bf16 v[64:79], a[228:231], v[208:211], v[64:79]
  ds_read_b128 a[252:255], v1 offset:23552
  s_waitcnt vmcnt(7) lgkmcnt(5)
  v_mfma_f32_32x32x16_bf16 v[80:95], a[232:235], v[212:215], v[80:95]
  buffer_load_dwordx4 v[244:247], v1, s[8:11], s62 offen offset:1024 sc1
  ds_read_b128 a[224:227], v1 offset:57344
  s_waitcnt lgkmcnt(5)
  v_mfma_f32_32x32x16_bf16 v[64:79], a[236:239], v[212:215], v[64:79]
  ds_read_b128 a[228:231], v1 offset:24576
  s_waitcnt vmcnt(7) lgkmcnt(5)
  v_mfma_f32_32x32x16_bf16 v[80:95], a[240:243], v[216:219], v[80:95]
  buffer_load_dwordx4 v[248:251], v1, s[8:11], s62 offen offset:2048 sc1
  v_and_b32 v30, 0x1f0, v1
  v_add_u32 v30, 0x20000, v30
  ds_read_b128 a[232:235], v1 offset:58368
  s_waitcnt lgkmcnt(5)
  v_mfma_f32_32x32x16_bf16 v[64:79], a[244:247], v[216:219], v[64:79]
  ds_read_b128 v[112:115], v30 offset:29696
  ds_read_b128 v[116:119], v30 offset:30208
  ds_read_b128 a[236:239], v1 offset:25600
  s_waitcnt vmcnt(7) lgkmcnt(7)
  v_mfma_f32_32x32x16_bf16 v[80:95], a[248:251], v[220:223], v[80:95]
  buffer_load_dwordx4 v[252:255], v1, s[8:11], s62 offen offset:3072 sc1
  v_add_f32 v48, v48, v50
  v_add_f32 v49, v49, v51
  ds_read_b128 a[240:243], v1 offset:59392
  s_waitcnt lgkmcnt(7)
  v_mfma_f32_32x32x16_bf16 v[64:79], a[252:255], v[220:223], v[64:79]
  v_add_f32 v52, v52, v54
  ds_read_b128 a[244:247], v1 offset:26624
  s_waitcnt vmcnt(7) lgkmcnt(7)
  v_mfma_f32_32x32x16_bf16 v[80:95], a[224:227], v[224:227], v[80:95]
  v_add_f32 v53, v53, v55
  v_add_f32 v48, v48, v52
  ds_read_b128 a[248:251], v1 offset:60416
  s_waitcnt lgkmcnt(7)
  v_mfma_f32_32x32x16_bf16 v[64:79], a[228:231], v[224:227], v[64:79]
  v_add_f32 v49, v49, v53
  s_nop 1
  v_permlane32_swap_b32 v48, v49
  ds_read_b128 a[252:255], v1 offset:27648
  s_waitcnt vmcnt(6) lgkmcnt(7)
  v_mfma_f32_32x32x16_bf16 v[80:95], a[232:235], v[228:231], v[80:95]
  v_add_f32 v48, v48, v49
  ds_read_b128 a[224:227], v1 offset:61440
  s_waitcnt lgkmcnt(5)
  v_mfma_f32_32x32x16_bf16 v[64:79], a[236:239], v[228:231], v[64:79]
  v_mul_f32 v48, 0x3b000000, v48
  v_mov_b32 v49, v48
  ds_read_b128 a[228:231], v1 offset:28672
  s_waitcnt vmcnt(5) lgkmcnt(5)
  v_mfma_f32_32x32x16_bf16 v[80:95], a[240:243], v[232:235], v[80:95]
  v_permlane32_swap_b32 v48, v49
  v_fma_f32 v49, -v48, v48, v49
  ds_read_b128 a[232:235], v1 offset:62464
  s_waitcnt lgkmcnt(5)
  v_mfma_f32_32x32x16_bf16 v[64:79], a[244:247], v[232:235], v[64:79]
  v_max_f32 v49, 0, v49
  v_add_f32 v49, 0x3727c5ac, v49
  ds_read_b128 a[236:239], v1 offset:29696
  s_waitcnt vmcnt(4) lgkmcnt(5)
  v_mfma_f32_32x32x16_bf16 v[80:95], a[248:251], v[236:239], v[80:95]
  v_cvt_pk_bf16_f32 v20, -v48, -v48
  ds_read_b128 a[240:243], v1 offset:63488
  s_waitcnt lgkmcnt(5)
  v_mfma_f32_32x32x16_bf16 v[64:79], a[252:255], v[236:239], v[64:79]
  v_and_b32 v50, 0xffff0000, v20
  v_sub_f32 v50, -v48, v50
  ds_read_b128 a[244:247], v1 offset:30720
  s_waitcnt vmcnt(3) lgkmcnt(5)
  v_mfma_f32_32x32x16_bf16 v[80:95], a[224:227], v[240:243], v[80:95]
  v_cvt_pk_bf16_f32 v50, v50, v50
  v_cmp_gt_u32 vcc, 32, v0
  s_nop 1
  v_cndmask_b32 v20, v50, v20, vcc
  ds_read_b128 a[248:251], v1 offset:64512
  s_waitcnt lgkmcnt(5)
  v_mfma_f32_32x32x16_bf16 v[64:79], a[228:231], v[240:243], v[64:79]
  v_mov_b32 v124, v20
  ds_read_b128 a[252:255], v1 offset:31744
  s_waitcnt vmcnt(2) lgkmcnt(5)
  v_mfma_f32_32x32x16_bf16 v[80:95], a[232:235], v[244:247], v[80:95]
  v_mov_b32 v125, v20
  v_mov_b32 v126, v20
  s_waitcnt lgkmcnt(4)
  v_mfma_f32_32x32x16_bf16 v[64:79], a[236:239], v[244:247], v[64:79]
  v_mov_b32 v127, v20
  v_rsq_f32 v24, v49
  s_waitcnt vmcnt(1) lgkmcnt(3)
  v_mfma_f32_32x32x16_bf16 v[80:95], a[240:243], v[248:251], v[80:95]
  v_mul_f32 v25, s56, v24
  s_lshl_b32 s71, s28, 11
  s_add_u32 s71, s71, s38
  v_lshlrev_b32 v29, 5, v3
  buffer_load_dword v21, v29, s[8:11], s71 offen sc1
  s_waitcnt lgkmcnt(2)
  v_mfma_f32_32x32x16_bf16 v[64:79], a[244:247], v[248:251], v[64:79]
  s_waitcnt vmcnt(1) lgkmcnt(1)
  v_mfma_f32_32x32x16_bf16 v[80:95], a[248:251], v[252:255], v[80:95]
  s_and_b32 s71, s28, 3
  s_lshl_b32 s71, s71, 13
  s_add_u32 s71, s71, s45
  buffer_load_dword v21, v5, s[8:11], s71 offen sc1
  s_waitcnt lgkmcnt(0)
  v_mfma_f32_32x32x16_bf16 v[64:79], a[252:255], v[252:255], v[64:79]
  s_branch PGS7
.p2align 12
PG7:
  s_branch PG11
PGS7:
  v_mfma_f32_32x32x16_bf16 v[80:95], v[116:119], v[124:127], v[80:95]
  v_mfma_f32_32x32x16_bf16 v[64:79], v[112:115], v[124:127], v[64:79]
  s_nop 10
  v_pk_mul_f32 v[80:81], v[80:81], v[24:25] op_sel_hi:[1,0]
  v_pk_mul_f32 v[82:83], v[82:83], v[24:25] op_sel_hi:[1,0]
  v_pk_mul_f32 v[84:85], v[84:85], v[24:25] op_sel_hi:[1,0]
  v_pk_mul_f32 v[86:87], v[86:87], v[24:25] op_sel_hi:[1,0]
  v_pk_mul_f32 v[88:89], v[88:89], v[24:25] op_sel_hi:[1,0]
  v_pk_mul_f32 v[90:91], v[90:91], v[24:25] op_sel_hi:[1,0]
  v_pk_mul_f32 v[92:93], v[92:93], v[24:25] op_sel_hi:[1,0]
  v_pk_mul_f32 v[94:95], v[94:95], v[24:25] op_sel_hi:[1,0]
  v_cvt_pk_bf16_f32 v80, v80, v81
  v_cvt_pk_bf16_f32 v81, v82, v83
  v_cvt_pk_bf16_f32 v82, v84, v85
  v_cvt_pk_bf16_f32 v83, v86, v87
  v_cvt_pk_bf16_f32 v84, v88, v89
  v_cvt_pk_bf16_f32 v85, v90, v91
  v_cvt_pk_bf16_f32 v86, v92, v93
  v_cvt_pk_bf16_f32 v87, v94, v95
  ds_write_b128 v8, v[80:83] offset:8448
  ds_write_b128 v8, v[84:87] offset:10560
  v_max3_f32 v26, v64, v65, v66
  v_min3_f32 v28, v64, v65, v66
  v_max3_f32 v26, v26, v67, v68
  v_min3_f32 v28, v28, v67, v68
  v_max3_f32 v26, v26, v69, v70
  v_min3_f32 v28, v28, v69, v70
  v_max3_f32 v26, v26, v71, v72
  v_min3_f32 v28, v28, v71, v72
  v_max3_f32 v26, v26, v73, v74
  v_min3_f32 v28, v28, v73, v74
  v_max3_f32 v26, v26, v75, v76
  v_min3_f32 v28, v28, v75, v76
  v_max3_f32 v26, v26, v77, v78
  v_min3_f32 v28, v28, v77, v78
  v_max_f32 v26, v26, v79
  v_min_f32 v28, v28, v79
  v_mul_f32 v26, v26, v25
  v_mul_f32 v28, v28, v25
  v_pk_fma_f32 v[112:113], v[64:65], v[24:25], v[26:27] op_sel:[0,1,0] op_sel_hi:[1,1,0] neg_lo:[0,0,1] neg_hi:[0,0,1]
  v_pk_fma_f32 v[114:115], v[66:67], v[24:25], v[26:27] op_sel:[0,1,0] op_sel_hi:[1,1,0] neg_lo:[0,0,1] neg_hi:[0,0,1]
  v_pk_fma_f32 v[116:117], v[68:69], v[24:25], v[26:27] op_sel:[0,1,0] op_sel_hi:[1,1,0] neg_lo:[0,0,1] neg_hi:[0,0,1]
  v_pk_fma_f32 v[118:119], v[70:71], v[24:25], v[26:27] op_sel:[0,1,0] op_sel_hi:[1,1,0] neg_lo:[0,0,1] neg_hi:[0,0,1]
  v_pk_fma_f32 v[120:121], v[72:73], v[24:25], v[26:27] op_sel:[0,1,0] op_sel_hi:[1,1,0] neg_lo:[0,0,1] neg_hi:[0,0,1]
  v_pk_fma_f32 v[122:123], v[74:75], v[24:25], v[26:27] op_sel:[0,1,0] op_sel_hi:[1,1,0] neg_lo:[0,0,1] neg_hi:[0,0,1]
  v_pk_fma_f32 v[124:125], v[76:77], v[24:25], v[26:27] op_sel:[0,1,0] op_sel_hi:[1,1,0] neg_lo:[0,0,1] neg_hi:[0,0,1]
  v_pk_fma_f32 v[126:127], v[78:79], v[24:25], v[26:27] op_sel:[0,1,0] op_sel_hi:[1,1,0] neg_lo:[0,0,1] neg_hi:[0,0,1]
  v_exp_f32 v112, v112
  v_exp_f32 v113, v113
  v_exp_f32 v114, v114
  v_exp_f32 v115, v115
  v_exp_f32 v116, v116
  v_exp_f32 v117, v117
  v_exp_f32 v118, v118
  v_exp_f32 v119, v119
  v_exp_f32 v120, v120
  v_exp_f32 v121, v121
  v_exp_f32 v122, v122
  v_exp_f32 v123, v123
  v_exp_f32 v124, v124
  v_exp_f32 v125, v125
  v_exp_f32 v126, v126
  v_exp_f32 v127, v127
  v_pk_add_f32 v[30:31], v[112:113], v[114:115]
  v_pk_add_f32 v[30:31], v[30:31], v[116:117]
  v_pk_add_f32 v[30:31], v[30:31], v[118:119]
  v_pk_add_f32 v[30:31], v[30:31], v[120:121]
  v_pk_add_f32 v[30:31], v[30:31], v[122:123]
  v_pk_add_f32 v[30:31], v[30:31], v[124:125]
  v_pk_add_f32 v[30:31], v[30:31], v[126:127]
  v_add_f32 v30, v30, v31
  v_rcp_f32 v30, v30
  s_nop 0
  v_pk_mul_f32 v[112:113], v[112:113], v[30:31] op_sel_hi:[1,0]
  v_pk_mul_f32 v[114:115], v[114:115], v[30:31] op_sel_hi:[1,0]
  v_pk_mul_f32 v[116:117], v[116:117], v[30:31] op_sel_hi:[1,0]
  v_pk_mul_f32 v[118:119], v[118:119], v[30:31] op_sel_hi:[1,0]
  v_pk_mul_f32 v[120:121], v[120:121], v[30:31] op_sel_hi:[1,0]
  v_pk_mul_f32 v[122:123], v[122:123], v[30:31] op_sel_hi:[1,0]
  v_pk_mul_f32 v[124:125], v[124:125], v[30:31] op_sel_hi:[1,0]
  v_pk_mul_f32 v[126:127], v[126:127], v[30:31] op_sel_hi:[1,0]
  v_cvt_pk_bf16_f32 v48, v112, v113
  v_cvt_pk_bf16_f32 v49, v114, v115
  v_cvt_pk_bf16_f32 v50, v116, v117
  v_cvt_pk_bf16_f32 v51, v118, v119
  ds_write_b128 v8, v[48:51] offset:0
  v_cvt_pk_bf16_f32 v52, v120, v121
  v_cvt_pk_bf16_f32 v53, v122, v123
  v_cvt_pk_bf16_f32 v54, v124, v125
  v_cvt_pk_bf16_f32 v55, v126, v127
  ds_write_b128 v8, v[52:55] offset:2112
  v_pk_fma_f32 v[64:65], v[64:65], v[24:25], v[28:29] op_sel:[0,1,0] op_sel_hi:[1,1,0] neg_lo:[1,0,0] neg_hi:[1,0,0]
  v_pk_fma_f32 v[66:67], v[66:67], v[24:25], v[28:29] op_sel:[0,1,0] op_sel_hi:[1,1,0] neg_lo:[1,0,0] neg_hi:[1,0,0]
  v_pk_fma_f32 v[68:69], v[68:69], v[24:25], v[28:29] op_sel:[0,1,0] op_sel_hi:[1,1,0] neg_lo:[1,0,0] neg_hi:[1,0,0]
  v_pk_fma_f32 v[70:71], v[70:71], v[24:25], v[28:29] op_sel:[0,1,0] op_sel_hi:[1,1,0] neg_lo:[1,0,0] neg_hi:[1,0,0]
  v_pk_fma_f32 v[72:73], v[72:73], v[24:25], v[28:29] op_sel:[0,1,0] op_sel_hi:[1,1,0] neg_lo:[1,0,0] neg_hi:[1,0,0]
  v_pk_fma_f32 v[74:75], v[74:75], v[24:25], v[28:29] op_sel:[0,1,0] op_sel_hi:[1,1,0] neg_lo:[1,0,0] neg_hi:[1,0,0]
  v_pk_fma_f32 v[76:77], v[76:77], v[24:25], v[28:29] op_sel:[0,1,0] op_sel_hi:[1,1,0] neg_lo:[1,0,0] neg_hi:[1,0,0]
  v_pk_fma_f32 v[78:79], v[78:79], v[24:25], v[28:29] op_sel:[0,1,0] op_sel_hi:[1,1,0] neg_lo:[1,0,0] neg_hi:[1,0,0]
  v_exp_f32 v64, v64
  v_exp_f32 v65, v65
  v_exp_f32 v66, v66
  v_exp_f32 v67, v67
  v_exp_f32 v68, v68
  v_exp_f32 v69, v69
  v_exp_f32 v70, v70
  v_exp_f32 v71, v71
  v_exp_f32 v72, v72
  v_exp_f32 v73, v73
  v_exp_f32 v74, v74
  v_exp_f32 v75, v75
  v_exp_f32 v76, v76
  v_exp_f32 v77, v77
  v_exp_f32 v78, v78
  v_exp_f32 v79, v79
  v_pk_add_f32 v[30:31], v[64:65], v[66:67]
  v_pk_add_f32 v[30:31], v[30:31], v[68:69]
  v_pk_add_f32 v[30:31], v[30:31], v[70:71]
  v_pk_add_f32 v[30:31], v[30:31], v[72:73]
  v_pk_add_f32 v[30:31], v[30:31], v[74:75]
  v_pk_add_f32 v[30:31], v[30:31], v[76:77]
  v_pk_add_f32 v[30:31], v[30:31], v[78:79]
  v_add_f32 v30, v30, v31
  v_rcp_f32 v30, v30
  s_nop 0
  v_pk_mul_f32 v[64:65], v[64:65], v[30:31] op_sel_hi:[1,0]
  v_pk_mul_f32 v[66:67], v[66:67], v[30:31] op_sel_hi:[1,0]
  v_pk_mul_f32 v[68:69], v[68:69], v[30:31] op_sel_hi:[1,0]
  v_pk_mul_f32 v[70:71], v[70:71], v[30:31] op_sel_hi:[1,0]
  v_pk_mul_f32 v[72:73], v[72:73], v[30:31] op_sel_hi:[1,0]
  v_pk_mul_f32 v[74:75], v[74:75], v[30:31] op_sel_hi:[1,0]
  v_pk_mul_f32 v[76:77], v[76:77], v[30:31] op_sel_hi:[1,0]
  v_pk_mul_f32 v[78:79], v[78:79], v[30:31] op_sel_hi:[1,0]
  v_cvt_pk_bf16_f32 v56, v64, v65
  v_cvt_pk_bf16_f32 v57, v66, v67
  v_cvt_pk_bf16_f32 v58, v68, v69
  v_cvt_pk_bf16_f32 v59, v70, v71
  ds_write_b128 v8, v[56:59] offset:4224
  v_cvt_pk_bf16_f32 v60, v72, v73
  v_cvt_pk_bf16_f32 v61, v74, v75
  v_cvt_pk_bf16_f32 v62, v76, v77
  v_cvt_pk_bf16_f32 v63, v78, v79
  ds_write_b128 v8, v[60:63] offset:6336
  v_mov_b32 v72, s55
  v_mov_b32 v73, s55
  v_mov_b32 v74, s55
  v_mov_b32 v75, s55
  s_waitcnt lgkmcnt(0)
  s_barrier
  ds_read_b64_tr_b16 v[96:97], v9 offset:0
  ds_read_b64_tr_b16 v[98:99], v9 offset:64
  ds_read_b64_tr_b16 v[112:113], v10 offset:0
  ds_read_b64_tr_b16 v[114:115], v10 offset:64
  ds_read_b64_tr_b16 v[100:101], v9 offset:512
  ds_read_b64_tr_b16 v[102:103], v9 offset:576
  ds_read_b64_tr_b16 v[116:117], v10 offset:512
  ds_read_b64_tr_b16 v[118:119], v10 offset:576
  ds_read_b64_tr_b16 v[104:105], v9 offset:1024
  ds_read_b64_tr_b16 v[106:107], v9 offset:1088
  ds_read_b64_tr_b16 v[120:121], v10 offset:1024
  ds_read_b64_tr_b16 v[122:123], v10 offset:1088
  ds_read_b64_tr_b16 v[108:109], v9 offset:1536
  ds_read_b64_tr_b16 v[110:111], v9 offset:1600
  ds_read_b64_tr_b16 v[124:125], v10 offset:1536
  ds_read_b64_tr_b16 v[126:127], v10 offset:1600
  s_waitcnt lgkmcnt(12)
  v_mfma_f32_16x16x32_bf16 v[64:67], v[96:99], v[112:115], 0
  v_mfma_f32_16x16x32_bf16 v[68:71], v[72:75], v[96:99], 0
  s_waitcnt lgkmcnt(8)
  v_mfma_f32_16x16x32_bf16 v[64:67], v[100:103], v[116:119], v[64:67]
  v_mfma_f32_16x16x32_bf16 v[68:71], v[72:75], v[100:103], v[68:71]
  s_waitcnt lgkmcnt(4)
  v_mfma_f32_16x16x32_bf16 v[64:67], v[104:107], v[120:123], v[64:67]
  v_mfma_f32_16x16x32_bf16 v[68:71], v[72:75], v[104:107], v[68:71]
  s_waitcnt lgkmcnt(0)
  v_mfma_f32_16x16x32_bf16 v[64:67], v[108:111], v[124:127], v[64:67]
  v_mfma_f32_16x16x32_bf16 v[68:71], v[72:75], v[108:111], v[68:71]
  s_sub_u32 s60, s49, s24
  s_lshl_b32 s60, s60, 9
  s_add_u32 s60, s60, 0x6d9c00
  s_lshl_b32 s63, s49, 6
  s_add_u32 s63, s63, 0x780000
  s_nop 1
  v_cvt_pk_bf16_f32 v112, v64, v65
  v_cvt_pk_bf16_f32 v113, v66, v67
  v_mov_b32 v114, v68
  buffer_store_dwordx2 v[112:113], v11, s[8:11], s60 offen sc1
  buffer_store_dword v114, v3, s[8:11], s63 offen sc1
  ds_read_b128 a[224:227], v2 offset:0
  ds_read_b128 a[228:231], v2 offset:1024
  ds_read_b128 a[232:235], v2 offset:2048
  ds_read_b128 a[236:239], v2 offset:3072
  ds_read_b128 a[240:243], v2 offset:4096
  ds_read_b128 a[244:247], v2 offset:5120
  s_waitcnt lgkmcnt(5)
  v_mfma_f32_32x32x16_bf16 v[96:111], a[224:227], v[128:131], 0
  v_lshrrev_b32 v27, 3, v0
  v_and_b32 v29, 0x70, v1
  v_lshl_or_b32 v27, v27, 10, v29
  v_add_u32 v29, 7168, v27
  s_xor_b32 m0, s57, 0x0
  s_xor_b32 s61, s36, 0x0
  buffer_load_dwordx4 v27, s[84:87], s61 offen  lds
  buffer_load_dwordx4 v29, s[84:87], s61 offen offset:1024  lds
  ds_read_b128 a[248:251], v2 offset:6144
  s_waitcnt lgkmcnt(5)
  v_mfma_f32_32x32x16_bf16 v[96:111], a[228:231], v[132:135], v[96:111]
  ds_read_b128 a[252:255], v2 offset:7168
  s_waitcnt lgkmcnt(5)
  v_mfma_f32_32x32x16_bf16 v[96:111], a[232:235], v[136:139], v[96:111]
  ds_read_b128 a[224:227], v2 offset:8192
  s_waitcnt lgkmcnt(5)
  v_mfma_f32_32x32x16_bf16 v[96:111], a[236:239], v[140:143], v[96:111]
  s_xor_b32 m0, s57, 0x800
  s_xor_b32 s61, s36, 0x4000
  buffer_load_dwordx4 v27, s[84:87], s61 offen  lds
  buffer_load_dwordx4 v29, s[84:87], s61 offen offset:1024  lds
  ds_read_b128 a[228:231], v2 offset:9216
  s_waitcnt lgkmcnt(5)
  v_mfma_f32_32x32x16_bf16 v[96:111], a[240:243], v[144:147], v[96:111]
  ds_read_b128 a[232:235], v2 offset:10240
  s_waitcnt lgkmcnt(5)
  v_mfma_f32_32x32x16_bf16 v[96:111], a[244:247], v[148:151], v[96:111]
  ds_read_b128 a[236:239], v2 offset:11264
  s_waitcnt lgkmcnt(5)
  v_mfma_f32_32x32x16_bf16 v[96:111], a[248:251], v[152:155], v[96:111]
  s_xor_b32 m0, s57, 0x1000
  s_xor_b32 s61, s36, 0x8000
  buffer_load_dwordx4 v27, s[84:87], s61 offen  lds
  buffer_load_dwordx4 v29, s[84:87], s61 offen offset:1024  lds
  ds_read_b128 a[240:243], v2 offset:12288
  s_waitcnt lgkmcnt(5)
  v_mfma_f32_32x32x16_bf16 v[96:111], a[252:255], v[156:159], v[96:111]
  ds_read_b128 a[244:247], v2 offset:13312
  s_waitcnt lgkmcnt(5)
  v_mfma_f32_32x32x16_bf16 v[96:111], a[224:227], v[160:163], v[96:111]
  ds_read_b128 a[248:251], v2 offset:14336
  s_waitcnt lgkmcnt(5)
  v_mfma_f32_32x32x16_bf16 v[96:111], a[228:231], v[164:167], v[96:111]
  s_xor_b32 m0, s57, 0x1800
  s_xor_b32 s61, s36, 0xc000
  buffer_load_dwordx4 v27, s[84:87], s61 offen  lds
  buffer_load_dwordx4 v29, s[84:87], s61 offen offset:1024  lds
  ds_read_b128 a[252:255], v2 offset:15360
  s_waitcnt lgkmcnt(5)
  v_mfma_f32_32x32x16_bf16 v[96:111], a[232:235], v[168:171], v[96:111]
  v_and_b32 v30, 0x1f0, v1
  ds_read_b128 a[224:227], v2 offset:16384
  s_waitcnt lgkmcnt(5)
  v_mfma_f32_32x32x16_bf16 v[96:111], a[236:239], v[172:175], v[96:111]
  v_add_u32 v30, 0x20000, v30
  ds_read_b128 a[228:231], v2 offset:17408
  s_waitcnt lgkmcnt(5)
  v_mfma_f32_32x32x16_bf16 v[96:111], a[240:243], v[176:179], v[96:111]
  s_xor_b32 m0, s57, 0x8000
  s_xor_b32 s61, s36, 0x10000
  buffer_load_dwordx4 v27, s[84:87], s61 offen  lds
  buffer_load_dwordx4 v29, s[84:87], s61 offen offset:1024  lds
  ds_read_b128 v[64:67], v30 offset:32256
  ds_read_b128 a[232:235], v2 offset:18432
  s_waitcnt lgkmcnt(6)
  v_mfma_f32_32x32x16_bf16 v[96:111], a[244:247], v[180:183], v[96:111]
  v_mov_b32 v68, v20
  ds_read_b128 a[236:239], v2 offset:19456
  s_waitcnt lgkmcnt(6)
  v_mfma_f32_32x32x16_bf16 v[96:111], a[248:251], v[184:187], v[96:111]
  v_mov_b32 v69, v20
  v_and_b32 v176, 1, v0
  ds_read_b128 a[240:243], v2 offset:20480
  s_waitcnt lgkmcnt(6)
  v_mfma_f32_32x32x16_bf16 v[96:111], a[252:255], v[188:191], v[96:111]
  s_xor_b32 m0, s57, 0x8800
  s_xor_b32 s61, s36, 0x14000
  buffer_load_dwordx4 v27, s[84:87], s61 offen  lds
  buffer_load_dwordx4 v29, s[84:87], s61 offen offset:1024  lds
  v_mov_b32 v70, v20
  v_lshlrev_b32 v176, 4, v176
  ds_read_b128 a[244:247], v2 offset:21504
  s_waitcnt lgkmcnt(6)
  v_mfma_f32_32x32x16_bf16 v[96:111], a[224:227], v[192:195], v[96:111]
  v_mov_b32 v71, v20
  v_lshlrev_b32 v176, v176, s53
  ds_read_b128 a[248:251], v2 offset:22528
  s_waitcnt lgkmcnt(6)
  v_mfma_f32_32x32x16_bf16 v[96:111], a[228:231], v[196:199], v[96:111]
  v_bfe_u32 v126, v0, 2, 2
  ds_read_b128 a[252:255], v2 offset:23552
  s_waitcnt lgkmcnt(5)
  v_mfma_f32_32x32x16_bf16 v[96:111], a[232:235], v[200:203], v[96:111]
  s_xor_b32 m0, s57, 0x9000
  s_xor_b32 s61, s36, 0x18000
  buffer_load_dwordx4 v27, s[84:87], s61 offen  lds
  buffer_load_dwordx4 v29, s[84:87], s61 offen offset:1024  lds
  v_lshrrev_b32 v125, 5, v0
  v_bfe_u32 v177, v0, 1, 3
  ds_read_b128 a[224:227], v2 offset:24576
  s_waitcnt lgkmcnt(5)
  v_mfma_f32_32x32x16_bf16 v[96:111], a[236:239], v[204:207], v[96:111]
  v_lshl_or_b32 v126, v125, 3, v126
  v_cmp_eq_u32 vcc, 0, v177
  s_nop 1
  v_cndmask_b32 v168, 0, v176, vcc
  ds_read_b128 a[228:231], v2 offset:25600
  s_waitcnt lgkmcnt(5)
  v_mfma_f32_32x32x16_bf16 v[96:111], a[240:243], v[208:211], v[96:111]
  s_xor_b32 s60, s50, 0x101800
  buffer_load_dwordx4 v[128:131], v7, s[8:11], s60 offen offset:0 sc1
  v_bfe_u32 v125, v0, 4, 1
  ds_read_b128 a[232:235], v2 offset:26624
  s_waitcnt lgkmcnt(5)
  v_mfma_f32_32x32x16_bf16 v[96:111], a[244:247], v[212:215], v[96:111]
  s_xor_b32 m0, s57, 0x9800
  s_xor_b32 s61, s36, 0x1c000
  buffer_load_dwordx4 v27, s[84:87], s61 offen  lds
  buffer_load_dwordx4 v29, s[84:87], s61 offen offset:1024  lds
  v_lshl_or_b32 v126, v126, 2, v125
  v_cmp_eq_u32 vcc, 1, v177
  s_nop 1
  v_cndmask_b32 v169, 0, v176, vcc
  ds_read_b128 a[236:239], v2 offset:27648
  s_waitcnt lgkmcnt(5)
  v_mfma_f32_32x32x16_bf16 v[96:111], a[248:251], v[216:219], v[96:111]
  v_and_b32 v125, 1, v0
  v_cmp_eq_u32 vcc, 2, v177
  s_nop 1
  v_cndmask_b32 v170, 0, v176, vcc
  ds_read_b128 a[240:243], v2 offset:28672
  s_waitcnt lgkmcnt(5)
  v_mfma_f32_32x32x16_bf16 v[96:111], a[252:255], v[220:223], v[96:111]
  v_lshl_or_b32 v126, v126, 1, v125
  v_cmp_eq_u32 vcc, 3, v177
  s_nop 1
  v_cndmask_b32 v171, 0, v176, vcc
  ds_read_b128 a[244:247], v2 offset:29696
  s_waitcnt lgkmcnt(5)
  v_mfma_f32_32x32x16_bf16 v[96:111], a[224:227], v[224:227], v[96:111]
  s_xor_b32 s60, s50, 0x101800
  buffer_load_dwordx4 v[132:135], v7, s[8:11], s60 offen offset:256 sc1
  v_bfe_u32 v125, v0, 1, 1
  ds_read_b128 a[248:251], v2 offset:30720
  s_waitcnt lgkmcnt(5)
  v_mfma_f32_32x32x16_bf16 v[96:111], a[228:231], v[228:231], v[96:111]
  v_lshl_or_b32 v126, v126, 1, v125
  v_cmp_eq_u32 vcc, 4, v177
  s_nop 1
  v_cndmask_b32 v172, 0, v176, vcc
  ds_read_b128 a[252:255], v2 offset:31744
  s_waitcnt lgkmcnt(5)
  v_mfma_f32_32x32x16_bf16 v[96:111], a[232:235], v[232:235], v[96:111]
  s_and_b32 s63, s27, 1
  s_mul_i32 s63, s63, 0x8000
  s_or_b32 s63, s63, s52
  v_lshl_add_u32 v125, v126, 3, s63
  v_cmp_eq_u32 vcc, 5, v177
  s_nop 1
  v_cndmask_b32 v173, 0, v176, vcc
  s_waitcnt lgkmcnt(4)
  v_mfma_f32_32x32x16_bf16 v[96:111], a[236:239], v[236:239], v[96:111]
  v_xor_b32 v126, 0x8000, v125
  s_waitcnt lgkmcnt(3)
  v_mfma_f32_32x32x16_bf16 v[96:111], a[240:243], v[240:243], v[96:111]
  s_xor_b32 s60, s50, 0x101000
  buffer_load_dwordx4 v[136:139], v7, s[8:11], s60 offen offset:0 sc1
  v_cmp_eq_u32 vcc, 6, v177
  s_nop 1
  v_cndmask_b32 v174, 0, v176, vcc
  s_waitcnt lgkmcnt(2)
  v_mfma_f32_32x32x16_bf16 v[96:111], a[244:247], v[244:247], v[96:111]
  v_cmp_eq_u32 vcc, 7, v177
  s_nop 1
  v_cndmask_b32 v175, 0, v176, vcc
  s_waitcnt lgkmcnt(1)
  v_mfma_f32_32x32x16_bf16 v[96:111], a[248:251], v[248:251], v[96:111]
  s_waitcnt lgkmcnt(0)
  v_mfma_f32_32x32x16_bf16 v[96:111], a[252:255], v[252:255], v[96:111]
  v_mfma_f32_32x32x16_bf16 v[96:111], v[64:67], v[68:71], v[96:111]
  s_nop 11
  v_max3_f32 v26, v96, v97, v98
  v_min3_f32 v28, v96, v97, v98
  v_max3_f32 v26, v26, v99, v100
  s_xor_b32 s60, s50, 0x101000
  buffer_load_dwordx4 v[140:143], v7, s[8:11], s60 offen offset:256 sc1
  v_min3_f32 v28, v28, v99, v100
  v_max3_f32 v26, v26, v101, v102
  v_min3_f32 v28, v28, v101, v102
  v_max3_f32 v26, v26, v103, v104
  v_min3_f32 v28, v28, v103, v104
  v_max3_f32 v26, v26, v105, v106
  v_min3_f32 v28, v28, v105, v106
  v_max3_f32 v26, v26, v107, v108
  v_min3_f32 v28, v28, v107, v108
  v_max3_f32 v26, v26, v109, v110
  v_min3_f32 v28, v28, v109, v110
  v_max_f32 v26, v26, v111
  s_xor_b32 s60, s50, 0x100800
  buffer_load_dwordx4 v[144:147], v7, s[8:11], s60 offen offset:0 sc1
  v_min_f32 v28, v28, v111
  v_mul_f32 v26, v26, v25
  v_mul_f32 v28, v28, v25
  v_pk_fma_f32 v[64:65], v[96:97], v[24:25], v[26:27] op_sel:[0,1,0] op_sel_hi:[1,1,0] neg_lo:[0,0,1] neg_hi:[0,0,1]
  v_pk_fma_f32 v[66:67], v[98:99], v[24:25], v[26:27] op_sel:[0,1,0] op_sel_hi:[1,1,0] neg_lo:[0,0,1] neg_hi:[0,0,1]
  v_pk_fma_f32 v[68:69], v[100:101], v[24:25], v[26:27] op_sel:[0,1,0] op_sel_hi:[1,1,0] neg_lo:[0,0,1] neg_hi:[0,0,1]
  v_pk_fma_f32 v[70:71], v[102:103], v[24:25], v[26:27] op_sel:[0,1,0] op_sel_hi:[1,1,0] neg_lo:[0,0,1] neg_hi:[0,0,1]
  v_pk_fma_f32 v[72:73], v[104:105], v[24:25], v[26:27] op_sel:[0,1,0] op_sel_hi:[1,1,0] neg_lo:[0,0,1] neg_hi:[0,0,1]
  v_pk_fma_f32 v[74:75], v[106:107], v[24:25], v[26:27] op_sel:[0,1,0] op_sel_hi:[1,1,0] neg_lo:[0,0,1] neg_hi:[0,0,1]
  v_pk_fma_f32 v[76:77], v[108:109], v[24:25], v[26:27] op_sel:[0,1,0] op_sel_hi:[1,1,0] neg_lo:[0,0,1] neg_hi:[0,0,1]
  v_pk_fma_f32 v[78:79], v[110:111], v[24:25], v[26:27] op_sel:[0,1,0] op_sel_hi:[1,1,0] neg_lo:[0,0,1] neg_hi:[0,0,1]
  v_exp_f32 v64, v64
  s_xor_b32 s60, s50, 0x100800
  buffer_load_dwordx4 v[148:151], v7, s[8:11], s60 offen offset:256 sc1
  v_exp_f32 v65, v65
  v_exp_f32 v66, v66
  v_exp_f32 v67, v67
  v_exp_f32 v68, v68
  v_exp_f32 v69, v69
  v_exp_f32 v70, v70
  v_exp_f32 v71, v71
  v_exp_f32 v72, v72
  v_exp_f32 v73, v73
  v_exp_f32 v74, v74
  v_exp_f32 v75, v75
  v_exp_f32 v76, v76
  s_xor_b32 s60, s50, 0x100000
  buffer_load_dwordx4 v[152:155], v7, s[8:11], s60 offen offset:0 sc1
  v_exp_f32 v77, v77
  v_exp_f32 v78, v78
  v_exp_f32 v79, v79
  v_pk_add_f32 v[30:31], v[64:65], v[66:67]
  v_pk_add_f32 v[30:31], v[30:31], v[68:69]
  v_pk_add_f32 v[30:31], v[30:31], v[70:71]
  v_pk_add_f32 v[30:31], v[30:31], v[72:73]
  v_pk_add_f32 v[30:31], v[30:31], v[74:75]
  v_pk_add_f32 v[30:31], v[30:31], v[76:77]
  v_pk_add_f32 v[30:31], v[30:31], v[78:79]
  v_add_f32 v30, v30, v31
  v_rcp_f32 v30, v30
  s_xor_b32 s60, s50, 0x100000
  buffer_load_dwordx4 v[156:159], v7, s[8:11], s60 offen offset:256 sc1
  v_pk_mul_f32 v[64:65], v[64:65], v[30:31] op_sel_hi:[1,0]
  v_pk_mul_f32 v[66:67], v[66:67], v[30:31] op_sel_hi:[1,0]
  v_pk_mul_f32 v[68:69], v[68:69], v[30:31] op_sel_hi:[1,0]
  v_pk_mul_f32 v[70:71], v[70:71], v[30:31] op_sel_hi:[1,0]
  v_pk_mul_f32 v[72:73], v[72:73], v[30:31] op_sel_hi:[1,0]
  v_pk_mul_f32 v[74:75], v[74:75], v[30:31] op_sel_hi:[1,0]
  v_pk_mul_f32 v[76:77], v[76:77], v[30:31] op_sel_hi:[1,0]
  v_pk_mul_f32 v[78:79], v[78:79], v[30:31] op_sel_hi:[1,0]
  v_cvt_pk_bf16_f32 v48, v64, v65
  v_cvt_pk_bf16_f32 v49, v66, v67
  v_cvt_pk_bf16_f32 v50, v68, v69
  v_cvt_pk_bf16_f32 v51, v70, v71
  s_lshr_b32 s60, s49, 4
  s_lshl_b32 s60, s60, 10
  s_add_u32 s60, s60, 0x780000
  buffer_load_dwordx4 v[160:163], v1, s[8:11], s60 offen sc1
  v_cvt_pk_bf16_f32 v52, v72, v73
  v_cvt_pk_bf16_f32 v53, v74, v75
  v_cvt_pk_bf16_f32 v54, v76, v77
  v_cvt_pk_bf16_f32 v55, v78, v79
  v_pk_fma_f32 v[80:81], v[96:97], v[24:25], v[28:29] op_sel:[0,1,0] op_sel_hi:[1,1,0] neg_lo:[1,0,0] neg_hi:[1,0,0]
  v_pk_fma_f32 v[82:83], v[98:99], v[24:25], v[28:29] op_sel:[0,1,0] op_sel_hi:[1,1,0] neg_lo:[1,0,0] neg_hi:[1,0,0]
  v_pk_fma_f32 v[84:85], v[100:101], v[24:25], v[28:29] op_sel:[0,1,0] op_sel_hi:[1,1,0] neg_lo:[1,0,0] neg_hi:[1,0,0]
  v_pk_fma_f32 v[86:87], v[102:103], v[24:25], v[28:29] op_sel:[0,1,0] op_sel_hi:[1,1,0] neg_lo:[1,0,0] neg_hi:[1,0,0]
  v_pk_fma_f32 v[88:89], v[104:105], v[24:25], v[28:29] op_sel:[0,1,0] op_sel_hi:[1,1,0] neg_lo:[1,0,0] neg_hi:[1,0,0]
  v_pk_fma_f32 v[90:91], v[106:107], v[24:25], v[28:29] op_sel:[0,1,0] op_sel_hi:[1,1,0] neg_lo:[1,0,0] neg_hi:[1,0,0]
  v_pk_fma_f32 v[92:93], v[108:109], v[24:25], v[28:29] op_sel:[0,1,0] op_sel_hi:[1,1,0] neg_lo:[1,0,0] neg_hi:[1,0,0]
  v_pk_fma_f32 v[94:95], v[110:111], v[24:25], v[28:29] op_sel:[0,1,0] op_sel_hi:[1,1,0] neg_lo:[1,0,0] neg_hi:[1,0,0]
  v_exp_f32 v80, v80
  v_exp_f32 v81, v81
  v_exp_f32 v82, v82
  v_exp_f32 v83, v83
  v_exp_f32 v84, v84
  v_exp_f32 v85, v85
  v_exp_f32 v86, v86
  v_exp_f32 v87, v87
  v_exp_f32 v88, v88
  v_exp_f32 v89, v89
  v_exp_f32 v90, v90
  v_exp_f32 v91, v91
  v_exp_f32 v92, v92
  v_exp_f32 v93, v93
  v_exp_f32 v94, v94
  v_exp_f32 v95, v95
  v_pk_add_f32 v[30:31], v[80:81], v[82:83]
  v_pk_add_f32 v[30:31], v[30:31], v[84:85]
  v_pk_add_f32 v[30:31], v[30:31], v[86:87]
  v_pk_add_f32 v[30:31], v[30:31], v[88:89]
  v_pk_add_f32 v[30:31], v[30:31], v[90:91]
  v_pk_add_f32 v[30:31], v[30:31], v[92:93]
  v_pk_add_f32 v[30:31], v[30:31], v[94:95]
  v_add_f32 v30, v30, v31
  v_rcp_f32 v30, v30
  s_nop 0
  v_pk_mul_f32 v[80:81], v[80:81], v[30:31] op_sel_hi:[1,0]
  v_pk_mul_f32 v[82:83], v[82:83], v[30:31] op_sel_hi:[1,0]
  v_pk_mul_f32 v[84:85], v[84:85], v[30:31] op_sel_hi:[1,0]
  v_pk_mul_f32 v[86:87], v[86:87], v[30:31] op_sel_hi:[1,0]
  v_pk_mul_f32 v[88:89], v[88:89], v[30:31] op_sel_hi:[1,0]
  v_pk_mul_f32 v[90:91], v[90:91], v[30:31] op_sel_hi:[1,0]
  v_pk_mul_f32 v[92:93], v[92:93], v[30:31] op_sel_hi:[1,0]
  v_pk_mul_f32 v[94:95], v[94:95], v[30:31] op_sel_hi:[1,0]
  v_cvt_pk_bf16_f32 v56, v80, v81
  v_cvt_pk_bf16_f32 v57, v82, v83
  v_cvt_pk_bf16_f32 v58, v84, v85
  v_cvt_pk_bf16_f32 v59, v86, v87
  v_cvt_pk_bf16_f32 v60, v88, v89
  v_cvt_pk_bf16_f32 v61, v90, v91
  v_cvt_pk_bf16_f32 v62, v92, v93
  v_cvt_pk_bf16_f32 v63, v94, v95
  s_waitcnt vmcnt(8)
  ds_read_b64_tr_b16 v[192:193], v125 offset:0
  ds_read_b64_tr_b16 v[194:195], v125 offset:512
  ds_read_b64_tr_b16 v[196:197], v125 offset:64
  ds_read_b64_tr_b16 v[198:199], v125 offset:576
  ds_read_b64_tr_b16 v[200:201], v125 offset:2048
  ds_read_b64_tr_b16 v[202:203], v125 offset:2560
  ds_read_b64_tr_b16 v[204:205], v125 offset:2112
  ds_read_b64_tr_b16 v[206:207], v125 offset:2624
  ds_read_b64_tr_b16 v[208:209], v125 offset:4096
  ds_read_b64_tr_b16 v[210:211], v125 offset:4608
  ds_read_b64_tr_b16 v[212:213], v125 offset:4160
  ds_read_b64_tr_b16 v[214:215], v125 offset:4672
  ds_read_b64_tr_b16 v[216:217], v125 offset:6144
  ds_read_b64_tr_b16 v[218:219], v125 offset:6656
  ds_read_b64_tr_b16 v[220:221], v125 offset:6208
  ds_read_b64_tr_b16 v[222:223], v125 offset:6720
  ds_read_b64_tr_b16 v[224:225], v126 offset:0
  ds_read_b64_tr_b16 v[226:227], v126 offset:512
  ds_read_b64_tr_b16 v[228:229], v126 offset:64
  ds_read_b64_tr_b16 v[230:231], v126 offset:576
  ds_read_b64_tr_b16 v[232:233], v126 offset:2048
  ds_read_b64_tr_b16 v[234:235], v126 offset:2560
  ds_read_b64_tr_b16 v[236:237], v126 offset:2112
  ds_read_b64_tr_b16 v[238:239], v126 offset:2624
  ds_read_b64_tr_b16 v[240:241], v126 offset:4096
  ds_read_b64_tr_b16 v[242:243], v126 offset:4608
  ds_read_b64_tr_b16 v[244:245], v126 offset:4160
  ds_read_b64_tr_b16 v[246:247], v126 offset:4672
  ds_read_b64_tr_b16 v[248:249], v126 offset:6144
  ds_read_b64_tr_b16 v[250:251], v126 offset:6656
  ds_read_b64_tr_b16 v[252:253], v126 offset:6208
  ds_read_b64_tr_b16 v[254:255], v126 offset:6720
  s_mov_b32 s69, 0
KV_22:
  v_mfma_f32_16x16x32_bf16 v[64:67], v[168:171], v[128:131], 0
  s_waitcnt vmcnt(7)
  v_mfma_f32_16x16x32_bf16 v[64:67], v[172:175], v[132:135], v[64:67]
  s_waitcnt vmcnt(6)
  v_mfma_f32_16x16x32_bf16 v[64:67], v[168:171], v[136:139], v[64:67]
  s_waitcnt vmcnt(5)
  v_mfma_f32_16x16x32_bf16 v[64:67], v[172:175], v[140:143], v[64:67]
  s_waitcnt vmcnt(4)
  v_mfma_f32_16x16x32_bf16 v[64:67], v[168:171], v[144:147], v[64:67]
  s_waitcnt vmcnt(3)
  v_mfma_f32_16x16x32_bf16 v[64:67], v[172:175], v[148:151], v[64:67]
  s_waitcnt vmcnt(2)
  v_mfma_f32_16x16x32_bf16 v[64:67], v[168:171], v[152:155], v[64:67]
  s_waitcnt vmcnt(1)
  v_mfma_f32_16x16x32_bf16 v[64:67], v[172:175], v[156:159], v[64:67]
  s_waitcnt vmcnt(0)
  v_permlane32_swap_b32 v160, v161
  v_permlane32_swap_b32 v162, v163
  v_add_f32 v68, v160, v161
  v_add_f32 v69, v162, v163
  s_nop 1
  v_permlane16_swap_b32 v68, v69
  v_add_f32 v68, v68, v69
  s_nop 1
  v_add_f32_dpp v68, v68, v68 row_ror:4 row_mask:0xf bank_mask:0xf
  s_nop 1
  v_add_f32_dpp v68, v68, v68 row_ror:8 row_mask:0xf bank_mask:0xf
  v_add_f32 v69, v68, v64
  v_cmp_u_f32 vcc, v69, v66
  s_cbranch_vccz KVD_23
  s_lshr_b32 s60, s49, 4
  s_lshl_b32 s60, s60, 10
  s_add_u32 s60, s60, 0x780000
  buffer_load_dwordx4 v[160:163], v1, s[8:11], s60 offen sc1
  v_max3_u32 v69, v128, v129, v130
  v_max_u32 v69, v69, v131
  v_cmp_eq_u32 s[76:77], -1, v69
  v_max3_u32 v69, v132, v133, v134
  v_max_u32 v69, v69, v135
  v_cmp_eq_u32 s[88:89], -1, v69
  v_max3_u32 v69, v136, v137, v138
  v_max_u32 v69, v69, v139
  v_cmp_eq_u32 s[90:91], -1, v69
  v_max3_u32 v69, v140, v141, v142
  v_max_u32 v69, v69, v143
  v_cmp_eq_u32 s[92:93], -1, v69
  v_max3_u32 v69, v144, v145, v146
  v_max_u32 v69, v69, v147
  v_cmp_eq_u32 s[94:95], -1, v69
  v_max3_u32 v69, v148, v149, v150
  v_max_u32 v69, v69, v151
  v_cmp_eq_u32 s[96:97], -1, v69
  v_max3_u32 v69, v152, v153, v154
  v_max_u32 v69, v69, v155
  v_cmp_eq_u32 s[98:99], -1, v69
  v_max3_u32 v69, v156, v157, v158
  v_max_u32 v69, v69, v159
  v_cmp_eq_u32 s[100:101], -1, v69
  s_mov_b64 exec, s[76:77]
  s_xor_b32 s60, s50, 0x101800
  buffer_load_dwordx4 v[128:131], v7, s[8:11], s60 offen offset:0 sc1
  s_mov_b64 exec, s[88:89]
  s_xor_b32 s60, s50, 0x101800
  buffer_load_dwordx4 v[132:135], v7, s[8:11], s60 offen offset:256 sc1
  s_mov_b64 exec, s[90:91]
  s_xor_b32 s60, s50, 0x101000
  buffer_load_dwordx4 v[136:139], v7, s[8:11], s60 offen offset:0 sc1
  s_mov_b64 exec, s[92:93]
  s_xor_b32 s60, s50, 0x101000
  buffer_load_dwordx4 v[140:143], v7, s[8:11], s60 offen offset:256 sc1
  s_mov_b64 exec, s[94:95]
  s_xor_b32 s60, s50, 0x100800
  buffer_load_dwordx4 v[144:147], v7, s[8:11], s60 offen offset:0 sc1
  s_branch PGS8
.p2align 12
PG8:
  s_branch PGB
PGS8:
  s_mov_b64 exec, s[96:97]
  s_xor_b32 s60, s50, 0x100800
  buffer_load_dwordx4 v[148:151], v7, s[8:11], s60 offen offset:256 sc1
  s_mov_b64 exec, s[98:99]
  s_xor_b32 s60, s50, 0x100000
  buffer_load_dwordx4 v[152:155], v7, s[8:11], s60 offen offset:0 sc1
  s_mov_b64 exec, s[100:101]
  s_xor_b32 s60, s50, 0x100000
  buffer_load_dwordx4 v[156:159], v7, s[8:11], s60 offen offset:256 sc1
  s_mov_b64 exec, -1
  s_waitcnt vmcnt(0)
  s_add_u32 s69, s69, 1
  s_cmp_lt_u32 s69, s33
  s_cbranch_scc1 KV_22
  s_mov_b32 s33, 1
KVD_23:
  s_waitcnt lgkmcnt(0)
  s_add_u32 m0, s52, 0x0
  s_add_u32 s61, s35, 0x20000
  buffer_load_dwordx4 v1, s[8:11], s61 offen sc1 lds
  buffer_load_dwordx4 v1, s[8:11], s61 offen offset:1024 sc1 lds
  buffer_load_dwordx4 v1, s[8:11], s61 offen offset:2048 sc1 lds
  buffer_load_dwordx4 v1, s[8:11], s61 offen offset:3072 sc1 lds
  s_add_u32 m0, s52, 0x1000
  s_add_u32 s61, s35, 0x21000
  buffer_load_dwordx4 v1, s[8:11], s61 offen sc1 lds
  buffer_load_dwordx4 v1, s[8:11], s61 offen offset:1024 sc1 lds
  v_cvt_pk_bf16_f32 v70, v64, v65
  v_cvt_pk_bf16_f32 v71, v66, v67
  v_cvt_pk_bf16_f32 v68, v68, v68
  ds_write_b64 v11, v[70:71]
  ds_write_b16 v12, v68
  s_waitcnt lgkmcnt(0)
  s_barrier
  ds_read_b128 a[224:227], v14 offset:0
  ds_read_b128 a[228:231], v13 offset:0
  ds_read_b128 a[232:235], v14 offset:16
  ds_read_b128 a[236:239], v13 offset:256
  ds_read_b128 a[240:243], v14 offset:32
  ds_read_b128 a[244:247], v13 offset:512
  ds_read_b128 a[248:251], v14 offset:48
  ds_read_b128 a[252:255], v13 offset:768
  s_waitcnt lgkmcnt(7)
  v_mfma_f32_32x32x16_bf16 v[80:95], a[224:227], v[48:51], 0
  s_waitcnt lgkmcnt(5)
  v_mfma_f32_32x32x16_bf16 v[80:95], a[232:235], v[52:55], v[80:95]
  s_waitcnt lgkmcnt(3)
  v_mfma_f32_32x32x16_bf16 v[80:95], a[240:243], v[56:59], v[80:95]
  s_waitcnt lgkmcnt(1)
  v_mfma_f32_32x32x16_bf16 v[80:95], a[248:251], v[60:63], v[80:95]
  v_mfma_f32_32x32x16_bf16 v[64:79], a[228:231], v[48:51], 0
  v_mfma_f32_32x32x16_bf16 v[64:79], a[236:239], v[52:55], v[64:79]
  v_mfma_f32_32x32x16_bf16 v[64:79], a[244:247], v[56:59], v[64:79]
  s_waitcnt lgkmcnt(0)
  v_mfma_f32_32x32x16_bf16 v[64:79], a[252:255], v[60:63], v[64:79]
  s_nop 6
  v_add_f32 v80, 0x358637bd, v80
  v_add_f32 v88, 0x358637bd, v88
  v_rcp_f32 v80, v80
  v_rcp_f32 v88, v88
  s_lshl_b32 s63, s28, 11
  s_add_u32 s63, s63, s38
  v_pk_mul_f32 v[64:65], v[64:65], v[80:81] op_sel_hi:[1,0]
  v_pk_mul_f32 v[66:67], v[66:67], v[80:81] op_sel_hi:[1,0]
  v_pk_mul_f32 v[68:69], v[68:69], v[80:81] op_sel_hi:[1,0]
  v_pk_mul_f32 v[70:71], v[70:71], v[80:81] op_sel_hi:[1,0]
  v_cvt_pk_bf16_f32 v96, v64, v65
  v_cvt_pk_bf16_f32 v97, v66, v67
  v_cvt_pk_bf16_f32 v98, v68, v69
  v_cvt_pk_bf16_f32 v99, v70, v71
  s_cmp_lg_u32 s58, 0
  s_cbranch_scc1 ALT_14
  buffer_store_dwordx4 v[96:99], v1, s[8:11], s63 offen
ALTB_14:
  v_pk_mul_f32 v[72:73], v[72:73], v[88:89] op_sel_hi:[1,0]
  v_pk_mul_f32 v[74:75], v[74:75], v[88:89] op_sel_hi:[1,0]
  v_pk_mul_f32 v[76:77], v[76:77], v[88:89] op_sel_hi:[1,0]
  v_pk_mul_f32 v[78:79], v[78:79], v[88:89] op_sel_hi:[1,0]
  v_cvt_pk_bf16_f32 v100, v72, v73
  v_cvt_pk_bf16_f32 v101, v74, v75
  v_cvt_pk_bf16_f32 v102, v76, v77
  v_cvt_pk_bf16_f32 v103, v78, v79
  s_cmp_lg_u32 s58, 0
  s_cbranch_scc1 ALT_15
  buffer_store_dwordx4 v[100:103], v1, s[8:11], s63 offen offset:1024
ALTB_15:
  s_waitcnt vmcnt(0)
  s_add_u32 s70, s31, 2
  v_mov_b32 v31, s70
  s_cmp_lg_u32 s58, 0
  s_cbranch_scc1 ALT_16
  buffer_store_dword v31, v5, s[8:11], s48 offen
ALTB_16:
  buffer_load_dwordx4 v1, s[8:11], s61 offen offset:2048 sc1 lds
  buffer_load_dwordx4 v1, s[8:11], s61 offen offset:3072 sc1 lds
  s_add_u32 m0, s52, 0x8000
  s_add_u32 s61, s35, 0x30000
  buffer_load_dwordx4 v1, s[8:11], s61 offen sc1 lds
  buffer_load_dwordx4 v1, s[8:11], s61 offen offset:1024 sc1 lds
  v_add_u32 v27, 0x10000, v15
  s_mov_b32 s69, 0
POLL_24:
  buffer_load_dword v26, v4, s[8:11], s47 offen sc1
  s_waitcnt vmcnt(0)
  s_add_u32 s68, s31, 2
  v_subrev_u32 v26, s68, v26
  v_cmp_lt_u32 vcc, 15, v26
  s_cbranch_vccz PD_25
  s_add_u32 s69, s69, 1
  s_cmp_lt_u32 s69, s33
  s_cbranch_scc1 POLL_24
  s_mov_b32 s33, 1
PD_25:
  buffer_load_dwordx4 v[128:131], v1, s[8:11], s39 offen sc1
  buffer_load_dwordx4 v[132:135], v1, s[8:11], s39 offen offset:1024 sc1
  buffer_load_dwordx4 v[136:139], v1, s[8:11], s39 offen offset:2048 sc1
  buffer_load_dwordx4 v[140:143], v1, s[8:11], s39 offen offset:3072 sc1
  s_add_u32 s60, s39, 0x1000
  buffer_load_dwordx4 v[144:147], v1, s[8:11], s60 offen sc1
  buffer_load_dwordx4 v[148:151], v1, s[8:11], s60 offen offset:1024 sc1
  buffer_load_dwordx4 v[152:155], v1, s[8:11], s60 offen offset:2048 sc1
  buffer_load_dwordx4 v[156:159], v1, s[8:11], s60 offen offset:3072 sc1
  s_waitcnt vmcnt(7)
  v_mfma_f32_32x32x16_bf16 v[64:79], v[192:195], v[128:131], 0
  s_add_u32 s60, s39, 0x8000
  buffer_load_dwordx4 v[160:163], v1, s[8:11], s60 offen sc1
  v_mfma_f32_32x32x16_bf16 v[80:95], v[196:199], v[128:131], 0
  s_waitcnt vmcnt(7)
  v_mfma_f32_32x32x16_bf16 v[64:79], v[200:203], v[132:135], v[64:79]
  buffer_load_dwordx4 v[164:167], v1, s[8:11], s60 offen offset:1024 sc1
  v_mfma_f32_32x32x16_bf16 v[80:95], v[204:207], v[132:135], v[80:95]
  s_waitcnt vmcnt(7)
  v_mfma_f32_32x32x16_bf16 v[64:79], v[208:211], v[136:139], v[64:79]
  buffer_load_dwordx4 v[168:171], v1, s[8:11], s60 offen offset:2048 sc1
  v_mfma_f32_32x32x16_bf16 v[80:95], v[212:215], v[136:139], v[80:95]
  s_waitcnt vmcnt(7)
  v_mfma_f32_32x32x16_bf16 v[64:79], v[216:219], v[140:143], v[64:79]
  buffer_load_dwordx4 v[172:175], v1, s[8:11], s60 offen offset:3072 sc1
  v_mfma_f32_32x32x16_bf16 v[80:95], v[220:223], v[140:143], v[80:95]
  s_waitcnt vmcnt(7)
  v_mfma_f32_32x32x16_bf16 v[64:79], v[224:227], v[144:147], v[64:79]
  s_add_u32 s60, s39, 0x9000
  buffer_load_dwordx4 v[176:179], v1, s[8:11], s60 offen sc1
  v_mfma_f32_32x32x16_bf16 v[80:95], v[228:231], v[144:147], v[80:95]
  s_waitcnt vmcnt(7)
  v_mfma_f32_32x32x16_bf16 v[64:79], v[232:235], v[148:151], v[64:79]
  buffer_load_dwordx4 v[180:183], v1, s[8:11], s60 offen offset:1024 sc1
  v_mfma_f32_32x32x16_bf16 v[80:95], v[236:239], v[148:151], v[80:95]
  s_waitcnt vmcnt(7)
  v_mfma_f32_32x32x16_bf16 v[64:79], v[240:243], v[152:155], v[64:79]
  buffer_load_dwordx4 v[184:187], v1, s[8:11], s60 offen offset:2048 sc1
  v_mfma_f32_32x32x16_bf16 v[80:95], v[244:247], v[152:155], v[80:95]
  s_waitcnt vmcnt(7)
  v_mfma_f32_32x32x16_bf16 v[64:79], v[248:251], v[156:159], v[64:79]
  buffer_load_dwordx4 v[188:191], v1, s[8:11], s60 offen offset:3072 sc1
  v_mfma_f32_32x32x16_bf16 v[80:95], v[252:255], v[156:159], v[80:95]
  s_waitcnt vmcnt(7)
  v_mfma_f32_32x32x16_bf16 v[96:111], v[192:195], v[160:163], 0
  v_mfma_f32_32x32x16_bf16 v[112:127], v[196:199], v[160:163], 0
  s_waitcnt vmcnt(6)
  v_mfma_f32_32x32x16_bf16 v[96:111], v[200:203], v[164:167], v[96:111]
  buffer_load_dwordx4 v1, s[8:11], s61 offen offset:2048 sc1 lds
  v_mfma_f32_32x32x16_bf16 v[112:127], v[204:207], v[164:167], v[112:127]
  s_nop 2
  v_cvt_pk_bf16_f32 v64, v64, v65
  v_cvt_pk_bf16_f32 v65, v66, v67
  s_waitcnt vmcnt(6)
  v_mfma_f32_32x32x16_bf16 v[96:111], v[208:211], v[168:171], v[96:111]
  buffer_load_dwordx4 v1, s[8:11], s61 offen offset:3072 sc1 lds
  v_cvt_pk_bf16_f32 v66, v68, v69
  v_cvt_pk_bf16_f32 v67, v70, v71
  v_mfma_f32_32x32x16_bf16 v[112:127], v[212:215], v[168:171], v[112:127]
  ds_write_b128 v27, v[64:67] offset:0
  s_waitcnt vmcnt(6)
  v_mfma_f32_32x32x16_bf16 v[96:111], v[216:219], v[172:175], v[96:111]
  s_add_u32 m0, s52, 0x9000
  s_add_u32 s61, s35, 0x31000
  buffer_load_dwordx4 v1, s[8:11], s61 offen sc1 lds
  v_cvt_pk_bf16_f32 v72, v72, v73
  v_cvt_pk_bf16_f32 v73, v74, v75
  v_mfma_f32_32x32x16_bf16 v[112:127], v[220:223], v[172:175], v[112:127]
  v_cvt_pk_bf16_f32 v74, v76, v77
  v_cvt_pk_bf16_f32 v75, v78, v79
  s_waitcnt vmcnt(6)
  v_mfma_f32_32x32x16_bf16 v[96:111], v[224:227], v[176:179], v[96:111]
  ds_write_b128 v27, v[72:75] offset:512
  v_mfma_f32_32x32x16_bf16 v[112:127], v[228:231], v[176:179], v[112:127]
  buffer_load_dwordx4 v1, s[8:11], s61 offen offset:1024 sc1 lds
  v_cvt_pk_bf16_f32 v80, v80, v81
  v_cvt_pk_bf16_f32 v81, v82, v83
  s_waitcnt vmcnt(6)
  v_mfma_f32_32x32x16_bf16 v[96:111], v[232:235], v[180:183], v[96:111]
  v_cvt_pk_bf16_f32 v82, v84, v85
  v_cvt_pk_bf16_f32 v83, v86, v87
  v_mfma_f32_32x32x16_bf16 v[112:127], v[236:239], v[180:183], v[112:127]
  buffer_load_dwordx4 v1, s[8:11], s61 offen offset:2048 sc1 lds
  ds_write_b128 v27, v[80:83] offset:1024
  s_waitcnt vmcnt(6)
  v_mfma_f32_32x32x16_bf16 v[96:111], v[240:243], v[184:187], v[96:111]
  v_cvt_pk_bf16_f32 v88, v88, v89
  v_cvt_pk_bf16_f32 v89, v90, v91
  v_mfma_f32_32x32x16_bf16 v[112:127], v[244:247], v[184:187], v[112:127]
  buffer_load_dwordx4 v1, s[8:11], s61 offen offset:3072 sc1 lds
  v_cvt_pk_bf16_f32 v90, v92, v93
  v_cvt_pk_bf16_f32 v91, v94, v95
  s_waitcnt vmcnt(6)
  v_mfma_f32_32x32x16_bf16 v[96:111], v[248:251], v[188:191], v[96:111]
  ds_write_b128 v27, v[88:91] offset:1536
  v_mfma_f32_32x32x16_bf16 v[112:127], v[252:255], v[188:191], v[112:127]
  s_nop 9
  v_cvt_pk_bf16_f32 v96, v96, v97
  v_cvt_pk_bf16_f32 v97, v98, v99
  v_cvt_pk_bf16_f32 v98, v100, v101
  v_cvt_pk_bf16_f32 v99, v102, v103
  ds_write_b128 v27, v[96:99] offset:16384
  v_cvt_pk_bf16_f32 v104, v104, v105
  v_cvt_pk_bf16_f32 v105, v106, v107
  v_cvt_pk_bf16_f32 v106, v108, v109
  v_cvt_pk_bf16_f32 v107, v110, v111
  ds_write_b128 v27, v[104:107] offset:16896
  v_cvt_pk_bf16_f32 v112, v112, v113
  v_cvt_pk_bf16_f32 v113, v114, v115
  v_cvt_pk_bf16_f32 v114, v116, v117
  v_cvt_pk_bf16_f32 v115, v118, v119
  ds_write_b128 v27, v[112:115] offset:17408
  v_cvt_pk_bf16_f32 v120, v120, v121
  v_cvt_pk_bf16_f32 v121, v122, v123
  v_cvt_pk_bf16_f32 v122, v124, v125
  v_cvt_pk_bf16_f32 v123, v126, v127
  ds_write_b128 v27, v[120:123] offset:17920
  s_add_u32 s63, s52, 0x10000
  v_add_u32 v26, s63, v1
  s_waitcnt lgkmcnt(0)
  s_barrier
  ds_read_b128 v[192:195], v26 offset:0
  ds_read_b128 v[196:199], v26 offset:2048
  ds_read_b128 v[200:203], v26 offset:4096
  ds_read_b128 v[204:207], v26 offset:6144
  ds_read_b128 v[208:211], v26 offset:1024
  ds_read_b128 v[212:215], v26 offset:3072
  ds_read_b128 v[216:219], v26 offset:5120
  ds_read_b128 v[220:223], v26 offset:7168
  s_waitcnt lgkmcnt(7)
  v_dot2_f32_bf16 v32, v192, s53, v32
  v_dot2_f32_bf16 v33, v192, s54, v33
  v_dot2_f32_bf16 v34, v193, s53, v34
  v_dot2_f32_bf16 v35, v193, s54, v35
  v_dot2_f32_bf16 v36, v194, s53, v36
  v_dot2_f32_bf16 v37, v194, s54, v37
  v_dot2_f32_bf16 v38, v195, s53, v38
  v_dot2_f32_bf16 v39, v195, s54, v39
  s_waitcnt lgkmcnt(6)
  v_dot2_f32_bf16 v32, v196, s53, v32
  v_dot2_f32_bf16 v33, v196, s54, v33
  v_dot2_f32_bf16 v34, v197, s53, v34
  v_dot2_f32_bf16 v35, v197, s54, v35
  v_dot2_f32_bf16 v36, v198, s53, v36
  v_dot2_f32_bf16 v37, v198, s54, v37
  v_dot2_f32_bf16 v38, v199, s53, v38
  v_dot2_f32_bf16 v39, v199, s54, v39
  s_waitcnt lgkmcnt(5)
  v_dot2_f32_bf16 v32, v200, s53, v32
  v_dot2_f32_bf16 v33, v200, s54, v33
  v_dot2_f32_bf16 v34, v201, s53, v34
  v_dot2_f32_bf16 v35, v201, s54, v35
  v_dot2_f32_bf16 v36, v202, s53, v36
  v_dot2_f32_bf16 v37, v202, s54, v37
  v_dot2_f32_bf16 v38, v203, s53, v38
  v_dot2_f32_bf16 v39, v203, s54, v39
  s_waitcnt lgkmcnt(4)
  v_dot2_f32_bf16 v32, v204, s53, v32
  v_dot2_f32_bf16 v33, v204, s54, v33
  v_dot2_f32_bf16 v34, v205, s53, v34
  v_dot2_f32_bf16 v35, v205, s54, v35
  v_dot2_f32_bf16 v36, v206, s53, v36
  v_dot2_f32_bf16 v37, v206, s54, v37
  v_dot2_f32_bf16 v38, v207, s53, v38
  v_dot2_f32_bf16 v39, v207, s54, v39
  v_cvt_pk_bf16_f32 v48, v32, v33
  v_cvt_pk_bf16_f32 v49, v34, v35
  v_cvt_pk_bf16_f32 v50, v36, v37
  v_cvt_pk_bf16_f32 v51, v38, v39
  s_add_u32 s60, s40, 0x200000
  s_cmp_lg_u32 s58, 0
  s_cbranch_scc1 ALT_17
  buffer_store_dwordx4 v[48:51], v7, s[8:11], s60 offen
ALTB_17:
  s_waitcnt lgkmcnt(3)
  v_dot2_f32_bf16 v40, v208, s53, v40
  v_dot2_f32_bf16 v41, v208, s54, v41
  v_dot2_f32_bf16 v42, v209, s53, v42
  v_dot2_f32_bf16 v43, v209, s54, v43
  v_dot2_f32_bf16 v44, v210, s53, v44
  v_dot2_f32_bf16 v45, v210, s54, v45
  v_dot2_f32_bf16 v46, v211, s53, v46
  v_dot2_f32_bf16 v47, v211, s54, v47
  s_waitcnt lgkmcnt(2)
  v_dot2_f32_bf16 v40, v212, s53, v40
  v_dot2_f32_bf16 v41, v212, s54, v41
  v_dot2_f32_bf16 v42, v213, s53, v42
  v_dot2_f32_bf16 v43, v213, s54, v43
  v_dot2_f32_bf16 v44, v214, s53, v44
  v_dot2_f32_bf16 v45, v214, s54, v45
  v_dot2_f32_bf16 v46, v215, s53, v46
  v_dot2_f32_bf16 v47, v215, s54, v47
  s_waitcnt lgkmcnt(1)
  v_dot2_f32_bf16 v40, v216, s53, v40
  v_dot2_f32_bf16 v41, v216, s54, v41
  v_dot2_f32_bf16 v42, v217, s53, v42
  v_dot2_f32_bf16 v43, v217, s54, v43
  v_dot2_f32_bf16 v44, v218, s53, v44
  v_dot2_f32_bf16 v45, v218, s54, v45
  v_dot2_f32_bf16 v46, v219, s53, v46
  v_dot2_f32_bf16 v47, v219, s54, v47
  s_waitcnt lgkmcnt(0)
  v_dot2_f32_bf16 v40, v220, s53, v40
  v_dot2_f32_bf16 v41, v220, s54, v41
  v_dot2_f32_bf16 v42, v221, s53, v42
  v_dot2_f32_bf16 v43, v221, s54, v43
  v_dot2_f32_bf16 v44, v222, s53, v44
  v_dot2_f32_bf16 v45, v222, s54, v45
  v_dot2_f32_bf16 v46, v223, s53, v46
  v_dot2_f32_bf16 v47, v223, s54, v47
  v_cvt_pk_bf16_f32 v52, v40, v41
  v_cvt_pk_bf16_f32 v53, v42, v43
  v_cvt_pk_bf16_f32 v54, v44, v45
  v_cvt_pk_bf16_f32 v55, v46, v47
  s_cmp_lg_u32 s58, 0
  s_cbranch_scc1 ALT_18
  buffer_store_dwordx4 v[52:55], v7, s[8:11], s60 offen offset:2048
ALTB_18:
  v_dot2_f32_bf16 v28, v48, s55, 0
  v_dot2_f32_bf16 v29, v48, v48, 0
  v_dot2_f32_bf16 v28, v49, s55, v28
  v_dot2_f32_bf16 v29, v49, v49, v29
  v_dot2_f32_bf16 v28, v50, s55, v28
  v_dot2_f32_bf16 v29, v50, v50, v29
  v_dot2_f32_bf16 v28, v51, s55, v28
  v_dot2_f32_bf16 v29, v51, v51, v29
  v_dot2_f32_bf16 v28, v52, s55, v28
  v_dot2_f32_bf16 v29, v52, v52, v29
  v_dot2_f32_bf16 v28, v53, s55, v28
  v_dot2_f32_bf16 v29, v53, v53, v29
  v_dot2_f32_bf16 v28, v54, s55, v28
  v_dot2_f32_bf16 v29, v54, v54, v29
  v_dot2_f32_bf16 v28, v55, s55, v28
  v_dot2_f32_bf16 v29, v55, v55, v29
  s_nop 2
  v_permlane32_swap_b32 v28, v29
  v_add_f32 v28, v28, v29
  v_mov_b32 v29, v28
  s_nop 1
  v_permlane16_swap_b32 v28, v29
  v_add_f32 v28, v28, v29
  s_add_u32 s60, s42, 0x20000
  s_cmp_lg_u32 s58, 0
  s_cbranch_scc1 ALT_19
  buffer_store_dword v28, v17, s[8:11], s60 offen
ALTB_19:
  s_waitcnt vmcnt(0)
  s_add_u32 s70, s31, 3
  v_mov_b32 v31, s70
  s_cmp_lg_u32 s58, 0
  s_cbranch_scc1 ALT_20
  buffer_store_dword v31, v5, s[8:11], s46 offen
ALTB_20:
  s_add_u32 m0, s52, 0x10000
  s_add_u32 s61, s35, 0x18000
  buffer_load_dwordx4 v1, s[8:11], s61 offen sc1 lds
  buffer_load_dwordx4 v1, s[8:11], s61 offen offset:1024 sc1 lds
  buffer_load_dwordx4 v1, s[8:11], s61 offen offset:2048 sc1 lds
  buffer_load_dwordx4 v1, s[8:11], s61 offen offset:3072 sc1 lds
  s_mov_b32 s69, 0
POLL_26:
  buffer_load_dword v26, v3, s[8:11], s45 offen sc1
  s_waitcnt vmcnt(0)
  s_add_u32 s68, s31, 3
  v_subrev_u32 v26, s68, v26
  v_cmp_lt_u32 vcc, 15, v26
  s_cbranch_vccz PD_27
  s_add_u32 s69, s69, 1
  s_cmp_lt_u32 s69, s33
  s_cbranch_scc1 POLL_26
  s_mov_b32 s33, 1
PD_27:
  s_add_u32 s60, s38, 0x200000
  buffer_load_dwordx4 v[128:131], v1, s[8:11], s60 offen sc1
  buffer_load_dwordx4 v[132:135], v1, s[8:11], s60 offen offset:1024 sc1
  buffer_load_dwordx4 v[136:139], v1, s[8:11], s60 offen offset:2048 sc1
  buffer_load_dwordx4 v[140:143], v1, s[8:11], s60 offen offset:3072 sc1
  s_add_u32 s60, s38, 0x201000
  buffer_load_dwordx4 v[144:147], v1, s[8:11], s60 offen sc1
  buffer_load_dwordx4 v[148:151], v1, s[8:11], s60 offen offset:1024 sc1
  buffer_load_dwordx4 v[152:155], v1, s[8:11], s60 offen offset:2048 sc1
  buffer_load_dwordx4 v[156:159], v1, s[8:11], s60 offen offset:3072 sc1
  s_barrier
  ds_read_b128 a[224:227], v2 offset:32768
  ds_read_b128 a[228:231], v1 offset:0
  ds_read_b128 a[232:235], v2 offset:33792
  ds_read_b128 a[236:239], v1 offset:1024
  ds_read_b128 a[240:243], v2 offset:34816
  ds_read_b128 a[244:247], v1 offset:2048
  s_waitcnt vmcnt(7) lgkmcnt(5)
  v_mfma_f32_32x32x16_bf16 v[64:79], a[224:227], v[128:131], 0
  s_add_u32 s60, s38, 0x202000
  buffer_load_dwordx4 v[160:163], v1, s[8:11], s60 offen sc1
  ds_read_b128 a[248:251], v2 offset:35840
  s_waitcnt lgkmcnt(5)
  v_mfma_f32_32x32x16_bf16 v[80:95], a[228:231], v[128:131], 0
  buffer_load_dwordx4 v[164:167], v1, s[8:11], s60 offen offset:1024 sc1
  ds_read_b128 a[252:255], v1 offset:3072
  s_waitcnt vmcnt(8) lgkmcnt(5)
  v_mfma_f32_32x32x16_bf16 v[64:79], a[232:235], v[132:135], v[64:79]
  ds_read_b128 a[224:227], v2 offset:36864
  s_waitcnt lgkmcnt(5)
  v_mfma_f32_32x32x16_bf16 v[80:95], a[236:239], v[132:135], v[80:95]
  buffer_load_dwordx4 v[168:171], v1, s[8:11], s60 offen offset:2048 sc1
  ds_read_b128 a[228:231], v1 offset:4096
  s_waitcnt vmcnt(8) lgkmcnt(5)
  v_mfma_f32_32x32x16_bf16 v[64:79], a[240:243], v[136:139], v[64:79]
  ds_read_b128 a[232:235], v2 offset:37888
  s_waitcnt lgkmcnt(5)
  v_mfma_f32_32x32x16_bf16 v[80:95], a[244:247], v[136:139], v[80:95]
  buffer_load_dwordx4 v[172:175], v1, s[8:11], s60 offen offset:3072 sc1
  ds_read_b128 a[236:239], v1 offset:5120
  s_waitcnt vmcnt(8) lgkmcnt(5)
  v_mfma_f32_32x32x16_bf16 v[64:79], a[248:251], v[140:143], v[64:79]
  ds_read_b128 a[240:243], v2 offset:38912
  s_waitcnt lgkmcnt(5)
  v_mfma_f32_32x32x16_bf16 v[80:95], a[252:255], v[140:143], v[80:95]
  s_add_u32 s60, s41, 0x20000
  buffer_load_dwordx4 v[48:51], v1, s[8:11], s60 offen sc1
  ds_read_b128 a[244:247], v1 offset:6144
  s_waitcnt vmcnt(8) lgkmcnt(5)
  v_mfma_f32_32x32x16_bf16 v[64:79], a[224:227], v[144:147], v[64:79]
  ds_read_b128 a[248:251], v2 offset:39936
  s_waitcnt lgkmcnt(5)
  v_mfma_f32_32x32x16_bf16 v[80:95], a[228:231], v[144:147], v[80:95]
  buffer_load_dwordx4 v[52:55], v1, s[8:11], s60 offen offset:1024 sc1
  ds_read_b128 a[252:255], v1 offset:7168
  s_waitcnt vmcnt(8) lgkmcnt(5)
  v_mfma_f32_32x32x16_bf16 v[64:79], a[232:235], v[148:151], v[64:79]
  ds_read_b128 a[224:227], v2 offset:40960
  s_waitcnt lgkmcnt(5)
  v_mfma_f32_32x32x16_bf16 v[80:95], a[236:239], v[148:151], v[80:95]
  s_add_u32 s60, s38, 0x203000
  buffer_load_dwordx4 v[176:179], v1, s[8:11], s60 offen sc1
  ds_read_b128 a[228:231], v1 offset:8192
  s_waitcnt vmcnt(8) lgkmcnt(5)
  v_mfma_f32_32x32x16_bf16 v[64:79], a[240:243], v[152:155], v[64:79]
  buffer_load_dwordx4 v[180:183], v1, s[8:11], s60 offen offset:1024 sc1
  ds_read_b128 a[232:235], v2 offset:41984
  s_waitcnt lgkmcnt(5)
  v_mfma_f32_32x32x16_bf16 v[80:95], a[244:247], v[152:155], v[80:95]
  ds_read_b128 a[236:239], v1 offset:9216
  s_waitcnt vmcnt(8) lgkmcnt(5)
  v_mfma_f32_32x32x16_bf16 v[64:79], a[248:251], v[156:159], v[64:79]
  buffer_load_dwordx4 v[184:187], v1, s[8:11], s60 offen offset:2048 sc1
  ds_read_b128 a[240:243], v2 offset:43008
  s_waitcnt lgkmcnt(5)
  v_mfma_f32_32x32x16_bf16 v[80:95], a[252:255], v[156:159], v[80:95]
  ds_read_b128 a[244:247], v1 offset:10240
  s_waitcnt vmcnt(8) lgkmcnt(5)
  v_mfma_f32_32x32x16_bf16 v[64:79], a[224:227], v[160:163], v[64:79]
  buffer_load_dwordx4 v[188:191], v1, s[8:11], s60 offen offset:3072 sc1
  ds_read_b128 a[248:251], v2 offset:44032
  s_waitcnt lgkmcnt(5)
  v_mfma_f32_32x32x16_bf16 v[80:95], a[228:231], v[160:163], v[80:95]
  ds_read_b128 a[252:255], v1 offset:11264
  s_waitcnt vmcnt(8) lgkmcnt(5)
  v_mfma_f32_32x32x16_bf16 v[64:79], a[232:235], v[164:167], v[64:79]
  s_add_u32 s60, s38, 0x204000
  buffer_load_dwordx4 v[192:195], v1, s[8:11], s60 offen sc1
  ds_read_b128 a[224:227], v2 offset:45056
  s_waitcnt lgkmcnt(5)
  v_mfma_f32_32x32x16_bf16 v[80:95], a[236:239], v[164:167], v[80:95]
  ds_read_b128 a[228:231], v1 offset:12288
  s_waitcnt vmcnt(8) lgkmcnt(5)
  v_mfma_f32_32x32x16_bf16 v[64:79], a[240:243], v[168:171], v[64:79]
  buffer_load_dwordx4 v[196:199], v1, s[8:11], s60 offen offset:1024 sc1
  ds_read_b128 a[232:235], v2 offset:46080
  s_waitcnt lgkmcnt(5)
  v_mfma_f32_32x32x16_bf16 v[80:95], a[244:247], v[168:171], v[80:95]
  ds_read_b128 a[236:239], v1 offset:13312
  s_waitcnt vmcnt(8) lgkmcnt(5)
  v_mfma_f32_32x32x16_bf16 v[64:79], a[248:251], v[172:175], v[64:79]
  buffer_load_dwordx4 v[200:203], v1, s[8:11], s60 offen offset:2048 sc1
  ds_read_b128 a[240:243], v2 offset:47104
  s_waitcnt lgkmcnt(5)
  v_mfma_f32_32x32x16_bf16 v[80:95], a[252:255], v[172:175], v[80:95]
  ds_read_b128 a[244:247], v1 offset:14336
  s_waitcnt vmcnt(6) lgkmcnt(5)
  v_mfma_f32_32x32x16_bf16 v[64:79], a[224:227], v[176:179], v[64:79]
  buffer_load_dwordx4 v[204:207], v1, s[8:11], s60 offen offset:3072 sc1
  ds_read_b128 a[248:251], v2 offset:48128
  s_waitcnt lgkmcnt(5)
  v_mfma_f32_32x32x16_bf16 v[80:95], a[228:231], v[176:179], v[80:95]
  s_add_u32 s60, s38, 0x205000
  buffer_load_dwordx4 v[208:211], v1, s[8:11], s60 offen sc1
  ds_read_b128 a[252:255], v1 offset:15360
  s_waitcnt vmcnt(7) lgkmcnt(5)
  v_mfma_f32_32x32x16_bf16 v[64:79], a[232:235], v[180:183], v[64:79]
  ds_read_b128 a[224:227], v2 offset:49152
  s_waitcnt lgkmcnt(5)
  v_mfma_f32_32x32x16_bf16 v[80:95], a[236:239], v[180:183], v[80:95]
  buffer_load_dwordx4 v[212:215], v1, s[8:11], s60 offen offset:1024 sc1
  ds_read_b128 a[228:231], v1 offset:16384
  s_waitcnt vmcnt(7) lgkmcnt(5)
  v_mfma_f32_32x32x16_bf16 v[64:79], a[240:243], v[184:187], v[64:79]
  ds_read_b128 a[232:235], v2 offset:50176
  s_waitcnt lgkmcnt(5)
  v_mfma_f32_32x32x16_bf16 v[80:95], a[244:247], v[184:187], v[80:95]
  buffer_load_dwordx4 v[216:219], v1, s[8:11], s60 offen offset:2048 sc1
  ds_read_b128 a[236:239], v1 offset:17408
  s_waitcnt vmcnt(7) lgkmcnt(5)
  v_mfma_f32_32x32x16_bf16 v[64:79], a[248:251], v[188:191], v[64:79]
  ds_read_b128 a[240:243], v2 offset:51200
  s_waitcnt lgkmcnt(5)
  v_mfma_f32_32x32x16_bf16 v[80:95], a[252:255], v[188:191], v[80:95]
  buffer_load_dwordx4 v[220:223], v1, s[8:11], s60 offen offset:3072 sc1
  ds_read_b128 a[244:247], v1 offset:18432
  s_waitcnt vmcnt(7) lgkmcnt(5)
  v_mfma_f32_32x32x16_bf16 v[64:79], a[224:227], v[192:195], v[64:79]
  ds_read_b128 a[248:251], v2 offset:52224
  s_waitcnt lgkmcnt(5)
  v_mfma_f32_32x32x16_bf16 v[80:95], a[228:231], v[192:195], v[80:95]
  s_add_u32 s60, s38, 0x206000
  buffer_load_dwordx4 v[224:227], v1, s[8:11], s60 offen sc1
  ds_read_b128 a[252:255], v1 offset:19456
  s_waitcnt vmcnt(7) lgkmcnt(5)
  v_mfma_f32_32x32x16_bf16 v[64:79], a[232:235], v[196:199], v[64:79]
  ds_read_b128 a[224:227], v2 offset:53248
  s_waitcnt lgkmcnt(5)
  v_mfma_f32_32x32x16_bf16 v[80:95], a[236:239], v[196:199], v[80:95]
  buffer_load_dwordx4 v[228:231], v1, s[8:11], s60 offen offset:1024 sc1
  ds_read_b128 a[228:231], v1 offset:20480
  s_waitcnt vmcnt(7) lgkmcnt(5)
  v_mfma_f32_32x32x16_bf16 v[64:79], a[240:243], v[200:203], v[64:79]
  buffer_load_dwordx4 v[232:235], v1, s[8:11], s60 offen offset:2048 sc1
  ds_read_b128 a[232:235], v2 offset:54272
  s_waitcnt lgkmcnt(5)
  v_mfma_f32_32x32x16_bf16 v[80:95], a[244:247], v[200:203], v[80:95]
  v_add_f32 v48, v48, v50
  v_add_f32 v49, v49, v51
  ds_read_b128 a[236:239], v1 offset:21504
  s_waitcnt vmcnt(7) lgkmcnt(5)
  v_mfma_f32_32x32x16_bf16 v[64:79], a[248:251], v[204:207], v[64:79]
  buffer_load_dwordx4 v[236:239], v1, s[8:11], s60 offen offset:3072 sc1
  v_add_f32 v52, v52, v54
  ds_read_b128 a[240:243], v2 offset:55296
  s_waitcnt lgkmcnt(5)
  v_mfma_f32_32x32x16_bf16 v[80:95], a[252:255], v[204:207], v[80:95]
  v_add_f32 v53, v53, v55
  ds_read_b128 a[244:247], v1 offset:22528
  s_waitcnt vmcnt(7) lgkmcnt(5)
  v_mfma_f32_32x32x16_bf16 v[64:79], a[224:227], v[208:211], v[64:79]
  s_add_u32 s60, s38, 0x207000
  buffer_load_dwordx4 v[240:243], v1, s[8:11], s60 offen sc1
  s_add_u32 m0, s52, 0x11000
  s_add_u32 s61, s35, 0x19000
  buffer_load_dwordx4 v1, s[8:11], s61 offen sc1 lds
  v_add_f32 v48, v48, v52
  ds_read_b128 a[248:251], v2 offset:56320
  s_waitcnt lgkmcnt(5)
  v_mfma_f32_32x32x16_bf16 v[80:95], a[228:231], v[208:211], v[80:95]
  v_add_f32 v49, v49, v53
  ds_read_b128 a[252:255], v1 offset:23552
  s_waitcnt vmcnt(8) lgkmcnt(5)
  v_mfma_f32_32x32x16_bf16 v[64:79], a[232:235], v[212:215], v[64:79]
  buffer_load_dwordx4 v[244:247], v1, s[8:11], s60 offen offset:1024 sc1
  v_permlane32_swap_b32 v48, v49
  v_add_f32 v48, v48, v49
  ds_read_b128 a[224:227], v2 offset:57344
  s_waitcnt lgkmcnt(5)
  v_mfma_f32_32x32x16_bf16 v[80:95], a[236:239], v[212:215], v[80:95]
  v_mul_f32 v48, 0x3b000000, v48
  ds_read_b128 a[228:231], v1 offset:24576
  s_waitcnt vmcnt(8) lgkmcnt(5)
  v_mfma_f32_32x32x16_bf16 v[64:79], a[240:243], v[216:219], v[64:79]
  buffer_load_dwordx4 v[248:251], v1, s[8:11], s60 offen offset:2048 sc1
  v_mov_b32 v49, v48
  ds_read_b128 a[232:235], v2 offset:58368
  s_waitcnt lgkmcnt(5)
  v_mfma_f32_32x32x16_bf16 v[80:95], a[244:247], v[216:219], v[80:95]
  buffer_load_dwordx4 v1, s[8:11], s61 offen offset:1024 sc1 lds
  v_permlane32_swap_b32 v48, v49
  ds_read_b128 a[236:239], v1 offset:25600
  s_waitcnt vmcnt(9) lgkmcnt(5)
  v_mfma_f32_32x32x16_bf16 v[64:79], a[248:251], v[220:223], v[64:79]
  buffer_load_dwordx4 v[252:255], v1, s[8:11], s60 offen offset:3072 sc1
  v_fma_f32 v49, -v48, v48, v49
  ds_read_b128 a[240:243], v2 offset:59392
  s_waitcnt lgkmcnt(5)
  v_mfma_f32_32x32x16_bf16 v[80:95], a[252:255], v[220:223], v[80:95]
  v_max_f32 v49, 0, v49
  ds_read_b128 a[244:247], v1 offset:26624
  s_waitcnt vmcnt(9) lgkmcnt(5)
  v_mfma_f32_32x32x16_bf16 v[64:79], a[224:227], v[224:227], v[64:79]
  v_add_f32 v49, 0x3727c5ac, v49
  v_cvt_pk_bf16_f32 v60, -v48, -v48
  ds_read_b128 a[248:251], v2 offset:60416
  s_waitcnt lgkmcnt(5)
  v_mfma_f32_32x32x16_bf16 v[80:95], a[228:231], v[224:227], v[80:95]
  s_branch PGS9
.p2align 12
PG9:
  s_branch PGB
PGS9:
  v_and_b32 v50, 0xffff0000, v60
  ds_read_b128 a[252:255], v1 offset:27648
  s_waitcnt vmcnt(8) lgkmcnt(5)
  v_mfma_f32_32x32x16_bf16 v[64:79], a[232:235], v[228:231], v[64:79]
  buffer_load_dwordx4 v1, s[8:11], s61 offen offset:2048 sc1 lds
  v_sub_f32 v50, -v48, v50
  ds_read_b128 a[224:227], v2 offset:61440
  s_waitcnt lgkmcnt(5)
  v_mfma_f32_32x32x16_bf16 v[80:95], a[236:239], v[228:231], v[80:95]
  v_cvt_pk_bf16_f32 v50, v50, v50
  ds_read_b128 a[228:231], v1 offset:28672
  s_waitcnt vmcnt(8) lgkmcnt(5)
  v_mfma_f32_32x32x16_bf16 v[64:79], a[240:243], v[232:235], v[64:79]
  v_cmp_gt_u32 vcc, 32, v0
  s_nop 1
  v_cndmask_b32 v60, v50, v60, vcc
  ds_read_b128 a[232:235], v2 offset:62464
  s_waitcnt lgkmcnt(5)
  v_mfma_f32_32x32x16_bf16 v[80:95], a[244:247], v[232:235], v[80:95]
  v_rcp_f32 v24, v49
  ds_read_b128 a[236:239], v1 offset:29696
  s_waitcnt vmcnt(7) lgkmcnt(5)
  v_mfma_f32_32x32x16_bf16 v[64:79], a[248:251], v[236:239], v[64:79]
  v_mov_b32 v61, 0
  v_mov_b32 v62, 0
  ds_read_b128 a[240:243], v2 offset:63488
  s_waitcnt lgkmcnt(5)
  v_mfma_f32_32x32x16_bf16 v[80:95], a[252:255], v[236:239], v[80:95]
  buffer_load_dwordx4 v1, s[8:11], s61 offen offset:3072 sc1 lds
  v_mov_b32 v63, 0
  ds_read_b128 a[244:247], v1 offset:30720
  s_waitcnt vmcnt(7) lgkmcnt(5)
  v_mfma_f32_32x32x16_bf16 v[64:79], a[224:227], v[240:243], v[64:79]
  v_and_b32 v28, 31, v0
  ds_read_b128 a[248:251], v2 offset:64512
  s_waitcnt lgkmcnt(5)
  v_mfma_f32_32x32x16_bf16 v[80:95], a[228:231], v[240:243], v[80:95]
  v_lshlrev_b32 v28, 2, v28
  ds_read_b128 a[252:255], v1 offset:31744
  s_waitcnt vmcnt(5) lgkmcnt(5)
  v_mfma_f32_32x32x16_bf16 v[64:79], a[232:235], v[244:247], v[64:79]
  v_add_u32 v28, 0x27800, v28
  s_waitcnt lgkmcnt(4)
  v_mfma_f32_32x32x16_bf16 v[80:95], a[236:239], v[244:247], v[80:95]
  ds_write_b32 v18, v24
  s_waitcnt vmcnt(4) lgkmcnt(4)
  v_mfma_f32_32x32x16_bf16 v[64:79], a[240:243], v[248:251], v[64:79]
  s_waitcnt lgkmcnt(1)
  s_barrier
  ds_read_b128 a[224:227], v1 offset:32768
  ds_read_b128 a[228:231], v1 offset:33792
  v_mfma_f32_32x32x16_bf16 v[80:95], a[244:247], v[248:251], v[80:95]
  s_add_u32 m0, s52, 0x18000
  s_add_u32 s61, s35, 0x10000
  buffer_load_dwordx4 v1, s[8:11], s61 offen sc1 lds
  ds_read2_b32 v[56:57], v28 offset0:160 offset1:160
  ds_read2_b32 v[58:59], v28 offset0:128 offset1:128
  ds_read_b128 a[232:235], v1 offset:34816
  ds_read_b128 a[236:239], v1 offset:35840
  s_waitcnt vmcnt(3)
  v_mfma_f32_32x32x16_bf16 v[64:79], a[248:251], v[252:255], v[64:79]
  ds_read_b128 a[240:243], v1 offset:36864
  v_mfma_f32_32x32x16_bf16 v[80:95], a[252:255], v[252:255], v[80:95]
  ds_read_b128 a[244:247], v1 offset:37888
  s_waitcnt lgkmcnt(7)
  v_mfma_f32_32x32x16_bf16 v[96:111], a[224:227], v[128:131], 0
  s_waitcnt lgkmcnt(4)
  v_mfma_f32_32x32x16_bf16 v[64:79], v[56:59], v[60:63], v[64:79]
  ds_read_b128 a[248:251], v1 offset:38912
  v_mfma_f32_32x32x16_bf16 v[96:111], a[228:231], v[132:135], v[96:111]
  buffer_load_dwordx4 v1, s[8:11], s61 offen offset:1024 sc1 lds
  v_mfma_f32_32x32x16_bf16 v[80:95], v[58:61], v[60:63], v[80:95]
  ds_read_b128 a[252:255], v1 offset:39936
  s_waitcnt lgkmcnt(5)
  v_mfma_f32_32x32x16_bf16 v[96:111], a[232:235], v[136:139], v[96:111]
  ds_read_b128 a[224:227], v1 offset:40960
  s_waitcnt lgkmcnt(5)
  v_mfma_f32_32x32x16_bf16 v[96:111], a[236:239], v[140:143], v[96:111]
  ds_read_b128 a[228:231], v1 offset:41984
  s_waitcnt lgkmcnt(5)
  v_mfma_f32_32x32x16_bf16 v[96:111], a[240:243], v[144:147], v[96:111]
  v_max_f32 v64, 0, v64
  v_max_f32 v65, 0, v65
  v_max_f32 v66, 0, v66
  ds_read_b128 a[232:235], v1 offset:43008
  s_waitcnt lgkmcnt(5)
  v_mfma_f32_32x32x16_bf16 v[96:111], a[244:247], v[148:151], v[96:111]
  buffer_load_dwordx4 v1, s[8:11], s61 offen offset:2048 sc1 lds
  v_max_f32 v67, 0, v67
  v_max_f32 v68, 0, v68
  ds_read_b128 a[236:239], v1 offset:44032
  s_waitcnt lgkmcnt(5)
  v_mfma_f32_32x32x16_bf16 v[96:111], a[248:251], v[152:155], v[96:111]
  v_max_f32 v69, 0, v69
  v_max_f32 v70, 0, v70
  ds_read_b128 a[240:243], v1 offset:45056
  s_waitcnt lgkmcnt(5)
  v_mfma_f32_32x32x16_bf16 v[96:111], a[252:255], v[156:159], v[96:111]
  v_max_f32 v71, 0, v71
  v_mul_f32 v64, v64, v72
  ds_read_b128 a[244:247], v1 offset:46080
  s_waitcnt lgkmcnt(5)
  v_mfma_f32_32x32x16_bf16 v[96:111], a[224:227], v[160:163], v[96:111]
  v_mul_f32 v65, v65, v73
  v_mul_f32 v66, v66, v74
  ds_read_b128 a[248:251], v1 offset:47104
  s_waitcnt lgkmcnt(5)
  v_mfma_f32_32x32x16_bf16 v[96:111], a[228:231], v[164:167], v[96:111]
  buffer_load_dwordx4 v1, s[8:11], s61 offen offset:3072 sc1 lds
  v_mul_f32 v67, v67, v75
  v_mul_f32 v68, v68, v76
  ds_read_b128 a[252:255], v1 offset:48128
  s_waitcnt lgkmcnt(5)
  v_mfma_f32_32x32x16_bf16 v[96:111], a[232:235], v[168:171], v[96:111]
  v_mul_f32 v69, v69, v77
  v_mul_f32 v70, v70, v78
  ds_read_b128 a[224:227], v1 offset:49152
  s_waitcnt lgkmcnt(5)
  v_mfma_f32_32x32x16_bf16 v[96:111], a[236:239], v[172:175], v[96:111]
  v_mul_f32 v71, v71, v79
  v_cvt_pk_bf16_f32 v72, v64, v65
  ds_read_b128 a[228:231], v1 offset:50176
  s_waitcnt lgkmcnt(5)
  v_mfma_f32_32x32x16_bf16 v[96:111], a[240:243], v[176:179], v[96:111]
  v_cvt_pk_bf16_f32 v73, v66, v67
  v_cvt_pk_bf16_f32 v74, v68, v69
  ds_read_b128 a[232:235], v1 offset:51200
  s_waitcnt lgkmcnt(5)
  v_mfma_f32_32x32x16_bf16 v[96:111], a[244:247], v[180:183], v[96:111]
  s_add_u32 m0, s52, 0x19000
  s_add_u32 s61, s35, 0x11000
  buffer_load_dwordx4 v1, s[8:11], s61 offen sc1 lds
  v_cvt_pk_bf16_f32 v75, v70, v71
  s_add_u32 s64, s43, 0x1000
  buffer_store_dwordx4 v[72:75], v1, s[8:11], s64 offen offset:1024 sc1
  ds_read_b128 a[236:239], v1 offset:52224
  s_waitcnt lgkmcnt(5)
  v_mfma_f32_32x32x16_bf16 v[96:111], a[248:251], v[184:187], v[96:111]
  v_max_f32 v80, 0, v80
  v_max_f32 v81, 0, v81
  v_max_f32 v82, 0, v82
  ds_read_b128 a[240:243], v1 offset:53248
  s_waitcnt lgkmcnt(5)
  v_mfma_f32_32x32x16_bf16 v[96:111], a[252:255], v[188:191], v[96:111]
  v_max_f32 v83, 0, v83
  v_max_f32 v84, 0, v84
  ds_read_b128 a[244:247], v1 offset:54272
  s_waitcnt lgkmcnt(5)
  v_mfma_f32_32x32x16_bf16 v[96:111], a[224:227], v[192:195], v[96:111]
  v_max_f32 v85, 0, v85
  v_max_f32 v86, 0, v86
  ds_read_b128 a[248:251], v1 offset:55296
  s_waitcnt lgkmcnt(5)
  v_mfma_f32_32x32x16_bf16 v[96:111], a[228:231], v[196:199], v[96:111]
  buffer_load_dwordx4 v1, s[8:11], s61 offen offset:1024 sc1 lds
  v_max_f32 v87, 0, v87
  v_mul_f32 v80, v80, v88
  ds_read_b128 a[252:255], v1 offset:56320
  s_waitcnt lgkmcnt(5)
  v_mfma_f32_32x32x16_bf16 v[96:111], a[232:235], v[200:203], v[96:111]
  v_mul_f32 v81, v81, v89
  v_mul_f32 v82, v82, v90
  ds_read_b128 a[224:227], v1 offset:57344
  s_waitcnt lgkmcnt(5)
  v_mfma_f32_32x32x16_bf16 v[96:111], a[236:239], v[204:207], v[96:111]
  v_mul_f32 v83, v83, v91
  v_mul_f32 v84, v84, v92
  ds_read_b128 a[228:231], v1 offset:58368
  s_waitcnt lgkmcnt(5)
  v_mfma_f32_32x32x16_bf16 v[96:111], a[240:243], v[208:211], v[96:111]
  v_mul_f32 v85, v85, v93
  v_mul_f32 v86, v86, v94
  ds_read_b32 v56, v28 offset:768
  ds_read_b128 a[232:235], v1 offset:59392
  s_waitcnt lgkmcnt(6)
  v_mfma_f32_32x32x16_bf16 v[96:111], a[244:247], v[212:215], v[96:111]
  buffer_load_dwordx4 v1, s[8:11], s61 offen offset:2048 sc1 lds
  v_mul_f32 v87, v87, v95
  v_cvt_pk_bf16_f32 v88, v80, v81
  ds_read_b128 a[236:239], v1 offset:60416
  s_waitcnt lgkmcnt(6)
  v_mfma_f32_32x32x16_bf16 v[96:111], a[248:251], v[216:219], v[96:111]
  v_cvt_pk_bf16_f32 v89, v82, v83
  v_cvt_pk_bf16_f32 v90, v84, v85
  ds_read_b128 a[240:243], v1 offset:61440
  s_waitcnt lgkmcnt(6)
  v_mfma_f32_32x32x16_bf16 v[96:111], a[252:255], v[220:223], v[96:111]
  v_cvt_pk_bf16_f32 v91, v86, v87
  buffer_store_dwordx4 v[88:91], v1, s[8:11], s64 offen sc1
  ds_read_b128 a[244:247], v1 offset:62464
  s_waitcnt lgkmcnt(6)
  v_mfma_f32_32x32x16_bf16 v[96:111], a[224:227], v[224:227], v[96:111]
  s_waitcnt lgkmcnt(4)
  v_mfma_f32_32x32x16_bf16 v[96:111], v[56:59], v[60:63], v[96:111]
  ds_read_b128 a[248:251], v1 offset:63488
  v_mfma_f32_32x32x16_bf16 v[96:111], a[228:231], v[228:231], v[96:111]
  buffer_load_dwordx4 v1, s[8:11], s61 offen offset:3072 sc1 lds
  ds_read_b128 a[252:255], v1 offset:64512
  s_waitcnt lgkmcnt(5)
  v_mfma_f32_32x32x16_bf16 v[96:111], a[232:235], v[232:235], v[96:111]
  s_waitcnt lgkmcnt(4)
  v_mfma_f32_32x32x16_bf16 v[96:111], a[236:239], v[236:239], v[96:111]
  s_waitcnt lgkmcnt(3)
  v_mfma_f32_32x32x16_bf16 v[96:111], a[240:243], v[240:243], v[96:111]
  s_waitcnt lgkmcnt(0)
  s_waitcnt vmcnt(10)
  s_barrier
  ds_read_b128 a[224:227], v2 offset:0
  ds_read_b128 a[228:231], v2 offset:1024
  v_mfma_f32_32x32x16_bf16 v[96:111], a[244:247], v[244:247], v[96:111]
  s_add_u32 m0, s52, 0x0
  s_add_u32 s61, s35, 0x8000
  buffer_load_dwordx4 v1, s[8:11], s61 offen sc1 lds
  ds_read_b128 a[232:235], v2 offset:2048
  ds_read_b128 a[236:239], v2 offset:3072
  v_mfma_f32_32x32x16_bf16 v[96:111], a[248:251], v[248:251], v[96:111]
  ds_read_b128 a[240:243], v2 offset:4096
  v_mfma_f32_32x32x16_bf16 v[96:111], a[252:255], v[252:255], v[96:111]
  ds_read_b128 a[244:247], v2 offset:5120
  s_waitcnt lgkmcnt(5)
  v_mfma_f32_32x32x16_bf16 v[112:127], a[224:227], v[128:131], 0
  ds_read_b128 a[248:251], v2 offset:6144
  s_waitcnt lgkmcnt(5)
  v_mfma_f32_32x32x16_bf16 v[112:127], a[228:231], v[132:135], v[112:127]
  buffer_load_dwordx4 v1, s[8:11], s61 offen offset:1024 sc1 lds
  ds_read_b128 a[252:255], v2 offset:7168
  s_waitcnt lgkmcnt(5)
  v_mfma_f32_32x32x16_bf16 v[112:127], a[232:235], v[136:139], v[112:127]
  ds_read_b128 a[224:227], v2 offset:8192
  s_waitcnt lgkmcnt(5)
  v_mfma_f32_32x32x16_bf16 v[112:127], a[236:239], v[140:143], v[112:127]
  ds_read_b128 a[228:231], v2 offset:9216
  s_waitcnt lgkmcnt(5)
  v_mfma_f32_32x32x16_bf16 v[112:127], a[240:243], v[144:147], v[112:127]
  v_max_f32 v96, 0, v96
  v_max_f32 v97, 0, v97
  ds_read_b128 a[232:235], v2 offset:10240
  s_waitcnt lgkmcnt(5)
  v_mfma_f32_32x32x16_bf16 v[112:127], a[244:247], v[148:151], v[112:127]
  buffer_load_dwordx4 v1, s[8:11], s61 offen offset:2048 sc1 lds
  v_max_f32 v98, 0, v98
  v_max_f32 v99, 0, v99
  ds_read_b128 a[236:239], v2 offset:11264
  s_waitcnt lgkmcnt(5)
  v_mfma_f32_32x32x16_bf16 v[112:127], a[248:251], v[152:155], v[112:127]
  v_max_f32 v100, 0, v100
  v_max_f32 v101, 0, v101
  ds_read_b128 a[240:243], v2 offset:12288
  s_waitcnt lgkmcnt(5)
  v_mfma_f32_32x32x16_bf16 v[112:127], a[252:255], v[156:159], v[112:127]
  v_max_f32 v102, 0, v102
  v_max_f32 v103, 0, v103
  ds_read_b128 a[244:247], v2 offset:13312
  s_waitcnt lgkmcnt(5)
  v_mfma_f32_32x32x16_bf16 v[112:127], a[224:227], v[160:163], v[112:127]
  v_mul_f32 v96, v96, v104
  v_mul_f32 v97, v97, v105
  ds_read_b128 a[248:251], v2 offset:14336
  s_waitcnt lgkmcnt(5)
  v_mfma_f32_32x32x16_bf16 v[112:127], a[228:231], v[164:167], v[112:127]
  buffer_load_dwordx4 v1, s[8:11], s61 offen offset:3072 sc1 lds
  v_mul_f32 v98, v98, v106
  v_mul_f32 v99, v99, v107
  ds_read_b128 a[252:255], v2 offset:15360
  s_waitcnt lgkmcnt(5)
  v_mfma_f32_32x32x16_bf16 v[112:127], a[232:235], v[168:171], v[112:127]
  v_mul_f32 v100, v100, v108
  v_mul_f32 v101, v101, v109
  ds_read_b128 a[224:227], v2 offset:16384
  s_waitcnt lgkmcnt(5)
  v_mfma_f32_32x32x16_bf16 v[112:127], a[236:239], v[172:175], v[112:127]
  v_mul_f32 v102, v102, v110
  v_mul_f32 v103, v103, v111
  ds_read_b128 a[228:231], v2 offset:17408
  s_waitcnt lgkmcnt(5)
  v_mfma_f32_32x32x16_bf16 v[112:127], a[240:243], v[176:179], v[112:127]
  v_cvt_pk_bf16_f32 v104, v96, v97
  v_cvt_pk_bf16_f32 v105, v98, v99
  ds_read_b128 a[232:235], v2 offset:18432
  s_waitcnt lgkmcnt(5)
  v_mfma_f32_32x32x16_bf16 v[112:127], a[244:247], v[180:183], v[112:127]
  s_add_u32 m0, s52, 0x1000
  s_add_u32 s61, s35, 0x9000
  buffer_load_dwordx4 v1, s[8:11], s61 offen sc1 lds
  v_cvt_pk_bf16_f32 v106, v100, v101
  v_cvt_pk_bf16_f32 v107, v102, v103
  ds_read_b128 a[236:239], v2 offset:19456
  s_waitcnt lgkmcnt(5)
  v_mfma_f32_32x32x16_bf16 v[112:127], a[248:251], v[184:187], v[112:127]
  buffer_store_dwordx4 v[104:107], v1, s[8:11], s64 offen offset:2048 sc1
  ds_read_b128 a[240:243], v2 offset:20480
  s_waitcnt lgkmcnt(5)
  v_mfma_f32_32x32x16_bf16 v[112:127], a[252:255], v[188:191], v[112:127]
  ds_read_b128 a[244:247], v2 offset:21504
  s_waitcnt lgkmcnt(5)
  v_mfma_f32_32x32x16_bf16 v[112:127], a[224:227], v[192:195], v[112:127]
  ds_read_b128 a[248:251], v2 offset:22528
  s_waitcnt lgkmcnt(5)
  v_mfma_f32_32x32x16_bf16 v[112:127], a[228:231], v[196:199], v[112:127]
  buffer_load_dwordx4 v1, s[8:11], s61 offen offset:1024 sc1 lds
  ds_read_b128 a[252:255], v2 offset:23552
  s_waitcnt lgkmcnt(5)
  v_mfma_f32_32x32x16_bf16 v[112:127], a[232:235], v[200:203], v[112:127]
  ds_read_b128 a[224:227], v2 offset:24576
  s_waitcnt lgkmcnt(5)
  v_mfma_f32_32x32x16_bf16 v[112:127], a[236:239], v[204:207], v[112:127]
  ds_read_b128 a[228:231], v2 offset:25600
  s_waitcnt lgkmcnt(5)
  v_mfma_f32_32x32x16_bf16 v[112:127], a[240:243], v[208:211], v[112:127]
  ds_read_b32 v56, v28 offset:384
  ds_read_b128 a[232:235], v2 offset:26624
  s_waitcnt lgkmcnt(6)
  v_mfma_f32_32x32x16_bf16 v[112:127], a[244:247], v[212:215], v[112:127]
  buffer_load_dwordx4 v1, s[8:11], s61 offen offset:2048 sc1 lds
  ds_read_b128 a[236:239], v2 offset:27648
  s_waitcnt lgkmcnt(6)
  v_mfma_f32_32x32x16_bf16 v[112:127], a[248:251], v[216:219], v[112:127]
  ds_read_b128 a[240:243], v2 offset:28672
  s_waitcnt lgkmcnt(6)
  v_mfma_f32_32x32x16_bf16 v[112:127], a[252:255], v[220:223], v[112:127]
  ds_read_b128 a[244:247], v2 offset:29696
  s_waitcnt lgkmcnt(6)
  v_mfma_f32_32x32x16_bf16 v[112:127], a[224:227], v[224:227], v[112:127]
  s_waitcnt lgkmcnt(4)
  v_mfma_f32_32x32x16_bf16 v[112:127], v[56:59], v[60:63], v[112:127]
  ds_read_b128 a[248:251], v2 offset:30720
  v_mfma_f32_32x32x16_bf16 v[112:127], a[228:231], v[228:231], v[112:127]
  buffer_load_dwordx4 v1, s[8:11], s61 offen offset:3072 sc1 lds
  ds_read_b128 a[252:255], v2 offset:31744
  s_waitcnt lgkmcnt(5)
  v_mfma_f32_32x32x16_bf16 v[112:127], a[232:235], v[232:235], v[112:127]
  s_waitcnt lgkmcnt(4)
  v_mfma_f32_32x32x16_bf16 v[112:127], a[236:239], v[236:239], v[112:127]
  s_waitcnt lgkmcnt(3)
  v_mfma_f32_32x32x16_bf16 v[112:127], a[240:243], v[240:243], v[112:127]
  s_waitcnt lgkmcnt(0)
  s_waitcnt vmcnt(9)
  s_barrier
  ds_read_b128 a[224:227], v2 offset:32768
  ds_read_b128 a[228:231], v2 offset:33792
  v_mfma_f32_32x32x16_bf16 v[112:127], a[244:247], v[244:247], v[112:127]
  s_add_u32 m0, s52, 0x8000
  s_add_u32 s61, s35, 0x0
  buffer_load_dwordx4 v1, s[8:11], s61 offen sc1 lds
  ds_read_b128 a[232:235], v2 offset:34816
  ds_read_b128 a[236:239], v2 offset:35840
  v_mfma_f32_32x32x16_bf16 v[112:127], a[248:251], v[248:251], v[112:127]
  ds_read_b128 a[240:243], v2 offset:36864
  v_mfma_f32_32x32x16_bf16 v[112:127], a[252:255], v[252:255], v[112:127]
  ds_read_b128 a[244:247], v2 offset:37888
  s_waitcnt lgkmcnt(5)
  v_mfma_f32_32x32x16_bf16 v[64:79], a[224:227], v[128:131], 0
  ds_read_b128 a[248:251], v2 offset:38912
  s_waitcnt lgkmcnt(5)
  v_mfma_f32_32x32x16_bf16 v[64:79], a[228:231], v[132:135], v[64:79]
  buffer_load_dwordx4 v1, s[8:11], s61 offen offset:1024 sc1 lds
  ds_read_b128 a[252:255], v2 offset:39936
  s_waitcnt lgkmcnt(5)
  v_mfma_f32_32x32x16_bf16 v[64:79], a[232:235], v[136:139], v[64:79]
  ds_read_b128 a[224:227], v2 offset:40960
  s_waitcnt lgkmcnt(5)
  v_mfma_f32_32x32x16_bf16 v[64:79], a[236:239], v[140:143], v[64:79]
  ds_read_b128 a[228:231], v2 offset:41984
  s_waitcnt lgkmcnt(5)
  v_mfma_f32_32x32x16_bf16 v[64:79], a[240:243], v[144:147], v[64:79]
  v_max_f32 v112, 0, v112
  v_max_f32 v113, 0, v113
  ds_read_b128 a[232:235], v2 offset:43008
  s_waitcnt lgkmcnt(5)
  v_mfma_f32_32x32x16_bf16 v[64:79], a[244:247], v[148:151], v[64:79]
  buffer_load_dwordx4 v1, s[8:11], s61 offen offset:2048 sc1 lds
  v_max_f32 v114, 0, v114
  v_max_f32 v115, 0, v115
  ds_read_b128 a[236:239], v2 offset:44032
  s_waitcnt lgkmcnt(5)
  v_mfma_f32_32x32x16_bf16 v[64:79], a[248:251], v[152:155], v[64:79]
  v_max_f32 v116, 0, v116
  v_max_f32 v117, 0, v117
  ds_read_b128 a[240:243], v2 offset:45056
  s_waitcnt lgkmcnt(5)
  v_mfma_f32_32x32x16_bf16 v[64:79], a[252:255], v[156:159], v[64:79]
  v_max_f32 v118, 0, v118
  v_max_f32 v119, 0, v119
  ds_read_b128 a[244:247], v2 offset:46080
  s_waitcnt lgkmcnt(5)
  v_mfma_f32_32x32x16_bf16 v[64:79], a[224:227], v[160:163], v[64:79]
  v_mul_f32 v112, v112, v120
  v_mul_f32 v113, v113, v121
  ds_read_b128 a[248:251], v2 offset:47104
  s_waitcnt lgkmcnt(5)
  v_mfma_f32_32x32x16_bf16 v[64:79], a[228:231], v[164:167], v[64:79]
  buffer_load_dwordx4 v1, s[8:11], s61 offen offset:3072 sc1 lds
  v_mul_f32 v114, v114, v122
  v_mul_f32 v115, v115, v123
  ds_read_b128 a[252:255], v2 offset:48128
  s_waitcnt lgkmcnt(5)
  v_mfma_f32_32x32x16_bf16 v[64:79], a[232:235], v[168:171], v[64:79]
  v_mul_f32 v116, v116, v124
  v_mul_f32 v117, v117, v125
  ds_read_b128 a[224:227], v2 offset:49152
  s_waitcnt lgkmcnt(5)
  v_mfma_f32_32x32x16_bf16 v[64:79], a[236:239], v[172:175], v[64:79]
  v_mul_f32 v118, v118, v126
  v_mul_f32 v119, v119, v127
  ds_read_b128 a[228:231], v2 offset:50176
  s_waitcnt lgkmcnt(5)
  v_mfma_f32_32x32x16_bf16 v[64:79], a[240:243], v[176:179], v[64:79]
  v_cvt_pk_bf16_f32 v120, v112, v113
  v_cvt_pk_bf16_f32 v121, v114, v115
  ds_read_b128 a[232:235], v2 offset:51200
  s_waitcnt lgkmcnt(5)
  v_mfma_f32_32x32x16_bf16 v[64:79], a[244:247], v[180:183], v[64:79]
  s_add_u32 m0, s52, 0x9000
  s_add_u32 s61, s35, 0x1000
  buffer_load_dwordx4 v1, s[8:11], s61 offen sc1 lds
  v_cvt_pk_bf16_f32 v122, v116, v117
  v_cvt_pk_bf16_f32 v123, v118, v119
  ds_read_b128 a[236:239], v2 offset:52224
  s_waitcnt lgkmcnt(5)
  v_mfma_f32_32x32x16_bf16 v[64:79], a[248:251], v[184:187], v[64:79]
  buffer_store_dwordx4 v[120:123], v1, s[8:11], s43 offen offset:3072 sc1
  ds_read_b128 a[240:243], v2 offset:53248
  s_waitcnt lgkmcnt(5)
  v_mfma_f32_32x32x16_bf16 v[64:79], a[252:255], v[188:191], v[64:79]
  ds_read_b128 a[244:247], v2 offset:54272
  s_waitcnt lgkmcnt(5)
  v_mfma_f32_32x32x16_bf16 v[64:79], a[224:227], v[192:195], v[64:79]
  ds_read_b128 a[248:251], v2 offset:55296
  s_waitcnt lgkmcnt(5)
  v_mfma_f32_32x32x16_bf16 v[64:79], a[228:231], v[196:199], v[64:79]
  buffer_load_dwordx4 v1, s[8:11], s61 offen offset:1024 sc1 lds
  ds_read_b128 a[252:255], v2 offset:56320
  s_waitcnt lgkmcnt(5)
  v_mfma_f32_32x32x16_bf16 v[64:79], a[232:235], v[200:203], v[64:79]
  ds_read_b128 a[224:227], v2 offset:57344
  s_waitcnt lgkmcnt(5)
  v_mfma_f32_32x32x16_bf16 v[64:79], a[236:239], v[204:207], v[64:79]
  ds_read_b128 a[228:231], v2 offset:58368
  s_waitcnt lgkmcnt(5)
  v_mfma_f32_32x32x16_bf16 v[64:79], a[240:243], v[208:211], v[64:79]
  ds_read_b32 v56, v28 offset:256
  ds_read_b128 a[232:235], v2 offset:59392
  s_waitcnt lgkmcnt(6)
  v_mfma_f32_32x32x16_bf16 v[64:79], a[244:247], v[212:215], v[64:79]
  buffer_load_dwordx4 v1, s[8:11], s61 offen offset:2048 sc1 lds
  ds_read_b128 a[236:239], v2 offset:60416
  s_waitcnt lgkmcnt(6)
  v_mfma_f32_32x32x16_bf16 v[64:79], a[248:251], v[216:219], v[64:79]
  ds_read_b128 a[240:243], v2 offset:61440
  s_waitcnt lgkmcnt(6)
  v_mfma_f32_32x32x16_bf16 v[64:79], a[252:255], v[220:223], v[64:79]
  ds_read_b128 a[244:247], v2 offset:62464
  s_waitcnt lgkmcnt(6)
  v_mfma_f32_32x32x16_bf16 v[64:79], a[224:227], v[224:227], v[64:79]
  s_waitcnt lgkmcnt(4)
  v_mfma_f32_32x32x16_bf16 v[64:79], v[56:59], v[60:63], v[64:79]
  ds_read_b128 a[248:251], v2 offset:63488
  v_mfma_f32_32x32x16_bf16 v[64:79], a[228:231], v[228:231], v[64:79]
  buffer_load_dwordx4 v1, s[8:11], s61 offen offset:3072 sc1 lds
  ds_read_b128 a[252:255], v2 offset:64512
  s_waitcnt lgkmcnt(5)
  v_mfma_f32_32x32x16_bf16 v[64:79], a[232:235], v[232:235], v[64:79]
  s_waitcnt lgkmcnt(4)
  v_mfma_f32_32x32x16_bf16 v[64:79], a[236:239], v[236:239], v[64:79]
  s_waitcnt lgkmcnt(3)
  v_mfma_f32_32x32x16_bf16 v[64:79], a[240:243], v[240:243], v[64:79]
  s_waitcnt lgkmcnt(0)
  s_waitcnt vmcnt(9)
  s_barrier
  ds_read_b128 a[224:227], v1 offset:0
  ds_read_b128 a[228:231], v1 offset:1024
  v_mfma_f32_32x32x16_bf16 v[64:79], a[244:247], v[244:247], v[64:79]
  ds_read_b128 a[232:235], v1 offset:2048
  ds_read_b128 a[236:239], v1 offset:3072
  v_mfma_f32_32x32x16_bf16 v[64:79], a[248:251], v[248:251], v[64:79]
  ds_read_b128 a[240:243], v1 offset:4096
  v_mfma_f32_32x32x16_bf16 v[64:79], a[252:255], v[252:255], v[64:79]
  ds_read_b128 a[244:247], v1 offset:5120
  s_waitcnt lgkmcnt(5)
  v_mfma_f32_32x32x16_bf16 v[80:95], a[224:227], v[128:131], 0
  ds_read_b128 a[248:251], v1 offset:6144
  s_waitcnt lgkmcnt(5)
  v_mfma_f32_32x32x16_bf16 v[80:95], a[228:231], v[132:135], v[80:95]
  ds_read_b128 a[252:255], v1 offset:7168
  s_waitcnt lgkmcnt(5)
  v_mfma_f32_32x32x16_bf16 v[80:95], a[232:235], v[136:139], v[80:95]
  ds_read_b128 a[224:227], v1 offset:8192
  s_waitcnt lgkmcnt(5)
  v_mfma_f32_32x32x16_bf16 v[80:95], a[236:239], v[140:143], v[80:95]
  ds_read_b128 a[228:231], v1 offset:9216
  s_waitcnt lgkmcnt(5)
  v_mfma_f32_32x32x16_bf16 v[80:95], a[240:243], v[144:147], v[80:95]
  v_max_f32 v64, 0, v64
  v_max_f32 v65, 0, v65
  ds_read_b128 a[232:235], v1 offset:10240
  s_waitcnt lgkmcnt(5)
  v_mfma_f32_32x32x16_bf16 v[80:95], a[244:247], v[148:151], v[80:95]
  v_max_f32 v66, 0, v66
  v_max_f32 v67, 0, v67
  ds_read_b128 a[236:239], v1 offset:11264
  s_waitcnt lgkmcnt(5)
  v_mfma_f32_32x32x16_bf16 v[80:95], a[248:251], v[152:155], v[80:95]
  v_max_f32 v68, 0, v68
  v_max_f32 v69, 0, v69
  ds_read_b128 a[240:243], v1 offset:12288
  s_waitcnt lgkmcnt(5)
  v_mfma_f32_32x32x16_bf16 v[80:95], a[252:255], v[156:159], v[80:95]
  v_max_f32 v70, 0, v70
  v_max_f32 v71, 0, v71
  ds_read_b128 a[244:247], v1 offset:13312
  s_waitcnt lgkmcnt(5)
  v_mfma_f32_32x32x16_bf16 v[80:95], a[224:227], v[160:163], v[80:95]
  v_mul_f32 v64, v64, v72
  v_mul_f32 v65, v65, v73
  ds_read_b128 a[248:251], v1 offset:14336
  s_waitcnt lgkmcnt(5)
  v_mfma_f32_32x32x16_bf16 v[80:95], a[228:231], v[164:167], v[80:95]
  v_mul_f32 v66, v66, v74
  v_mul_f32 v67, v67, v75
  ds_read_b128 a[252:255], v1 offset:15360
  s_waitcnt lgkmcnt(5)
  v_mfma_f32_32x32x16_bf16 v[80:95], a[232:235], v[168:171], v[80:95]
  v_mul_f32 v68, v68, v76
  v_mul_f32 v69, v69, v77
  ds_read_b128 a[224:227], v1 offset:16384
  s_waitcnt lgkmcnt(5)
  v_mfma_f32_32x32x16_bf16 v[80:95], a[236:239], v[172:175], v[80:95]
  v_mul_f32 v70, v70, v78
  v_mul_f32 v71, v71, v79
  ds_read_b128 a[228:231], v1 offset:17408
  s_waitcnt lgkmcnt(5)
  v_mfma_f32_32x32x16_bf16 v[80:95], a[240:243], v[176:179], v[80:95]
  v_cvt_pk_bf16_f32 v72, v64, v65
  v_cvt_pk_bf16_f32 v73, v66, v67
  ds_read_b128 a[232:235], v1 offset:18432
  s_waitcnt lgkmcnt(5)
  v_mfma_f32_32x32x16_bf16 v[80:95], a[244:247], v[180:183], v[80:95]
  v_cvt_pk_bf16_f32 v74, v68, v69
  v_cvt_pk_bf16_f32 v75, v70, v71
  ds_read_b128 a[236:239], v1 offset:19456
  s_waitcnt lgkmcnt(5)
  v_mfma_f32_32x32x16_bf16 v[80:95], a[248:251], v[184:187], v[80:95]
  buffer_store_dwordx4 v[72:75], v1, s[8:11], s43 offen offset:2048 sc1
  ds_read_b128 a[240:243], v1 offset:20480
  s_waitcnt lgkmcnt(5)
  v_mfma_f32_32x32x16_bf16 v[80:95], a[252:255], v[188:191], v[80:95]
  s_add_u32 s65, s48, 0x2000
  s_add_u32 s66, s47, 0x2000
  s_waitcnt vmcnt(4)
  s_add_u32 s70, s31, 11
  v_mov_b32 v31, s70
  s_cmp_lg_u32 s58, 0
  s_cbranch_scc1 ALT_21
  buffer_store_dword v31, v5, s[8:11], s65 offen
ALTB_21:
  ds_read_b128 a[244:247], v1 offset:21504
  s_waitcnt lgkmcnt(5)
  v_mfma_f32_32x32x16_bf16 v[80:95], a[224:227], v[192:195], v[80:95]
  ds_read_b128 a[248:251], v1 offset:22528
  s_waitcnt lgkmcnt(5)
  v_mfma_f32_32x32x16_bf16 v[80:95], a[228:231], v[196:199], v[80:95]
  ds_read_b128 a[252:255], v1 offset:23552
  s_waitcnt lgkmcnt(5)
  v_mfma_f32_32x32x16_bf16 v[80:95], a[232:235], v[200:203], v[80:95]
  ds_read_b128 a[224:227], v1 offset:24576
  s_waitcnt lgkmcnt(5)
  v_mfma_f32_32x32x16_bf16 v[80:95], a[236:239], v[204:207], v[80:95]
  ds_read_b128 a[228:231], v1 offset:25600
  s_waitcnt lgkmcnt(5)
  v_mfma_f32_32x32x16_bf16 v[80:95], a[240:243], v[208:211], v[80:95]
  ds_read_b32 v56, v28 offset:128
  ds_read_b128 a[232:235], v1 offset:26624
  s_waitcnt lgkmcnt(6)
  v_mfma_f32_32x32x16_bf16 v[80:95], a[244:247], v[212:215], v[80:95]
  ds_read_b128 a[236:239], v1 offset:27648
  s_waitcnt lgkmcnt(6)
  v_mfma_f32_32x32x16_bf16 v[80:95], a[248:251], v[216:219], v[80:95]
  ds_read_b128 a[240:243], v1 offset:28672
  s_waitcnt lgkmcnt(6)
  v_mfma_f32_32x32x16_bf16 v[80:95], a[252:255], v[220:223], v[80:95]
  ds_read_b128 a[244:247], v1 offset:29696
  s_waitcnt lgkmcnt(6)
  v_mfma_f32_32x32x16_bf16 v[80:95], a[224:227], v[224:227], v[80:95]
  s_waitcnt lgkmcnt(4)
  v_mfma_f32_32x32x16_bf16 v[80:95], v[56:59], v[60:63], v[80:95]
  ds_read_b128 a[248:251], v1 offset:30720
  v_mfma_f32_32x32x16_bf16 v[80:95], a[228:231], v[228:231], v[80:95]
  ds_read_b128 a[252:255], v1 offset:31744
  s_waitcnt lgkmcnt(5)
  v_mfma_f32_32x32x16_bf16 v[80:95], a[232:235], v[232:235], v[80:95]
  s_waitcnt lgkmcnt(4)
  v_mfma_f32_32x32x16_bf16 v[80:95], a[236:239], v[236:239], v[80:95]
  s_waitcnt lgkmcnt(3)
  v_mfma_f32_32x32x16_bf16 v[80:95], a[240:243], v[240:243], v[80:95]
  buffer_load_dword v26, v4, s[8:11], s66 offen sc1
  s_waitcnt lgkmcnt(0)
  s_waitcnt vmcnt(3)
  s_barrier
  ds_read_b128 a[224:227], v1 offset:32768
  ds_read_b128 a[228:231], v1 offset:33792
  v_mfma_f32_32x32x16_bf16 v[80:95], a[244:247], v[244:247], v[80:95]
  ds_read_b128 a[232:235], v1 offset:34816
  ds_read_b128 a[236:239], v1 offset:35840
  v_mfma_f32_32x32x16_bf16 v[80:95], a[248:251], v[248:251], v[80:95]
  s_and_b32 s71, s28, 3
  s_lshl_b32 s71, s71, 13
  s_add_u32 s71, s71, s45
  buffer_load_dword v21, v5, s[8:11], s71 offen sc1
  ds_read_b128 a[240:243], v1 offset:36864
  v_mfma_f32_32x32x16_bf16 v[80:95], a[252:255], v[252:255], v[80:95]
  ds_read_b128 a[244:247], v1 offset:37888
  s_waitcnt lgkmcnt(5)
  v_mfma_f32_32x32x16_bf16 v[96:111], a[224:227], v[128:131], 0
  ds_read_b128 a[248:251], v1 offset:38912
  s_waitcnt lgkmcnt(5)
  v_mfma_f32_32x32x16_bf16 v[96:111], a[228:231], v[132:135], v[96:111]
  ds_read_b128 a[252:255], v1 offset:39936
  s_waitcnt lgkmcnt(5)
  v_mfma_f32_32x32x16_bf16 v[96:111], a[232:235], v[136:139], v[96:111]
  ds_read_b128 a[224:227], v1 offset:40960
  s_waitcnt lgkmcnt(5)
  v_mfma_f32_32x32x16_bf16 v[96:111], a[236:239], v[140:143], v[96:111]
  ds_read_b128 a[228:231], v1 offset:41984
  s_waitcnt lgkmcnt(5)
  v_mfma_f32_32x32x16_bf16 v[96:111], a[240:243], v[144:147], v[96:111]
  v_max_f32 v80, 0, v80
  v_max_f32 v81, 0, v81
  ds_read_b128 a[232:235], v1 offset:43008
  s_waitcnt lgkmcnt(5)
  v_mfma_f32_32x32x16_bf16 v[96:111], a[244:247], v[148:151], v[96:111]
  v_max_f32 v82, 0, v82
  v_max_f32 v83, 0, v83
  ds_read_b128 a[236:239], v1 offset:44032
  s_waitcnt lgkmcnt(5)
  v_mfma_f32_32x32x16_bf16 v[96:111], a[248:251], v[152:155], v[96:111]
  v_max_f32 v84, 0, v84
  v_max_f32 v85, 0, v85
  ds_read_b128 a[240:243], v1 offset:45056
  s_waitcnt lgkmcnt(5)
  s_branch PGS10
.p2align 12
PG10:
  s_branch PGB
PGS10:
  v_mfma_f32_32x32x16_bf16 v[96:111], a[252:255], v[156:159], v[96:111]
  v_max_f32 v86, 0, v86
  v_max_f32 v87, 0, v87
  ds_read_b128 a[244:247], v1 offset:46080
  s_waitcnt lgkmcnt(5)
  v_mfma_f32_32x32x16_bf16 v[96:111], a[224:227], v[160:163], v[96:111]
  v_mul_f32 v80, v80, v88
  v_mul_f32 v81, v81, v89
  s_add_u32 s68, s31, 11
  s_waitcnt vmcnt(1)
  v_subrev_u32 v26, s68, v26
  v_cmp_lt_u32 vcc, 15, v26
  s_cbranch_vccz HC_29
  s_mov_b32 s69, 0
POLL_30:
  buffer_load_dword v26, v4, s[8:11], s66 offen sc1
  s_waitcnt vmcnt(0)
  s_add_u32 s68, s31, 11
  s_waitcnt vmcnt(0)
  v_subrev_u32 v26, s68, v26
  s_waitcnt vmcnt(0)
  v_cmp_lt_u32 vcc, 15, v26
  s_cbranch_vccz PD_31
  s_add_u32 s69, s69, 1
  s_cmp_lt_u32 s69, s33
  s_cbranch_scc1 POLL_30
  s_mov_b32 s33, 1
PD_31:
HC_29:
  ds_read_b128 a[248:251], v1 offset:47104
  s_waitcnt lgkmcnt(5)
  v_mfma_f32_32x32x16_bf16 v[96:111], a[228:231], v[164:167], v[96:111]
  v_mul_f32 v82, v82, v90
  v_mul_f32 v83, v83, v91
  s_add_u32 s60, s72, 0x1000
  buffer_load_dwordx4 v[128:131], v1, s[8:11], s60 offen offset:1024 sc1
  ds_read_b128 a[252:255], v1 offset:48128
  s_waitcnt lgkmcnt(5)
  v_mfma_f32_32x32x16_bf16 v[96:111], a[232:235], v[168:171], v[96:111]
  v_mul_f32 v84, v84, v92
  v_mul_f32 v85, v85, v93
  s_add_u32 s60, s73, 0x1000
  buffer_load_dwordx4 v[132:135], v1, s[8:11], s60 offen offset:1024 sc1
  ds_read_b128 a[224:227], v1 offset:49152
  s_waitcnt lgkmcnt(5)
  v_mfma_f32_32x32x16_bf16 v[96:111], a[236:239], v[172:175], v[96:111]
  v_mul_f32 v86, v86, v94
  v_mul_f32 v87, v87, v95
  ds_read_b128 a[228:231], v1 offset:50176
  s_waitcnt lgkmcnt(5)
  v_mfma_f32_32x32x16_bf16 v[96:111], a[240:243], v[176:179], v[96:111]
  v_cvt_pk_bf16_f32 v88, v80, v81
  v_cvt_pk_bf16_f32 v89, v82, v83
  s_add_u32 s60, s74, 0x1000
  buffer_load_dwordx4 v[136:139], v1, s[8:11], s60 offen offset:1024 sc1
  ds_read_b128 a[232:235], v1 offset:51200
  s_waitcnt lgkmcnt(5)
  v_mfma_f32_32x32x16_bf16 v[96:111], a[244:247], v[180:183], v[96:111]
  v_cvt_pk_bf16_f32 v90, v84, v85
  v_cvt_pk_bf16_f32 v91, v86, v87
  ds_read_b128 a[236:239], v1 offset:52224
  s_waitcnt lgkmcnt(5)
  v_mfma_f32_32x32x16_bf16 v[96:111], a[248:251], v[184:187], v[96:111]
  buffer_store_dwordx4 v[88:91], v1, s[8:11], s43 offen offset:1024 sc1
  s_add_u32 s60, s75, 0x1000
  buffer_load_dwordx4 v[140:143], v1, s[8:11], s60 offen offset:1024 sc1
  ds_read_b128 a[240:243], v1 offset:53248
  s_waitcnt lgkmcnt(5)
  v_mfma_f32_32x32x16_bf16 v[96:111], a[252:255], v[188:191], v[96:111]
  ds_read_b128 a[244:247], v1 offset:54272
  s_waitcnt lgkmcnt(5)
  v_mfma_f32_32x32x16_bf16 v[96:111], a[224:227], v[192:195], v[96:111]
  s_add_u32 s62, s72, 0x1d000
  buffer_load_dwordx4 v[144:147], v1, s[8:11], s62 offen offset:1024 sc1
  ds_read_b128 a[248:251], v1 offset:55296
  s_waitcnt lgkmcnt(5)
  v_mfma_f32_32x32x16_bf16 v[96:111], a[228:231], v[196:199], v[96:111]
  ds_read_b128 a[252:255], v1 offset:56320
  s_waitcnt lgkmcnt(5)
  v_mfma_f32_32x32x16_bf16 v[96:111], a[232:235], v[200:203], v[96:111]
  s_add_u32 s62, s73, 0x1d000
  buffer_load_dwordx4 v[148:151], v1, s[8:11], s62 offen offset:1024 sc1
  ds_read_b128 a[224:227], v1 offset:57344
  s_waitcnt lgkmcnt(5)
  v_mfma_f32_32x32x16_bf16 v[96:111], a[236:239], v[204:207], v[96:111]
  ds_read_b128 a[228:231], v1 offset:58368
  s_waitcnt lgkmcnt(5)
  v_mfma_f32_32x32x16_bf16 v[96:111], a[240:243], v[208:211], v[96:111]
  ds_read_b32 v56, v28 offset:0
  s_add_u32 s62, s74, 0x1d000
  buffer_load_dwordx4 v[152:155], v1, s[8:11], s62 offen offset:1024 sc1
  ds_read_b128 a[232:235], v1 offset:59392
  s_waitcnt lgkmcnt(6)
  v_mfma_f32_32x32x16_bf16 v[96:111], a[244:247], v[212:215], v[96:111]
  ds_read_b128 a[236:239], v1 offset:60416
  s_waitcnt lgkmcnt(6)
  v_mfma_f32_32x32x16_bf16 v[96:111], a[248:251], v[216:219], v[96:111]
  s_add_u32 s62, s75, 0x1d000
  buffer_load_dwordx4 v[156:159], v1, s[8:11], s62 offen offset:1024 sc1
  ds_read_b128 a[240:243], v1 offset:61440
  s_waitcnt lgkmcnt(6)
  v_mfma_f32_32x32x16_bf16 v[96:111], a[252:255], v[220:223], v[96:111]
  ds_read_b128 a[244:247], v1 offset:62464
  s_waitcnt lgkmcnt(6)
  v_mfma_f32_32x32x16_bf16 v[96:111], a[224:227], v[224:227], v[96:111]
  s_waitcnt lgkmcnt(4)
  v_mfma_f32_32x32x16_bf16 v[96:111], v[56:59], v[60:63], v[96:111]
  s_add_u32 s60, s72, 0x1000
  buffer_load_dwordx4 v[160:163], v1, s[8:11], s60 offen sc1
  ds_read_b128 a[248:251], v1 offset:63488
  v_mfma_f32_32x32x16_bf16 v[96:111], a[228:231], v[228:231], v[96:111]
  ds_read_b128 a[252:255], v1 offset:64512
  s_waitcnt lgkmcnt(5)
  v_mfma_f32_32x32x16_bf16 v[96:111], a[232:235], v[232:235], v[96:111]
  s_add_u32 s62, s72, 0x1d000
  buffer_load_dwordx4 v[164:167], v1, s[8:11], s62 offen sc1
  s_waitcnt lgkmcnt(4)
  v_mfma_f32_32x32x16_bf16 v[96:111], a[236:239], v[236:239], v[96:111]
  s_waitcnt vmcnt(7)
  s_add_u32 s70, s31, 13
  v_mov_b32 v31, s70
  s_cmp_lg_u32 s58, 0
  s_cbranch_scc1 ALT_22
  buffer_store_dword v31, v5, s[8:11], s65 offen
ALTB_22:
  s_waitcnt lgkmcnt(3)
  v_mfma_f32_32x32x16_bf16 v[96:111], a[240:243], v[240:243], v[96:111]
  s_add_u32 s60, s73, 0x1000
  buffer_load_dwordx4 v[168:171], v1, s[8:11], s60 offen sc1
  s_waitcnt lgkmcnt(2)
  v_mfma_f32_32x32x16_bf16 v[96:111], a[244:247], v[244:247], v[96:111]
  s_waitcnt lgkmcnt(1)
  v_mfma_f32_32x32x16_bf16 v[96:111], a[248:251], v[248:251], v[96:111]
  s_add_u32 s62, s73, 0x1d000
  buffer_load_dwordx4 v[172:175], v1, s[8:11], s62 offen sc1
  s_waitcnt lgkmcnt(0)
  v_mfma_f32_32x32x16_bf16 v[96:111], a[252:255], v[252:255], v[96:111]
  v_add_u32 v27, 0x8000, v15
  v_mfma_f32_32x32x16_bf16 v[64:79], a[40:43], v[128:131], 0
  v_mfma_f32_32x32x16_bf16 v[80:95], a[44:47], v[128:131], 0
  s_nop 8
  v_max_f32 v96, 0, v96
  v_max_f32 v97, 0, v97
  v_max_f32 v98, 0, v98
  s_add_u32 s60, s74, 0x1000
  buffer_load_dwordx4 v[176:179], v1, s[8:11], s60 offen sc1
  v_mfma_f32_32x32x16_bf16 v[64:79], a[88:91], v[132:135], v[64:79]
  v_max_f32 v99, 0, v99
  v_max_f32 v100, 0, v100
  v_max_f32 v101, 0, v101
  v_mfma_f32_32x32x16_bf16 v[80:95], a[92:95], v[132:135], v[80:95]
  v_max_f32 v102, 0, v102
  v_max_f32 v103, 0, v103
  v_mul_f32 v96, v96, v104
  s_add_u32 s62, s74, 0x1d000
  buffer_load_dwordx4 v[180:183], v1, s[8:11], s62 offen sc1
  v_mfma_f32_32x32x16_bf16 v[64:79], a[136:139], v[136:139], v[64:79]
  v_mul_f32 v97, v97, v105
  v_mul_f32 v98, v98, v106
  v_mul_f32 v99, v99, v107
  v_mfma_f32_32x32x16_bf16 v[80:95], a[140:143], v[136:139], v[80:95]
  v_mul_f32 v100, v100, v108
  v_mul_f32 v101, v101, v109
  v_mul_f32 v102, v102, v110
  s_add_u32 s60, s75, 0x1000
  buffer_load_dwordx4 v[184:187], v1, s[8:11], s60 offen sc1
  s_waitcnt vmcnt(12)
  v_mfma_f32_32x32x16_bf16 v[64:79], a[184:187], v[140:143], v[64:79]
  v_mul_f32 v103, v103, v111
  v_cvt_pk_bf16_f32 v104, v96, v97
  v_cvt_pk_bf16_f32 v105, v98, v99
  v_mfma_f32_32x32x16_bf16 v[80:95], a[188:191], v[140:143], v[80:95]
  v_cvt_pk_bf16_f32 v106, v100, v101
  v_cvt_pk_bf16_f32 v107, v102, v103
  buffer_store_dwordx4 v[104:107], v1, s[8:11], s43 offen sc1
  s_add_u32 s62, s75, 0x1d000
  buffer_load_dwordx4 v[188:191], v1, s[8:11], s62 offen sc1
  s_waitcnt vmcnt(13)
  v_mfma_f32_32x32x16_bf16 v[96:111], a[40:43], v[144:147], 0
  v_mfma_f32_32x32x16_bf16 v[112:127], a[44:47], v[144:147], 0
  s_add_u32 s60, s72, 0x1000
  buffer_load_dwordx4 v[192:195], v1, s[8:11], s60 offen offset:2048 sc1
  s_waitcnt vmcnt(13)
  v_mfma_f32_32x32x16_bf16 v[96:111], a[88:91], v[148:151], v[96:111]
  v_mfma_f32_32x32x16_bf16 v[112:127], a[92:95], v[148:151], v[112:127]
  s_add_u32 s62, s72, 0x1d000
  buffer_load_dwordx4 v[196:199], v1, s[8:11], s62 offen offset:2048 sc1
  s_waitcnt vmcnt(13)
  v_mfma_f32_32x32x16_bf16 v[96:111], a[136:139], v[152:155], v[96:111]
  v_mfma_f32_32x32x16_bf16 v[112:127], a[140:143], v[152:155], v[112:127]
  s_add_u32 s60, s73, 0x1000
  buffer_load_dwordx4 v[200:203], v1, s[8:11], s60 offen offset:2048 sc1
  s_waitcnt vmcnt(13)
  v_mfma_f32_32x32x16_bf16 v[96:111], a[184:187], v[156:159], v[96:111]
  v_mfma_f32_32x32x16_bf16 v[112:127], a[188:191], v[156:159], v[112:127]
  s_add_u32 s62, s73, 0x1d000
  buffer_load_dwordx4 v[204:207], v1, s[8:11], s62 offen offset:2048 sc1
  s_waitcnt vmcnt(13)
  v_mfma_f32_32x32x16_bf16 v[64:79], a[32:35], v[160:163], v[64:79]
  v_mfma_f32_32x32x16_bf16 v[80:95], a[36:39], v[160:163], v[80:95]
  s_add_u32 s60, s74, 0x1000
  buffer_load_dwordx4 v[208:211], v1, s[8:11], s60 offen offset:2048 sc1
  s_waitcnt vmcnt(13)
  v_mfma_f32_32x32x16_bf16 v[96:111], a[32:35], v[164:167], v[96:111]
  v_mfma_f32_32x32x16_bf16 v[112:127], a[36:39], v[164:167], v[112:127]
  s_add_u32 s62, s74, 0x1d000
  buffer_load_dwordx4 v[212:215], v1, s[8:11], s62 offen offset:2048 sc1
  s_waitcnt vmcnt(12)
  v_mfma_f32_32x32x16_bf16 v[64:79], a[80:83], v[168:171], v[64:79]
  v_mfma_f32_32x32x16_bf16 v[80:95], a[84:87], v[168:171], v[80:95]
  buffer_load_dword v26, v4, s[8:11], s66 offen sc1
  s_add_u32 s60, s75, 0x1000
  buffer_load_dwordx4 v[216:219], v1, s[8:11], s60 offen offset:2048 sc1
  s_waitcnt vmcnt(13)
  v_mfma_f32_32x32x16_bf16 v[96:111], a[80:83], v[172:175], v[96:111]
  v_mfma_f32_32x32x16_bf16 v[112:127], a[84:87], v[172:175], v[112:127]
  s_add_u32 s62, s75, 0x1d000
  buffer_load_dwordx4 v[220:223], v1, s[8:11], s62 offen offset:2048 sc1
  s_waitcnt vmcnt(13)
  v_mfma_f32_32x32x16_bf16 v[64:79], a[128:131], v[176:179], v[64:79]
  v_mfma_f32_32x32x16_bf16 v[80:95], a[132:135], v[176:179], v[80:95]
  buffer_load_dwordx4 v[224:227], v1, s[8:11], s72 offen offset:3072 sc1
  s_waitcnt vmcnt(13)
  v_mfma_f32_32x32x16_bf16 v[96:111], a[128:131], v[180:183], v[96:111]
  v_mfma_f32_32x32x16_bf16 v[112:127], a[132:135], v[180:183], v[112:127]
  s_add_u32 s62, s72, 0x1c000
  buffer_load_dwordx4 v[228:231], v1, s[8:11], s62 offen offset:3072 sc1
  s_waitcnt vmcnt(13)
  v_mfma_f32_32x32x16_bf16 v[64:79], a[176:179], v[184:187], v[64:79]
  v_mfma_f32_32x32x16_bf16 v[80:95], a[180:183], v[184:187], v[80:95]
  buffer_load_dwordx4 v[232:235], v1, s[8:11], s73 offen offset:3072 sc1
  s_waitcnt vmcnt(12)
  v_mfma_f32_32x32x16_bf16 v[96:111], a[176:179], v[188:191], v[96:111]
  v_mfma_f32_32x32x16_bf16 v[112:127], a[180:183], v[188:191], v[112:127]
  s_add_u32 s62, s73, 0x1c000
  buffer_load_dwordx4 v[236:239], v1, s[8:11], s62 offen offset:3072 sc1
  s_waitcnt vmcnt(12)
  v_mfma_f32_32x32x16_bf16 v[64:79], a[192:195], v[192:195], v[64:79]
  v_mfma_f32_32x32x16_bf16 v[80:95], a[196:199], v[192:195], v[80:95]
  buffer_load_dwordx4 v[240:243], v1, s[8:11], s74 offen offset:3072 sc1
  s_waitcnt vmcnt(12)
  v_mfma_f32_32x32x16_bf16 v[96:111], a[192:195], v[196:199], v[96:111]
  v_mfma_f32_32x32x16_bf16 v[112:127], a[196:199], v[196:199], v[112:127]
  s_add_u32 s70, s31, 14
  v_mov_b32 v31, s70
  s_cmp_lg_u32 s58, 0
  s_cbranch_scc1 ALT_23
  buffer_store_dword v31, v5, s[8:11], s65 offen
ALTB_23:
  s_add_u32 s62, s74, 0x1c000
  buffer_load_dwordx4 v[244:247], v1, s[8:11], s62 offen offset:3072 sc1
  s_waitcnt vmcnt(13)
  v_mfma_f32_32x32x16_bf16 v[64:79], a[200:203], v[200:203], v[64:79]
  v_mfma_f32_32x32x16_bf16 v[80:95], a[204:207], v[200:203], v[80:95]
  buffer_load_dwordx4 v[248:251], v1, s[8:11], s75 offen offset:3072 sc1
  s_waitcnt vmcnt(13)
  v_mfma_f32_32x32x16_bf16 v[96:111], a[200:203], v[204:207], v[96:111]
  v_mfma_f32_32x32x16_bf16 v[112:127], a[204:207], v[204:207], v[112:127]
  s_add_u32 s62, s75, 0x1c000
  buffer_load_dwordx4 v[252:255], v1, s[8:11], s62 offen offset:3072 sc1
  s_waitcnt vmcnt(13)
  v_mfma_f32_32x32x16_bf16 v[64:79], a[208:211], v[208:211], v[64:79]
  v_mfma_f32_32x32x16_bf16 v[80:95], a[212:215], v[208:211], v[80:95]
  s_add_u32 s68, s31, 13
  s_waitcnt vmcnt(11)
  v_subrev_u32 v26, s68, v26
  v_cmp_lt_u32 vcc, 15, v26
  s_cbranch_vccz HC_32
  s_mov_b32 s69, 0
POLL_33:
  buffer_load_dword v26, v4, s[8:11], s66 offen sc1
  s_waitcnt vmcnt(0)
  s_add_u32 s68, s31, 13
  s_waitcnt vmcnt(0)
  v_subrev_u32 v26, s68, v26
  s_waitcnt vmcnt(0)
  v_cmp_lt_u32 vcc, 15, v26
  s_cbranch_vccz PD_34
  s_add_u32 s69, s69, 1
  s_cmp_lt_u32 s69, s33
  s_cbranch_scc1 POLL_33
  s_mov_b32 s33, 1
PD_34:
HC_32:
  buffer_load_dwordx4 v[128:131], v1, s[8:11], s72 offen offset:2048 sc1
  v_mfma_f32_32x32x16_bf16 v[96:111], a[208:211], v[212:215], v[96:111]
  v_mfma_f32_32x32x16_bf16 v[112:127], a[212:215], v[212:215], v[112:127]
  s_add_u32 s62, s72, 0x1c000
  buffer_load_dwordx4 v[132:135], v1, s[8:11], s62 offen offset:2048 sc1
  s_waitcnt vmcnt(12)
  v_mfma_f32_32x32x16_bf16 v[64:79], a[216:219], v[216:219], v[64:79]
  v_mfma_f32_32x32x16_bf16 v[80:95], a[220:223], v[216:219], v[80:95]
  buffer_load_dwordx4 v[136:139], v1, s[8:11], s73 offen offset:2048 sc1
  s_waitcnt vmcnt(12)
  v_mfma_f32_32x32x16_bf16 v[96:111], a[216:219], v[220:223], v[96:111]
  v_mfma_f32_32x32x16_bf16 v[112:127], a[220:223], v[220:223], v[112:127]
  s_add_u32 s62, s73, 0x1c000
  buffer_load_dwordx4 v[140:143], v1, s[8:11], s62 offen offset:2048 sc1
  s_waitcnt vmcnt(12)
  v_mfma_f32_32x32x16_bf16 v[64:79], a[24:27], v[224:227], v[64:79]
  v_mfma_f32_32x32x16_bf16 v[80:95], a[28:31], v[224:227], v[80:95]
  buffer_load_dwordx4 v[144:147], v1, s[8:11], s74 offen offset:2048 sc1
  s_waitcnt vmcnt(12)
  v_mfma_f32_32x32x16_bf16 v[96:111], a[24:27], v[228:231], v[96:111]
  v_mfma_f32_32x32x16_bf16 v[112:127], a[28:31], v[228:231], v[112:127]
  s_add_u32 s62, s74, 0x1c000
  buffer_load_dwordx4 v[148:151], v1, s[8:11], s62 offen offset:2048 sc1
  s_waitcnt vmcnt(12)
  v_mfma_f32_32x32x16_bf16 v[64:79], a[72:75], v[232:235], v[64:79]
  v_mfma_f32_32x32x16_bf16 v[80:95], a[76:79], v[232:235], v[80:95]
  buffer_load_dword v26, v4, s[8:11], s66 offen sc1
  buffer_load_dwordx4 v[152:155], v1, s[8:11], s75 offen offset:2048 sc1
  s_waitcnt vmcnt(13)
  v_mfma_f32_32x32x16_bf16 v[96:111], a[72:75], v[236:239], v[96:111]
  v_mfma_f32_32x32x16_bf16 v[112:127], a[76:79], v[236:239], v[112:127]
  s_add_u32 s62, s75, 0x1c000
  buffer_load_dwordx4 v[156:159], v1, s[8:11], s62 offen offset:2048 sc1
  s_waitcnt vmcnt(13)
  v_mfma_f32_32x32x16_bf16 v[64:79], a[120:123], v[240:243], v[64:79]
  v_mfma_f32_32x32x16_bf16 v[80:95], a[124:127], v[240:243], v[80:95]
  buffer_load_dwordx4 v[160:163], v1, s[8:11], s72 offen offset:1024 sc1
  s_waitcnt vmcnt(12)
  v_mfma_f32_32x32x16_bf16 v[96:111], a[120:123], v[244:247], v[96:111]
  v_mfma_f32_32x32x16_bf16 v[112:127], a[124:127], v[244:247], v[112:127]
  s_add_u32 s62, s72, 0x1c000
  buffer_load_dwordx4 v[164:167], v1, s[8:11], s62 offen offset:1024 sc1
  s_waitcnt vmcnt(12)
  v_mfma_f32_32x32x16_bf16 v[64:79], a[168:171], v[248:251], v[64:79]
  v_mfma_f32_32x32x16_bf16 v[80:95], a[172:175], v[248:251], v[80:95]
  buffer_load_dwordx4 v[168:171], v1, s[8:11], s73 offen offset:1024 sc1
  s_waitcnt vmcnt(12)
  v_mfma_f32_32x32x16_bf16 v[96:111], a[168:171], v[252:255], v[96:111]
  v_mfma_f32_32x32x16_bf16 v[112:127], a[172:175], v[252:255], v[112:127]
  s_add_u32 s62, s73, 0x1c000
  buffer_load_dwordx4 v[172:175], v1, s[8:11], s62 offen offset:1024 sc1
  s_waitcnt vmcnt(12)
  v_mfma_f32_32x32x16_bf16 v[64:79], a[16:19], v[128:131], v[64:79]
  v_mfma_f32_32x32x16_bf16 v[80:95], a[20:23], v[128:131], v[80:95]
  buffer_load_dwordx4 v[176:179], v1, s[8:11], s74 offen offset:1024 sc1
  s_waitcnt vmcnt(12)
  v_mfma_f32_32x32x16_bf16 v[96:111], a[16:19], v[132:135], v[96:111]
  v_mfma_f32_32x32x16_bf16 v[112:127], a[20:23], v[132:135], v[112:127]
  s_add_u32 s62, s74, 0x1c000
  buffer_load_dwordx4 v[180:183], v1, s[8:11], s62 offen offset:1024 sc1
  s_waitcnt vmcnt(12)
  v_mfma_f32_32x32x16_bf16 v[64:79], a[64:67], v[136:139], v[64:79]
  v_mfma_f32_32x32x16_bf16 v[80:95], a[68:71], v[136:139], v[80:95]
  buffer_load_dwordx4 v[184:187], v1, s[8:11], s75 offen offset:1024 sc1
  s_waitcnt vmcnt(12)
  v_mfma_f32_32x32x16_bf16 v[96:111], a[64:67], v[140:143], v[96:111]
  v_mfma_f32_32x32x16_bf16 v[112:127], a[68:71], v[140:143], v[112:127]
  s_add_u32 s62, s75, 0x1c000
  buffer_load_dwordx4 v[188:191], v1, s[8:11], s62 offen offset:1024 sc1
  s_waitcnt vmcnt(12)
  v_mfma_f32_32x32x16_bf16 v[64:79], a[112:115], v[144:147], v[64:79]
  v_mfma_f32_32x32x16_bf16 v[80:95], a[116:119], v[144:147], v[80:95]
  s_add_u32 s68, s31, 14
  s_waitcnt vmcnt(10)
  v_subrev_u32 v26, s68, v26
  v_cmp_lt_u32 vcc, 15, v26
  s_cbranch_vccz HC_35
  s_mov_b32 s69, 0
POLL_36:
  buffer_load_dword v26, v4, s[8:11], s66 offen sc1
  s_waitcnt vmcnt(0)
  s_add_u32 s68, s31, 14
  s_waitcnt vmcnt(0)
  v_subrev_u32 v26, s68, v26
  s_waitcnt vmcnt(0)
  v_cmp_lt_u32 vcc, 15, v26
  s_cbranch_vccz PD_37
  s_add_u32 s69, s69, 1
  s_cmp_lt_u32 s69, s33
  s_cbranch_scc1 POLL_36
  s_mov_b32 s33, 1
PD_37:
HC_35:
  buffer_load_dwordx4 v[192:195], v1, s[8:11], s72 offen sc1
  v_mfma_f32_32x32x16_bf16 v[96:111], a[112:115], v[148:151], v[96:111]
  v_mfma_f32_32x32x16_bf16 v[112:127], a[116:119], v[148:151], v[112:127]
  buffer_load_dwordx4 v[196:199], v1, s[8:11], s73 offen sc1
  s_waitcnt vmcnt(11)
  v_mfma_f32_32x32x16_bf16 v[64:79], a[160:163], v[152:155], v[64:79]
  v_mfma_f32_32x32x16_bf16 v[80:95], a[164:167], v[152:155], v[80:95]
  buffer_load_dwordx4 v[200:203], v1, s[8:11], s74 offen sc1
  s_waitcnt vmcnt(11)
  v_mfma_f32_32x32x16_bf16 v[96:111], a[160:163], v[156:159], v[96:111]
  v_mfma_f32_32x32x16_bf16 v[112:127], a[164:167], v[156:159], v[112:127]
  buffer_load_dwordx4 v[204:207], v1, s[8:11], s75 offen sc1
  s_waitcnt vmcnt(11)
  v_mfma_f32_32x32x16_bf16 v[64:79], a[8:11], v[160:163], v[64:79]
  v_mfma_f32_32x32x16_bf16 v[80:95], a[12:15], v[160:163], v[80:95]
  s_barrier
  s_add_u32 s62, s72, 0x1c000
  buffer_load_dwordx4 v[208:211], v1, s[8:11], s62 offen sc1
  s_waitcnt vmcnt(11)
  v_mfma_f32_32x32x16_bf16 v[96:111], a[8:11], v[164:167], v[96:111]
  v_mfma_f32_32x32x16_bf16 v[112:127], a[12:15], v[164:167], v[112:127]
  s_add_u32 s62, s73, 0x1c000
  buffer_load_dwordx4 v[212:215], v1, s[8:11], s62 offen sc1
  s_waitcnt vmcnt(11)
  v_mfma_f32_32x32x16_bf16 v[64:79], a[56:59], v[168:171], v[64:79]
  v_mfma_f32_32x32x16_bf16 v[80:95], a[60:63], v[168:171], v[80:95]
  s_add_u32 s62, s74, 0x1c000
  buffer_load_dwordx4 v[216:219], v1, s[8:11], s62 offen sc1
  s_waitcnt vmcnt(11)
  v_mfma_f32_32x32x16_bf16 v[96:111], a[56:59], v[172:175], v[96:111]
  v_mfma_f32_32x32x16_bf16 v[112:127], a[60:63], v[172:175], v[112:127]
  s_add_u32 s62, s75, 0x1c000
  buffer_load_dwordx4 v[220:223], v1, s[8:11], s62 offen sc1
  s_waitcnt vmcnt(11)
  v_mfma_f32_32x32x16_bf16 v[64:79], a[104:107], v[176:179], v[64:79]
  v_mfma_f32_32x32x16_bf16 v[80:95], a[108:111], v[176:179], v[80:95]
  s_waitcnt vmcnt(10)
  v_mfma_f32_32x32x16_bf16 v[96:111], a[104:107], v[180:183], v[96:111]
  v_mfma_f32_32x32x16_bf16 v[112:127], a[108:111], v[180:183], v[112:127]
  s_waitcnt vmcnt(9)
  v_mfma_f32_32x32x16_bf16 v[64:79], a[152:155], v[184:187], v[64:79]
  v_mfma_f32_32x32x16_bf16 v[80:95], a[156:159], v[184:187], v[80:95]
  s_waitcnt vmcnt(8)
  v_mfma_f32_32x32x16_bf16 v[96:111], a[152:155], v[188:191], v[96:111]
  v_mfma_f32_32x32x16_bf16 v[112:127], a[156:159], v[188:191], v[112:127]
  s_waitcnt vmcnt(7)
  v_mfma_f32_32x32x16_bf16 v[64:79], a[0:3], v[192:195], v[64:79]
  v_mfma_f32_32x32x16_bf16 v[80:95], a[4:7], v[192:195], v[80:95]
  s_or_b32 s63, s26, s24
  s_cselect_b32 s63, 0, 1
  s_cmp_lg_u32 s63, 0
  s_cbranch_scc1 ALT_24
  buffer_load_dword v21, v5, s[8:11], s45 offen
ALTB_24:
  s_waitcnt vmcnt(7)
  v_mfma_f32_32x32x16_bf16 v[64:79], a[48:51], v[196:199], v[64:79]
  v_mfma_f32_32x32x16_bf16 v[80:95], a[52:55], v[196:199], v[80:95]
  s_waitcnt vmcnt(6)
  v_mfma_f32_32x32x16_bf16 v[64:79], a[96:99], v[200:203], v[64:79]
  v_mfma_f32_32x32x16_bf16 v[80:95], a[100:103], v[200:203], v[80:95]
  s_waitcnt vmcnt(5)
  v_mfma_f32_32x32x16_bf16 v[64:79], a[144:147], v[204:207], v[64:79]
  v_mfma_f32_32x32x16_bf16 v[80:95], a[148:151], v[204:207], v[80:95]
  s_waitcnt vmcnt(4)
  v_mfma_f32_32x32x16_bf16 v[96:111], a[0:3], v[208:211], v[96:111]
  s_waitcnt vmcnt(3)
  v_mfma_f32_32x32x16_bf16 v[96:111], a[48:51], v[212:215], v[96:111]
  s_nop 6
  v_cvt_pk_bf16_f32 v64, v64, v65
  v_cvt_pk_bf16_f32 v65, v66, v67
  v_cvt_pk_bf16_f32 v66, v68, v69
  v_cvt_pk_bf16_f32 v67, v70, v71
  ds_write_b128 v27, v[64:67] offset:0
  s_waitcnt vmcnt(2)
  v_mfma_f32_32x32x16_bf16 v[96:111], a[96:99], v[216:219], v[96:111]
  v_cvt_pk_bf16_f32 v72, v72, v73
  v_cvt_pk_bf16_f32 v73, v74, v75
  v_cvt_pk_bf16_f32 v74, v76, v77
  v_cvt_pk_bf16_f32 v75, v78, v79
  ds_write_b128 v27, v[72:75] offset:512
  s_waitcnt vmcnt(1)
  v_mfma_f32_32x32x16_bf16 v[96:111], a[144:147], v[220:223], v[96:111]
  v_cvt_pk_bf16_f32 v80, v80, v81
  v_cvt_pk_bf16_f32 v81, v82, v83
  v_cvt_pk_bf16_f32 v82, v84, v85
  v_cvt_pk_bf16_f32 v83, v86, v87
  ds_write_b128 v27, v[80:83] offset:1024
  v_mfma_f32_32x32x16_bf16 v[112:127], a[4:7], v[208:211], v[112:127]
  v_cvt_pk_bf16_f32 v88, v88, v89
  v_cvt_pk_bf16_f32 v89, v90, v91
  v_cvt_pk_bf16_f32 v90, v92, v93
  v_cvt_pk_bf16_f32 v91, v94, v95
  ds_write_b128 v27, v[88:91] offset:1536
  v_mfma_f32_32x32x16_bf16 v[112:127], a[52:55], v[212:215], v[112:127]
  v_cvt_pk_bf16_f32 v96, v96, v97
  v_cvt_pk_bf16_f32 v97, v98, v99
  v_cvt_pk_bf16_f32 v98, v100, v101
  v_cvt_pk_bf16_f32 v99, v102, v103
  v_mfma_f32_32x32x16_bf16 v[112:127], a[100:103], v[216:219], v[112:127]
  ds_write_b128 v27, v[96:99] offset:16384
  v_cvt_pk_bf16_f32 v104, v104, v105
  v_cvt_pk_bf16_f32 v105, v106, v107
  v_mfma_f32_32x32x16_bf16 v[112:127], a[148:151], v[220:223], v[112:127]
  v_cvt_pk_bf16_f32 v106, v108, v109
  v_cvt_pk_bf16_f32 v107, v110, v111
  ds_write_b128 v27, v[104:107] offset:16896
  s_nop 8
  v_cvt_pk_bf16_f32 v112, v112, v113
  v_cvt_pk_bf16_f32 v113, v114, v115
  v_cvt_pk_bf16_f32 v114, v116, v117
  v_cvt_pk_bf16_f32 v115, v118, v119
  ds_write_b128 v27, v[112:115] offset:17408
  v_cvt_pk_bf16_f32 v120, v120, v121
  v_cvt_pk_bf16_f32 v121, v122, v123
  v_cvt_pk_bf16_f32 v122, v124, v125
  v_cvt_pk_bf16_f32 v123, v126, v127
  ds_write_b128 v27, v[120:123] offset:17920
  s_add_u32 s63, s52, 0x8000
  v_add_u32 v26, s63, v1
  s_waitcnt lgkmcnt(0)
  s_barrier
  ds_read_b32 v28, v19
  ds_read_b128 v[192:195], v26 offset:0
  ds_read_b128 v[196:199], v26 offset:2048
  ds_read_b128 v[200:203], v26 offset:4096
  ds_read_b128 v[204:207], v26 offset:6144
  ds_read_b128 v[208:211], v26 offset:1024
  ds_read_b128 v[212:215], v26 offset:3072
  ds_read_b128 v[216:219], v26 offset:5120
  ds_read_b128 v[220:223], v26 offset:7168
  s_waitcnt lgkmcnt(7)
  v_dot2_f32_bf16 v64, v192, s53, 0
  v_dot2_f32_bf16 v65, v192, s54, 0
  v_dot2_f32_bf16 v66, v193, s53, 0
  v_dot2_f32_bf16 v67, v193, s54, 0
  v_dot2_f32_bf16 v68, v194, s53, 0
  v_dot2_f32_bf16 v69, v194, s54, 0
  v_dot2_f32_bf16 v70, v195, s53, 0
  v_dot2_f32_bf16 v71, v195, s54, 0
  s_waitcnt lgkmcnt(6)
  v_dot2_f32_bf16 v64, v196, s53, v64
  v_dot2_f32_bf16 v65, v196, s54, v65
  v_dot2_f32_bf16 v66, v197, s53, v66
  v_dot2_f32_bf16 v67, v197, s54, v67
  v_dot2_f32_bf16 v68, v198, s53, v68
  v_dot2_f32_bf16 v69, v198, s54, v69
  v_dot2_f32_bf16 v70, v199, s53, v70
  v_dot2_f32_bf16 v71, v199, s54, v71
  s_waitcnt lgkmcnt(5)
  v_dot2_f32_bf16 v64, v200, s53, v64
  v_dot2_f32_bf16 v65, v200, s54, v65
  v_dot2_f32_bf16 v66, v201, s53, v66
  v_dot2_f32_bf16 v67, v201, s54, v67
  v_dot2_f32_bf16 v68, v202, s53, v68
  v_dot2_f32_bf16 v69, v202, s54, v69
  v_dot2_f32_bf16 v70, v203, s53, v70
  v_dot2_f32_bf16 v71, v203, s54, v71
  s_waitcnt lgkmcnt(4)
  v_dot2_f32_bf16 v64, v204, s53, v64
  v_dot2_f32_bf16 v65, v204, s54, v65
  v_dot2_f32_bf16 v66, v205, s53, v66
  v_dot2_f32_bf16 v67, v205, s54, v67
  v_dot2_f32_bf16 v68, v206, s53, v68
  v_dot2_f32_bf16 v69, v206, s54, v69
  v_dot2_f32_bf16 v70, v207, s53, v70
  v_dot2_f32_bf16 v71, v207, s54, v71
  v_pk_fma_f32 v[32:33], v[64:65], v[28:29], v[32:33] op_sel_hi:[1,0,1]
  v_pk_fma_f32 v[34:35], v[66:67], v[28:29], v[34:35] op_sel_hi:[1,0,1]
  v_pk_fma_f32 v[36:37], v[68:69], v[28:29], v[36:37] op_sel_hi:[1,0,1]
  v_pk_fma_f32 v[38:39], v[70:71], v[28:29], v[38:39] op_sel_hi:[1,0,1]
  v_cvt_pk_bf16_f32 v48, v32, v33
  v_cvt_pk_bf16_f32 v49, v34, v35
  v_cvt_pk_bf16_f32 v50, v36, v37
  v_cvt_pk_bf16_f32 v51, v38, v39
  buffer_store_dwordx4 v[48:51], v16, s[16:19], s51 offen sc1
  s_waitcnt lgkmcnt(3)
  v_dot2_f32_bf16 v72, v208, s53, 0
  v_dot2_f32_bf16 v73, v208, s54, 0
  v_dot2_f32_bf16 v74, v209, s53, 0
  v_dot2_f32_bf16 v75, v209, s54, 0
  v_dot2_f32_bf16 v76, v210, s53, 0
  v_dot2_f32_bf16 v77, v210, s54, 0
  v_dot2_f32_bf16 v78, v211, s53, 0
  v_dot2_f32_bf16 v79, v211, s54, 0
  s_waitcnt lgkmcnt(2)
  v_dot2_f32_bf16 v72, v212, s53, v72
  v_dot2_f32_bf16 v73, v212, s54, v73
  v_dot2_f32_bf16 v74, v213, s53, v74
  v_dot2_f32_bf16 v75, v213, s54, v75
  v_dot2_f32_bf16 v76, v214, s53, v76
  v_dot2_f32_bf16 v77, v214, s54, v77
  v_dot2_f32_bf16 v78, v215, s53, v78
  v_dot2_f32_bf16 v79, v215, s54, v79
  s_waitcnt lgkmcnt(1)
  v_dot2_f32_bf16 v72, v216, s53, v72
  v_dot2_f32_bf16 v73, v216, s54, v73
  v_dot2_f32_bf16 v74, v217, s53, v74
  v_dot2_f32_bf16 v75, v217, s54, v75
  v_dot2_f32_bf16 v76, v218, s53, v76
  v_dot2_f32_bf16 v77, v218, s54, v77
  v_dot2_f32_bf16 v78, v219, s53, v78
  v_dot2_f32_bf16 v79, v219, s54, v79
  s_waitcnt lgkmcnt(0)
  v_dot2_f32_bf16 v72, v220, s53, v72
  v_dot2_f32_bf16 v73, v220, s54, v73
  v_dot2_f32_bf16 v74, v221, s53, v74
  v_dot2_f32_bf16 v75, v221, s54, v75
  v_dot2_f32_bf16 v76, v222, s53, v76
  v_dot2_f32_bf16 v77, v222, s54, v77
  v_dot2_f32_bf16 v78, v223, s53, v78
  v_dot2_f32_bf16 v79, v223, s54, v79
  v_pk_fma_f32 v[40:41], v[72:73], v[28:29], v[40:41] op_sel_hi:[1,0,1]
  v_pk_fma_f32 v[42:43], v[74:75], v[28:29], v[42:43] op_sel_hi:[1,0,1]
  v_pk_fma_f32 v[44:45], v[76:77], v[28:29], v[44:45] op_sel_hi:[1,0,1]
  v_pk_fma_f32 v[46:47], v[78:79], v[28:29], v[46:47] op_sel_hi:[1,0,1]
  v_cvt_pk_bf16_f32 v52, v40, v41
  v_cvt_pk_bf16_f32 v53, v42, v43
  v_cvt_pk_bf16_f32 v54, v44, v45
  v_cvt_pk_bf16_f32 v55, v46, v47
  buffer_store_dwordx4 v[52:55], v16, s[16:19], s51 offen offset:64 sc1
  s_or_b32 s63, s27, s28
  s_or_b32 s63, s63, s24
  s_cselect_b32 s63, 0x70000000, 0
  s_add_u32 s70, s32, 1
  v_mov_b32 v31, s70
  buffer_store_dword v31, v5, s[8:11], s63 offen sc1
  s_waitcnt vmcnt(0)
M_END:
  s_endpgm
ALT_0:
  buffer_store_dwordx4 v[96:99], v1, s[8:11], s60 offen sc1
  s_branch ALTB_0
ALT_1:
  buffer_store_dwordx4 v[100:103], v1, s[8:11], s60 offen offset:1024 sc1
  s_branch ALTB_1
ALT_2:
  buffer_store_dword v31, v5, s[8:11], s48 offen sc1
  s_branch ALTB_2
ALT_3:
  buffer_store_dwordx4 v[48:51], v7, s[8:11], s40 offen sc1
  s_branch ALTB_3
ALT_4:
  buffer_store_dwordx4 v[52:55], v7, s[8:11], s40 offen offset:2048 sc1
  s_branch ALTB_4
ALT_5:
  buffer_store_dword v28, v17, s[8:11], s42 offen sc1
  s_branch ALTB_5
ALT_6:
  buffer_store_dword v31, v5, s[8:11], s46 offen sc1
  s_branch ALTB_6
ALT_7:
  s_branch PGS11
.p2align 12
PG11:
  s_branch PGB
PGS11:
  buffer_store_dword v31, v5, s[8:11], s65 offen sc1
  s_branch ALTB_7
ALT_8:
  buffer_store_dword v31, v5, s[8:11], s65 offen sc1
  s_branch ALTB_8
ALT_9:
  buffer_store_dword v31, v5, s[8:11], s65 offen sc1
  s_branch ALTB_9
ALT_10:
  buffer_store_dwordx4 v[48:51], v7, s[8:11], s60 offen sc1
  s_branch ALTB_10
ALT_11:
  buffer_store_dwordx4 v[52:55], v7, s[8:11], s60 offen offset:2048 sc1
  s_branch ALTB_11
ALT_12:
  buffer_store_dword v28, v17, s[8:11], s60 offen sc1
  s_branch ALTB_12
ALT_13:
  buffer_store_dword v31, v5, s[8:11], s46 offen sc1
  s_branch ALTB_13
ALT_14:
  buffer_store_dwordx4 v[96:99], v1, s[8:11], s63 offen sc1
  s_branch ALTB_14
ALT_15:
  buffer_store_dwordx4 v[100:103], v1, s[8:11], s63 offen offset:1024 sc1
  s_branch ALTB_15
ALT_16:
  buffer_store_dword v31, v5, s[8:11], s48 offen sc1
  s_branch ALTB_16
ALT_17:
  buffer_store_dwordx4 v[48:51], v7, s[8:11], s60 offen sc1
  s_branch ALTB_17
ALT_18:
  buffer_store_dwordx4 v[52:55], v7, s[8:11], s60 offen offset:2048 sc1
  s_branch ALTB_18
ALT_19:
  buffer_store_dword v28, v17, s[8:11], s60 offen sc1
  s_branch ALTB_19
ALT_20:
  buffer_store_dword v31, v5, s[8:11], s46 offen sc1
  s_branch ALTB_20
ALT_21:
  buffer_store_dword v31, v5, s[8:11], s65 offen sc1
  s_branch ALTB_21
ALT_22:
  buffer_store_dword v31, v5, s[8:11], s65 offen sc1
  s_branch ALTB_22
ALT_23:
  buffer_store_dword v31, v5, s[8:11], s65 offen sc1
  s_branch ALTB_23
ALT_24:
  buffer_wbl2 sc1
  s_branch ALTB_24
CODE_END:
.section .rodata,"a"
.p2align 6
.amdhsa_kernel interleave_layers__linear_kernel_hedgehog__glu_gated_reglu__prompt_kernel
  .amdhsa_next_free_vgpr 512
  .amdhsa_next_free_sgpr 102
  .amdhsa_accum_offset 256
  .amdhsa_group_segment_fixed_size 0
  .amdhsa_kernarg_size 88
  .amdhsa_user_sgpr_count 2
  .amdhsa_user_sgpr_kernarg_segment_ptr 1
  .amdhsa_system_sgpr_workgroup_id_x 1
.end_amdhsa_kernel
.text
```
